```python
import torch

def _softmax(x, axis=-1):
    return torch.softmax(x, dim=axis)
def _gelu(x):
    return torch.nn.functional.gelu(x, approximate="tanh")
def _silu(x):
    return torch.nn.functional.silu(x)
def _sigmoid(x):
    return torch.sigmoid(x)
def _layernorm(x, axis=-1, eps=1e-5):
    m = x.mean(dim=axis, keepdim=True)
    v = x.var(dim=axis, keepdim=True, unbiased=False)
    return (x - m) / torch.sqrt(v + eps)
def _scatter_add(tgt, idx, src, axis=0):
    return tgt.clone().index_add_(axis, idx, src)
def _segment_sum(src, seg, n):
    out = torch.zeros((n,) + src.shape[1:], dtype=src.dtype)
    return out.index_add_(0, seg, src)
def _pad(x, pw):
    flat = tuple(v for pair in reversed(pw) for v in pair)
    return torch.nn.functional.pad(x, flat)

kernel_name = 'gated_mix__mha_block__swiglu_ffn__prompt'

def setup_inputs():

    _w = (lambda a: (lambda t: t.to(torch.bfloat16) if t.is_floating_point() else t)(torch.as_tensor(a)))
    def _A_setup():
        B, S, D, H = 1, 2048, 512, 32
        return {
            "x": _w((lambda *s: torch.randn(*s, dtype=torch.bfloat16) * 0.05)(B, S, D)),
            "wqkv": _w((lambda *s: torch.randn(*s, dtype=torch.bfloat16) * 0.8)(D, 3 * D)),
            "wo": _w((lambda *s: torch.randn(*s, dtype=torch.bfloat16) * 0.05)(D, D)),
        }
    _A_in = _A_setup()

    def _B_setup():
        B, S, D, F = 1, 2048, 512, 1376
        return {
            "x": _w((lambda *s: torch.randn(*s, dtype=torch.bfloat16) * 0.05)(B, S, D)),
            "w_gate": _w((lambda *s: torch.randn(*s, dtype=torch.bfloat16) * 0.1)(D, F)),
            "w_up": _w((lambda *s: torch.randn(*s, dtype=torch.bfloat16) * 0.1)(D, F)),
            "w_down": _w((lambda *s: torch.randn(*s, dtype=torch.bfloat16) * 0.1)(F, D)),
        }
    _B_in = _B_setup()

    return {
        "A_x": _A_in["x"],
        "A_wqkv": _A_in["wqkv"],
        "A_wo": _A_in["wo"],
        "B_x": _B_in["x"],
        "B_w_gate": _B_in["w_gate"],
        "B_w_up": _B_in["w_up"],
        "B_w_down": _B_in["w_down"],
        "gate_w": _w((lambda *s: torch.randn(*s, dtype=torch.bfloat16) * 0.05)(512) * 16.0),
    }

def reference(A_x, A_wqkv, A_wo, B_x, B_w_gate, B_w_up, B_w_down, gate_w):
    def _A_ref(x, wqkv, wo):
        B, S, D = x.shape
        H = 32
        Dh = D // H
        qkv = (lambda x, *d: x.permute(*d))((x @ wqkv).reshape(B, S, 3, H, Dh), 2, 0, 3, 1, 4)
        q, k, v = qkv[0], qkv[1], qkv[2]
        scores = torch.einsum("bhqd,bhkd->bhqk", q, k) * (Dh ** -0.5)
        p = _softmax(scores, axis=-1)
        o = torch.einsum("bhqk,bhkd->bhqd", p, v)
        return (lambda x, *d: x.permute(*d))(o, 0, 2, 1, 3).reshape(B, S, D) @ wo

    def _B_ref(x, w_gate, w_up, w_down):
        g = _silu(x @ w_gate)
        u = x @ w_up
        return (g * u) @ w_down

    x = A_x
    g = _sigmoid((x * gate_w).sum(-1, keepdims=True))
    a = _A_ref(x, A_wqkv, A_wo)
    b = _B_ref(x, B_w_gate, B_w_up, B_w_down)
    return g * a + (1 - g) * b
```

```asm
; @launch grid=(512,1,1) block=(512,1,1) lds=81920
.amdgcn_target "amdgcn-amd-amdhsa--gfx950"
.text
.globl gated_mix__mha_block__swiglu_ffn__prompt_kernel
.p2align 8
.type gated_mix__mha_block__swiglu_ffn__prompt_kernel,@function
gated_mix__mha_block__swiglu_ffn__prompt_kernel:
    s_cmp_ge_u32 s2, 512
    s_cbranch_scc1 L_exit
    s_load_dwordx16 s[16:31], s[0:1], 0
    s_load_dwordx4 s[32:35], s[0:1], 64
    s_load_dwordx2 s[36:37], s[0:1], 80
    v_lshrrev_b32 v1, 6, v0
    v_and_b32 v0, 63, v0
    s_nop 0
    v_readfirstlane_b32 s3, v1
    s_cmp_ge_u32 s2, 256
    s_cbranch_scc1 L_attn
    s_cmp_lt_u32 s2, 192
    s_cbranch_scc1 L_f_front
    s_cmp_ge_u32 s3, 4
    s_cbranch_scc1 L_f_front
    s_waitcnt lgkmcnt(0)
    v_lshrrev_b32 v24, 2, v0
    v_mul_u32_u24 v24, 2752, v24
    v_and_b32 v25, 3, v0
    v_lshlrev_b32 v25, 7, v25
    v_add_u32 v24, v24, v25
    s_lshr_b32 s60, s2, 3
    s_sub_u32 s60, s60, 24
    s_lshl_b32 s60, s60, 3
    s_lshl_b32 s62, s3, 1
    s_add_u32 s60, s60, s62
    s_add_u32 s60, s60, 0
    s_cmp_ge_u32 s60, 32
    s_cselect_b32 s92, s26, s24
    s_cselect_b32 s93, s27, s25
    s_mov_b32 s94, 0x158000
    s_mov_b32 s95, 0x20000
    s_and_b32 s60, s60, 31
    s_mul_i32 s60, s60, 44032
    s_and_b32 s62, s2, 3
    s_mul_i32 s62, s62, 11
    s_add_u32 s62, s62, 7
    s_lshr_b32 s62, s62, 1
    s_lshl_b32 s62, s62, 7
    s_add_u32 s60, s60, s62
    buffer_load_dword v1, v24, s[92:95], s60 offen
    s_lshr_b32 s60, s2, 3
    s_sub_u32 s60, s60, 24
    s_lshl_b32 s60, s60, 3
    s_lshl_b32 s62, s3, 1
    s_add_u32 s60, s60, s62
    s_add_u32 s60, s60, 1
    s_cmp_ge_u32 s60, 32
    s_cselect_b32 s92, s26, s24
    s_cselect_b32 s93, s27, s25
    s_mov_b32 s94, 0x158000
    s_mov_b32 s95, 0x20000
    s_and_b32 s60, s60, 31
    s_mul_i32 s60, s60, 44032
    s_and_b32 s62, s2, 3
    s_mul_i32 s62, s62, 11
    s_add_u32 s62, s62, 7
    s_lshr_b32 s62, s62, 1
    s_lshl_b32 s62, s62, 7
    s_add_u32 s60, s60, s62
    buffer_load_dword v2, v24, s[92:95], s60 offen
L_f_front:
    s_and_b32 s62, s2, 7
    s_lshr_b32 s63, s2, 3
    s_and_b32 s63, s63, 31
    s_lshr_b32 s38, s62, 2
    s_lshl_b32 s38, s38, 3
    s_and_b32 s60, s63, 7
    s_add_u32 s38, s38, s60
    s_and_b32 s62, s62, 3
    s_lshr_b32 s63, s63, 3
    s_mul_i32 s39, s62, 3
    s_add_u32 s39, s39, s63
    s_mul_i32 s60, s62, 11
    s_add_u32 s60, s60, 1
    s_lshr_b32 s60, s60, 1
    s_add_u32 s92, s60, s63
    s_mov_b32 s93, 2
    s_cmp_ge_u32 s62, 2
    s_cselect_b32 s97, 16, 5
    s_and_b32 s98, s62, 1
    s_mov_b32 s94, 0
    s_cmp_lt_u32 s3, 4
    s_cbranch_scc1 fr_compute
    s_setprio 3
    s_and_b32 s60, s3, 1
    s_lshl_b32 s60, s60, 2
    v_lshrrev_b32 v8, 4, v0
    v_add_u32 v8, s60, v8
    v_and_b32 v9, 7, v0
    v_xor_b32 v8, v8, v9
    v_lshlrev_b32 v8, 4, v8
    v_lshrrev_b32 v9, 3, v0
    v_lshlrev_b32 v9, 10, v9
    v_add_u32 v1, v8, v9
    v_lshrrev_b32 v8, 4, v0
    v_bfe_u32 v9, v0, 2, 2
    v_xor_b32 v9, v9, v8
    v_lshlrev_b32 v9, 6, v9
    v_mul_u32_u24 v8, 3072, v8
    v_add_u32 v8, v8, v9
    v_and_b32 v9, 3, v0
    v_lshlrev_b32 v9, 4, v9
    v_add_u32 v2, v8, v9
    v_bfe_u32 v8, v0, 2, 1
    v_bfe_u32 v9, v0, 4, 1
    v_xor_b32 v8, v8, v9
    v_lshlrev_b32 v8, 6, v8
    v_and_b32 v9, 3, v0
    v_lshlrev_b32 v9, 4, v9
    v_lshrrev_b32 v10, 3, v0
    v_mul_u32_u24 v10, 2752, v10
    v_add3_u32 v3, v8, v9, v10
    s_sub_u32 s63, s3, 4
    s_lshl_b32 s58, s38, 7
    s_lshl_b32 s60, s63, 3
    s_add_u32 s58, s58, s60
    s_lshl_b32 s58, s58, 10
    s_mul_i32 s59, s63, 12288
    s_lshl_b32 s60, s39, 8
    s_add_u32 s59, s59, s60
    s_lshl_b32 s61, s63, 10
    s_mul_i32 s95, s63, 22016
    s_lshl_b32 s60, s92, 7
    s_add_u32 s95, s95, s60
    s_add_u32 s96, s95, 128
    s_waitcnt lgkmcnt(0)
    s_mov_b32 s40, s16
    s_mov_b32 s41, s17
    s_mov_b32 s42, 0x200000
    s_mov_b32 s43, 0x20000
    s_mov_b32 s44, s18
    s_mov_b32 s45, s19
    s_mov_b32 s46, 0x180000
    s_mov_b32 s47, 0x20000
    s_mov_b32 s48, s24
    s_mov_b32 s49, s25
    s_mov_b32 s50, 0x158000
    s_mov_b32 s51, 0x20000
    s_mov_b32 s52, s26
    s_mov_b32 s53, s27
    s_mov_b32 s54, 0x158000
    s_mov_b32 s55, 0x20000
    s_lshl_b32 s60, s98, 16
    s_add_u32 s99, s58, s60
    s_mul_i32 s100, s63, 22016
    s_lshl_b32 s60, s97, 7
    s_add_u32 s100, s100, s60
    s_cmp_ge_u32 s2, 192
    s_cbranch_scc1 fr_lgate
    s_add_u32 m0, s61, 0x0
    s_add_u32 s60, s58, 0x0
    buffer_load_dwordx4 v1, s[40:43], s60 offen lds
    s_add_u32 m0, s61, 0x1000
    s_add_u32 s60, s58, 0x8000
    buffer_load_dwordx4 v1, s[40:43], s60 offen lds
    s_add_u32 m0, s61, 0x2000
    s_add_u32 s60, s58, 0x10000
    buffer_load_dwordx4 v1, s[40:43], s60 offen lds
    s_add_u32 m0, s61, 0x3000
    s_add_u32 s60, s58, 0x18000
    buffer_load_dwordx4 v1, s[40:43], s60 offen lds
    s_add_u32 m0, s61, 0xc000
    s_add_u32 s60, s59, 0x0
    buffer_load_dwordx4 v2, s[44:47], s60 offen lds
    s_add_u32 m0, s61, 0xd000
    s_add_u32 s60, s59, 0xc000
    buffer_load_dwordx4 v2, s[44:47], s60 offen lds
    s_add_u32 m0, s61, 0xe000
    s_add_u32 s60, s59, 0x18000
    buffer_load_dwordx4 v2, s[44:47], s60 offen lds
    s_add_u32 m0, s61, 0xf000
    s_add_u32 s60, s59, 0x24000
    buffer_load_dwordx4 v2, s[44:47], s60 offen lds
    s_add_u32 m0, s61, 0x4000
    s_add_u32 s60, s58, 0x80
    buffer_load_dwordx4 v1, s[40:43], s60 offen lds
    s_add_u32 m0, s61, 0x5000
    s_add_u32 s60, s58, 0x8080
    buffer_load_dwordx4 v1, s[40:43], s60 offen lds
    s_add_u32 m0, s61, 0x6000
    s_add_u32 s60, s58, 0x10080
    buffer_load_dwordx4 v1, s[40:43], s60 offen lds
    s_add_u32 m0, s61, 0x7000
    s_add_u32 s60, s58, 0x18080
    buffer_load_dwordx4 v1, s[40:43], s60 offen lds
    s_add_u32 m0, s61, 0x10000
    s_add_u32 s60, s59, 0x30000
    buffer_load_dwordx4 v2, s[44:47], s60 offen lds
    s_add_u32 m0, s61, 0x11000
    s_add_u32 s60, s59, 0x3c000
    buffer_load_dwordx4 v2, s[44:47], s60 offen lds
    s_add_u32 m0, s61, 0x12000
    s_add_u32 s60, s59, 0x48000
    buffer_load_dwordx4 v2, s[44:47], s60 offen lds
    s_add_u32 m0, s61, 0x13000
    s_add_u32 s60, s59, 0x54000
    buffer_load_dwordx4 v2, s[44:47], s60 offen lds
    s_add_u32 m0, s61, 0x8000
    s_add_u32 s60, s58, 0x100
    buffer_load_dwordx4 v1, s[40:43], s60 offen lds
    s_add_u32 m0, s61, 0x9000
    s_add_u32 s60, s58, 0x8100
    buffer_load_dwordx4 v1, s[40:43], s60 offen lds
    s_add_u32 m0, s61, 0xa000
    s_add_u32 s60, s58, 0x10100
    buffer_load_dwordx4 v1, s[40:43], s60 offen lds
    s_add_u32 m0, s61, 0xb000
    s_add_u32 s60, s58, 0x18100
    buffer_load_dwordx4 v1, s[40:43], s60 offen lds
    s_waitcnt vmcnt(12)
    s_barrier
    s_waitcnt vmcnt(4)
    s_barrier
    s_add_u32 m0, s61, 0xc000
    s_add_u32 s60, s59, 0x60000
    buffer_load_dwordx4 v2, s[44:47], s60 offen lds
    s_add_u32 m0, s61, 0xd000
    s_add_u32 s60, s59, 0x6c000
    buffer_load_dwordx4 v2, s[44:47], s60 offen lds
    s_add_u32 m0, s61, 0xe000
    s_add_u32 s60, s59, 0x78000
    buffer_load_dwordx4 v2, s[44:47], s60 offen lds
    s_add_u32 m0, s61, 0xf000
    s_add_u32 s60, s59, 0x84000
    buffer_load_dwordx4 v2, s[44:47], s60 offen lds
    s_add_u32 m0, s61, 0x0
    s_add_u32 s60, s58, 0x180
    buffer_load_dwordx4 v1, s[40:43], s60 offen lds
    s_add_u32 m0, s61, 0x1000
    s_add_u32 s60, s58, 0x8180
    buffer_load_dwordx4 v1, s[40:43], s60 offen lds
    s_add_u32 m0, s61, 0x2000
    s_add_u32 s60, s58, 0x10180
    buffer_load_dwordx4 v1, s[40:43], s60 offen lds
    s_add_u32 m0, s61, 0x3000
    s_add_u32 s60, s58, 0x18180
    buffer_load_dwordx4 v1, s[40:43], s60 offen lds
    s_waitcnt vmcnt(4)
    s_barrier
    s_add_u32 m0, s61, 0x10000
    s_add_u32 s60, s59, 0x90000
    buffer_load_dwordx4 v2, s[44:47], s60 offen lds
    s_add_u32 m0, s61, 0x11000
    s_add_u32 s60, s59, 0x9c000
    buffer_load_dwordx4 v2, s[44:47], s60 offen lds
    s_add_u32 m0, s61, 0x12000
    s_add_u32 s60, s59, 0xa8000
    buffer_load_dwordx4 v2, s[44:47], s60 offen lds
    s_add_u32 m0, s61, 0x13000
    s_add_u32 s60, s59, 0xb4000
    buffer_load_dwordx4 v2, s[44:47], s60 offen lds
    s_add_u32 m0, s61, 0x4000
    s_add_u32 s60, s58, 0x200
    buffer_load_dwordx4 v1, s[40:43], s60 offen lds
    s_add_u32 m0, s61, 0x5000
    s_add_u32 s60, s58, 0x8200
    buffer_load_dwordx4 v1, s[40:43], s60 offen lds
    s_add_u32 m0, s61, 0x6000
    s_add_u32 s60, s58, 0x10200
    buffer_load_dwordx4 v1, s[40:43], s60 offen lds
    s_add_u32 m0, s61, 0x7000
    s_add_u32 s60, s58, 0x18200
    buffer_load_dwordx4 v1, s[40:43], s60 offen lds
    s_waitcnt vmcnt(4)
    s_barrier
    s_add_u32 m0, s61, 0xc000
    s_add_u32 s60, s59, 0xc0000
    buffer_load_dwordx4 v2, s[44:47], s60 offen lds
    s_add_u32 m0, s61, 0xd000
    s_add_u32 s60, s59, 0xcc000
    buffer_load_dwordx4 v2, s[44:47], s60 offen lds
    s_add_u32 m0, s61, 0xe000
    s_add_u32 s60, s59, 0xd8000
    buffer_load_dwordx4 v2, s[44:47], s60 offen lds
    s_add_u32 m0, s61, 0xf000
    s_add_u32 s60, s59, 0xe4000
    buffer_load_dwordx4 v2, s[44:47], s60 offen lds
    s_add_u32 m0, s61, 0x8000
    s_add_u32 s60, s58, 0x280
    buffer_load_dwordx4 v1, s[40:43], s60 offen lds
    s_add_u32 m0, s61, 0x9000
    s_add_u32 s60, s58, 0x8280
    buffer_load_dwordx4 v1, s[40:43], s60 offen lds
    s_add_u32 m0, s61, 0xa000
    s_add_u32 s60, s58, 0x10280
    buffer_load_dwordx4 v1, s[40:43], s60 offen lds
    s_add_u32 m0, s61, 0xb000
    s_add_u32 s60, s58, 0x18280
    buffer_load_dwordx4 v1, s[40:43], s60 offen lds
    s_waitcnt vmcnt(4)
    s_barrier
    s_add_u32 m0, s61, 0x10000
    s_add_u32 s60, s59, 0xf0000
    buffer_load_dwordx4 v2, s[44:47], s60 offen lds
    s_add_u32 m0, s61, 0x11000
    s_add_u32 s60, s59, 0xfc000
    buffer_load_dwordx4 v2, s[44:47], s60 offen lds
    s_add_u32 m0, s61, 0x12000
    s_add_u32 s60, s59, 0x108000
    buffer_load_dwordx4 v2, s[44:47], s60 offen lds
    s_add_u32 m0, s61, 0x13000
    s_add_u32 s60, s59, 0x114000
    buffer_load_dwordx4 v2, s[44:47], s60 offen lds
    s_add_u32 m0, s61, 0x0
    s_add_u32 s60, s58, 0x300
    buffer_load_dwordx4 v1, s[40:43], s60 offen lds
    s_add_u32 m0, s61, 0x1000
    s_add_u32 s60, s58, 0x8300
    buffer_load_dwordx4 v1, s[40:43], s60 offen lds
    s_add_u32 m0, s61, 0x2000
    s_add_u32 s60, s58, 0x10300
    buffer_load_dwordx4 v1, s[40:43], s60 offen lds
    s_add_u32 m0, s61, 0x3000
    s_add_u32 s60, s58, 0x18300
    buffer_load_dwordx4 v1, s[40:43], s60 offen lds
    s_waitcnt vmcnt(4)
    s_barrier
    s_add_u32 m0, s61, 0xc000
    s_add_u32 s60, s59, 0x120000
    buffer_load_dwordx4 v2, s[44:47], s60 offen lds
    s_add_u32 m0, s61, 0xd000
    s_add_u32 s60, s59, 0x12c000
    buffer_load_dwordx4 v2, s[44:47], s60 offen lds
    s_add_u32 m0, s61, 0xe000
    s_add_u32 s60, s59, 0x138000
    buffer_load_dwordx4 v2, s[44:47], s60 offen lds
    s_add_u32 m0, s61, 0xf000
    s_add_u32 s60, s59, 0x144000
    buffer_load_dwordx4 v2, s[44:47], s60 offen lds
    s_add_u32 m0, s61, 0x4000
    s_add_u32 s60, s58, 0x380
    buffer_load_dwordx4 v1, s[40:43], s60 offen lds
    s_add_u32 m0, s61, 0x5000
    s_add_u32 s60, s58, 0x8380
    buffer_load_dwordx4 v1, s[40:43], s60 offen lds
    s_add_u32 m0, s61, 0x6000
    s_add_u32 s60, s58, 0x10380
    buffer_load_dwordx4 v1, s[40:43], s60 offen lds
    s_add_u32 m0, s61, 0x7000
    s_add_u32 s60, s58, 0x18380
    buffer_load_dwordx4 v1, s[40:43], s60 offen lds
    s_waitcnt vmcnt(4)
    s_barrier
    s_add_u32 m0, s61, 0x10000
    s_add_u32 s60, s59, 0x150000
    buffer_load_dwordx4 v2, s[44:47], s60 offen lds
    s_add_u32 m0, s61, 0x11000
    s_add_u32 s60, s59, 0x15c000
    buffer_load_dwordx4 v2, s[44:47], s60 offen lds
    s_add_u32 m0, s61, 0x12000
    s_add_u32 s60, s59, 0x168000
    buffer_load_dwordx4 v2, s[44:47], s60 offen lds
    s_add_u32 m0, s61, 0x13000
    s_add_u32 s60, s59, 0x174000
    buffer_load_dwordx4 v2, s[44:47], s60 offen lds
    s_waitcnt vmcnt(0)
    s_barrier
    s_barrier
    s_barrier
    s_barrier
    s_add_u32 m0, s61, 0x0
    s_add_u32 s60, s58, 0x0
    buffer_load_dwordx4 v1, s[40:43], s60 offen lds
    s_add_u32 m0, s61, 0x1000
    s_add_u32 s60, s58, 0x8000
    buffer_load_dwordx4 v1, s[40:43], s60 offen lds
    s_add_u32 m0, s61, 0x2000
    s_add_u32 s60, s58, 0x10000
    buffer_load_dwordx4 v1, s[40:43], s60 offen lds
    s_add_u32 m0, s61, 0x3000
    s_add_u32 s60, s58, 0x18000
    buffer_load_dwordx4 v1, s[40:43], s60 offen lds
    s_add_u32 m0, s61, 0xc000
    s_add_u32 s60, s95, 0x0
    buffer_load_dwordx4 v3, s[48:51], s60 offen lds
    s_add_u32 m0, s61, 0xd000
    s_add_u32 s60, s95, 0x15800
    buffer_load_dwordx4 v3, s[48:51], s60 offen lds
    s_add_u32 m0, s61, 0xe000
    s_add_u32 s60, s95, 0x0
    buffer_load_dwordx4 v3, s[52:55], s60 offen lds
    s_add_u32 m0, s61, 0xf000
    s_add_u32 s60, s95, 0x15800
    buffer_load_dwordx4 v3, s[52:55], s60 offen lds
    s_add_u32 m0, s61, 0x4000
    s_add_u32 s60, s58, 0x80
    buffer_load_dwordx4 v1, s[40:43], s60 offen lds
    s_add_u32 m0, s61, 0x5000
    s_add_u32 s60, s58, 0x8080
    buffer_load_dwordx4 v1, s[40:43], s60 offen lds
    s_add_u32 m0, s61, 0x6000
    s_add_u32 s60, s58, 0x10080
    buffer_load_dwordx4 v1, s[40:43], s60 offen lds
    s_add_u32 m0, s61, 0x7000
    s_add_u32 s60, s58, 0x18080
    buffer_load_dwordx4 v1, s[40:43], s60 offen lds
    s_add_u32 m0, s61, 0x10000
    s_add_u32 s60, s95, 0x2b000
    buffer_load_dwordx4 v3, s[48:51], s60 offen lds
    s_add_u32 m0, s61, 0x11000
    s_add_u32 s60, s95, 0x40800
    buffer_load_dwordx4 v3, s[48:51], s60 offen lds
    s_add_u32 m0, s61, 0x12000
    s_add_u32 s60, s95, 0x2b000
    buffer_load_dwordx4 v3, s[52:55], s60 offen lds
    s_add_u32 m0, s61, 0x13000
    s_add_u32 s60, s95, 0x40800
    buffer_load_dwordx4 v3, s[52:55], s60 offen lds
    s_add_u32 m0, s61, 0x8000
    s_add_u32 s60, s58, 0x100
    buffer_load_dwordx4 v1, s[40:43], s60 offen lds
    s_add_u32 m0, s61, 0x9000
    s_add_u32 s60, s58, 0x8100
    buffer_load_dwordx4 v1, s[40:43], s60 offen lds
    s_add_u32 m0, s61, 0xa000
    s_add_u32 s60, s58, 0x10100
    buffer_load_dwordx4 v1, s[40:43], s60 offen lds
    s_add_u32 m0, s61, 0xb000
    s_add_u32 s60, s58, 0x18100
    buffer_load_dwordx4 v1, s[40:43], s60 offen lds
    s_waitcnt vmcnt(12)
    s_barrier
    s_waitcnt vmcnt(4)
    s_barrier
    s_add_u32 m0, s61, 0xc000
    s_add_u32 s60, s95, 0x56000
    buffer_load_dwordx4 v3, s[48:51], s60 offen lds
    s_add_u32 m0, s61, 0xd000
    s_add_u32 s60, s95, 0x6b800
    buffer_load_dwordx4 v3, s[48:51], s60 offen lds
    s_add_u32 m0, s61, 0xe000
    s_add_u32 s60, s95, 0x56000
    buffer_load_dwordx4 v3, s[52:55], s60 offen lds
    s_add_u32 m0, s61, 0xf000
    s_add_u32 s60, s95, 0x6b800
    buffer_load_dwordx4 v3, s[52:55], s60 offen lds
    s_add_u32 m0, s61, 0x0
    s_add_u32 s60, s58, 0x180
    buffer_load_dwordx4 v1, s[40:43], s60 offen lds
    s_add_u32 m0, s61, 0x1000
    s_add_u32 s60, s58, 0x8180
    buffer_load_dwordx4 v1, s[40:43], s60 offen lds
    s_add_u32 m0, s61, 0x2000
    s_add_u32 s60, s58, 0x10180
    buffer_load_dwordx4 v1, s[40:43], s60 offen lds
    s_add_u32 m0, s61, 0x3000
    s_add_u32 s60, s58, 0x18180
    buffer_load_dwordx4 v1, s[40:43], s60 offen lds
    s_waitcnt vmcnt(4)
    s_barrier
    s_add_u32 m0, s61, 0x10000
    s_add_u32 s60, s95, 0x81000
    buffer_load_dwordx4 v3, s[48:51], s60 offen lds
    s_add_u32 m0, s61, 0x11000
    s_add_u32 s60, s95, 0x96800
    buffer_load_dwordx4 v3, s[48:51], s60 offen lds
    s_add_u32 m0, s61, 0x12000
    s_add_u32 s60, s95, 0x81000
    buffer_load_dwordx4 v3, s[52:55], s60 offen lds
    s_add_u32 m0, s61, 0x13000
    s_add_u32 s60, s95, 0x96800
    buffer_load_dwordx4 v3, s[52:55], s60 offen lds
    s_add_u32 m0, s61, 0x4000
    s_add_u32 s60, s58, 0x200
    buffer_load_dwordx4 v1, s[40:43], s60 offen lds
    s_add_u32 m0, s61, 0x5000
    s_add_u32 s60, s58, 0x8200
    buffer_load_dwordx4 v1, s[40:43], s60 offen lds
    s_add_u32 m0, s61, 0x6000
    s_add_u32 s60, s58, 0x10200
    buffer_load_dwordx4 v1, s[40:43], s60 offen lds
    s_add_u32 m0, s61, 0x7000
    s_add_u32 s60, s58, 0x18200
    buffer_load_dwordx4 v1, s[40:43], s60 offen lds
    s_waitcnt vmcnt(4)
    s_barrier
    s_add_u32 m0, s61, 0xc000
    s_add_u32 s60, s95, 0xac000
    buffer_load_dwordx4 v3, s[48:51], s60 offen lds
    s_add_u32 m0, s61, 0xd000
    s_add_u32 s60, s95, 0xc1800
    buffer_load_dwordx4 v3, s[48:51], s60 offen lds
    s_add_u32 m0, s61, 0xe000
    s_add_u32 s60, s95, 0xac000
    buffer_load_dwordx4 v3, s[52:55], s60 offen lds
    s_add_u32 m0, s61, 0xf000
    s_add_u32 s60, s95, 0xc1800
    buffer_load_dwordx4 v3, s[52:55], s60 offen lds
    s_add_u32 m0, s61, 0x8000
    s_add_u32 s60, s58, 0x280
    buffer_load_dwordx4 v1, s[40:43], s60 offen lds
    s_add_u32 m0, s61, 0x9000
    s_add_u32 s60, s58, 0x8280
    buffer_load_dwordx4 v1, s[40:43], s60 offen lds
    s_add_u32 m0, s61, 0xa000
    s_add_u32 s60, s58, 0x10280
    buffer_load_dwordx4 v1, s[40:43], s60 offen lds
    s_add_u32 m0, s61, 0xb000
    s_add_u32 s60, s58, 0x18280
    buffer_load_dwordx4 v1, s[40:43], s60 offen lds
    s_waitcnt vmcnt(4)
    s_barrier
    s_add_u32 m0, s61, 0x10000
    s_add_u32 s60, s95, 0xd7000
    buffer_load_dwordx4 v3, s[48:51], s60 offen lds
    s_add_u32 m0, s61, 0x11000
    s_add_u32 s60, s95, 0xec800
    buffer_load_dwordx4 v3, s[48:51], s60 offen lds
    s_add_u32 m0, s61, 0x12000
    s_add_u32 s60, s95, 0xd7000
    buffer_load_dwordx4 v3, s[52:55], s60 offen lds
    s_add_u32 m0, s61, 0x13000
    s_add_u32 s60, s95, 0xec800
    buffer_load_dwordx4 v3, s[52:55], s60 offen lds
    s_add_u32 m0, s61, 0x0
    s_add_u32 s60, s58, 0x300
    buffer_load_dwordx4 v1, s[40:43], s60 offen lds
    s_add_u32 m0, s61, 0x1000
    s_add_u32 s60, s58, 0x8300
    buffer_load_dwordx4 v1, s[40:43], s60 offen lds
    s_add_u32 m0, s61, 0x2000
    s_add_u32 s60, s58, 0x10300
    buffer_load_dwordx4 v1, s[40:43], s60 offen lds
    s_add_u32 m0, s61, 0x3000
    s_add_u32 s60, s58, 0x18300
    buffer_load_dwordx4 v1, s[40:43], s60 offen lds
    s_waitcnt vmcnt(4)
    s_barrier
    s_add_u32 m0, s61, 0xc000
    s_add_u32 s60, s95, 0x102000
    buffer_load_dwordx4 v3, s[48:51], s60 offen lds
    s_add_u32 m0, s61, 0xd000
    s_add_u32 s60, s95, 0x117800
    buffer_load_dwordx4 v3, s[48:51], s60 offen lds
    s_add_u32 m0, s61, 0xe000
    s_add_u32 s60, s95, 0x102000
    buffer_load_dwordx4 v3, s[52:55], s60 offen lds
    s_add_u32 m0, s61, 0xf000
    s_add_u32 s60, s95, 0x117800
    buffer_load_dwordx4 v3, s[52:55], s60 offen lds
    s_add_u32 m0, s61, 0x4000
    s_add_u32 s60, s58, 0x380
    buffer_load_dwordx4 v1, s[40:43], s60 offen lds
    s_add_u32 m0, s61, 0x5000
    s_add_u32 s60, s58, 0x8380
    buffer_load_dwordx4 v1, s[40:43], s60 offen lds
    s_add_u32 m0, s61, 0x6000
    s_add_u32 s60, s58, 0x10380
    buffer_load_dwordx4 v1, s[40:43], s60 offen lds
    s_add_u32 m0, s61, 0x7000
    s_add_u32 s60, s58, 0x18380
    buffer_load_dwordx4 v1, s[40:43], s60 offen lds
    s_waitcnt vmcnt(4)
    s_barrier
    s_add_u32 m0, s61, 0x10000
    s_add_u32 s60, s95, 0x12d000
    buffer_load_dwordx4 v3, s[48:51], s60 offen lds
    s_add_u32 m0, s61, 0x11000
    s_add_u32 s60, s95, 0x142800
    buffer_load_dwordx4 v3, s[48:51], s60 offen lds
    s_add_u32 m0, s61, 0x12000
    s_add_u32 s60, s95, 0x12d000
    buffer_load_dwordx4 v3, s[52:55], s60 offen lds
    s_add_u32 m0, s61, 0x13000
    s_add_u32 s60, s95, 0x142800
    buffer_load_dwordx4 v3, s[52:55], s60 offen lds
    s_waitcnt vmcnt(0)
    s_barrier
    s_barrier
    s_branch fr_pub
fr_lgate:
    s_add_u32 m0, s61, 0x0
    s_add_u32 s60, s58, 0x0
    buffer_load_dwordx4 v1, s[40:43], s60 offen lds
    s_add_u32 m0, s61, 0x1000
    s_add_u32 s60, s58, 0x8000
    buffer_load_dwordx4 v1, s[40:43], s60 offen lds
    s_add_u32 m0, s61, 0x2000
    s_add_u32 s60, s58, 0x10000
    buffer_load_dwordx4 v1, s[40:43], s60 offen lds
    s_add_u32 m0, s61, 0x3000
    s_add_u32 s60, s58, 0x18000
    buffer_load_dwordx4 v1, s[40:43], s60 offen lds
    s_add_u32 m0, s61, 0xc000
    s_add_u32 s60, s95, 0x0
    buffer_load_dwordx4 v3, s[48:51], s60 offen lds
    s_add_u32 m0, s61, 0xd000
    s_add_u32 s60, s95, 0x15800
    buffer_load_dwordx4 v3, s[48:51], s60 offen lds
    s_add_u32 m0, s61, 0xe000
    s_add_u32 s60, s95, 0x0
    buffer_load_dwordx4 v3, s[52:55], s60 offen lds
    s_add_u32 m0, s61, 0xf000
    s_add_u32 s60, s95, 0x15800
    buffer_load_dwordx4 v3, s[52:55], s60 offen lds
    s_add_u32 m0, s61, 0x4000
    s_add_u32 s60, s58, 0x80
    buffer_load_dwordx4 v1, s[40:43], s60 offen lds
    s_add_u32 m0, s61, 0x5000
    s_add_u32 s60, s58, 0x8080
    buffer_load_dwordx4 v1, s[40:43], s60 offen lds
    s_add_u32 m0, s61, 0x6000
    s_add_u32 s60, s58, 0x10080
    buffer_load_dwordx4 v1, s[40:43], s60 offen lds
    s_add_u32 m0, s61, 0x7000
    s_add_u32 s60, s58, 0x18080
    buffer_load_dwordx4 v1, s[40:43], s60 offen lds
    s_add_u32 m0, s61, 0x10000
    s_add_u32 s60, s95, 0x2b000
    buffer_load_dwordx4 v3, s[48:51], s60 offen lds
    s_add_u32 m0, s61, 0x11000
    s_add_u32 s60, s95, 0x40800
    buffer_load_dwordx4 v3, s[48:51], s60 offen lds
    s_add_u32 m0, s61, 0x12000
    s_add_u32 s60, s95, 0x2b000
    buffer_load_dwordx4 v3, s[52:55], s60 offen lds
    s_add_u32 m0, s61, 0x13000
    s_add_u32 s60, s95, 0x40800
    buffer_load_dwordx4 v3, s[52:55], s60 offen lds
    s_add_u32 m0, s61, 0x8000
    s_add_u32 s60, s58, 0x100
    buffer_load_dwordx4 v1, s[40:43], s60 offen lds
    s_add_u32 m0, s61, 0x9000
    s_add_u32 s60, s58, 0x8100
    buffer_load_dwordx4 v1, s[40:43], s60 offen lds
    s_add_u32 m0, s61, 0xa000
    s_add_u32 s60, s58, 0x10100
    buffer_load_dwordx4 v1, s[40:43], s60 offen lds
    s_add_u32 m0, s61, 0xb000
    s_add_u32 s60, s58, 0x18100
    buffer_load_dwordx4 v1, s[40:43], s60 offen lds
    s_waitcnt vmcnt(12)
    s_barrier
    s_waitcnt vmcnt(4)
    s_barrier
    s_add_u32 m0, s61, 0xc000
    s_add_u32 s60, s95, 0x56000
    buffer_load_dwordx4 v3, s[48:51], s60 offen lds
    s_add_u32 m0, s61, 0xd000
    s_add_u32 s60, s95, 0x6b800
    buffer_load_dwordx4 v3, s[48:51], s60 offen lds
    s_add_u32 m0, s61, 0xe000
    s_add_u32 s60, s95, 0x56000
    buffer_load_dwordx4 v3, s[52:55], s60 offen lds
    s_add_u32 m0, s61, 0xf000
    s_add_u32 s60, s95, 0x6b800
    buffer_load_dwordx4 v3, s[52:55], s60 offen lds
    s_add_u32 m0, s61, 0x0
    s_add_u32 s60, s58, 0x180
    buffer_load_dwordx4 v1, s[40:43], s60 offen lds
    s_add_u32 m0, s61, 0x1000
    s_add_u32 s60, s58, 0x8180
    buffer_load_dwordx4 v1, s[40:43], s60 offen lds
    s_add_u32 m0, s61, 0x2000
    s_add_u32 s60, s58, 0x10180
    buffer_load_dwordx4 v1, s[40:43], s60 offen lds
    s_add_u32 m0, s61, 0x3000
    s_add_u32 s60, s58, 0x18180
    buffer_load_dwordx4 v1, s[40:43], s60 offen lds
    s_waitcnt vmcnt(4)
    s_barrier
    s_add_u32 m0, s61, 0x10000
    s_add_u32 s60, s95, 0x81000
    buffer_load_dwordx4 v3, s[48:51], s60 offen lds
    s_add_u32 m0, s61, 0x11000
    s_add_u32 s60, s95, 0x96800
    buffer_load_dwordx4 v3, s[48:51], s60 offen lds
    s_add_u32 m0, s61, 0x12000
    s_add_u32 s60, s95, 0x81000
    buffer_load_dwordx4 v3, s[52:55], s60 offen lds
    s_add_u32 m0, s61, 0x13000
    s_add_u32 s60, s95, 0x96800
    buffer_load_dwordx4 v3, s[52:55], s60 offen lds
    s_add_u32 m0, s61, 0x4000
    s_add_u32 s60, s58, 0x200
    buffer_load_dwordx4 v1, s[40:43], s60 offen lds
    s_add_u32 m0, s61, 0x5000
    s_add_u32 s60, s58, 0x8200
    buffer_load_dwordx4 v1, s[40:43], s60 offen lds
    s_add_u32 m0, s61, 0x6000
    s_add_u32 s60, s58, 0x10200
    buffer_load_dwordx4 v1, s[40:43], s60 offen lds
    s_add_u32 m0, s61, 0x7000
    s_add_u32 s60, s58, 0x18200
    buffer_load_dwordx4 v1, s[40:43], s60 offen lds
    s_waitcnt vmcnt(4)
    s_barrier
    s_add_u32 m0, s61, 0xc000
    s_add_u32 s60, s95, 0xac000
    buffer_load_dwordx4 v3, s[48:51], s60 offen lds
    s_add_u32 m0, s61, 0xd000
    s_add_u32 s60, s95, 0xc1800
    buffer_load_dwordx4 v3, s[48:51], s60 offen lds
    s_add_u32 m0, s61, 0xe000
    s_add_u32 s60, s95, 0xac000
    buffer_load_dwordx4 v3, s[52:55], s60 offen lds
    s_add_u32 m0, s61, 0xf000
    s_add_u32 s60, s95, 0xc1800
    buffer_load_dwordx4 v3, s[52:55], s60 offen lds
    s_add_u32 m0, s61, 0x8000
    s_add_u32 s60, s58, 0x280
    buffer_load_dwordx4 v1, s[40:43], s60 offen lds
    s_add_u32 m0, s61, 0x9000
    s_add_u32 s60, s58, 0x8280
    buffer_load_dwordx4 v1, s[40:43], s60 offen lds
    s_add_u32 m0, s61, 0xa000
    s_add_u32 s60, s58, 0x10280
    buffer_load_dwordx4 v1, s[40:43], s60 offen lds
    s_add_u32 m0, s61, 0xb000
    s_add_u32 s60, s58, 0x18280
    buffer_load_dwordx4 v1, s[40:43], s60 offen lds
    s_waitcnt vmcnt(4)
    s_barrier
    s_add_u32 m0, s61, 0x10000
    s_add_u32 s60, s95, 0xd7000
    buffer_load_dwordx4 v3, s[48:51], s60 offen lds
    s_add_u32 m0, s61, 0x11000
    s_add_u32 s60, s95, 0xec800
    buffer_load_dwordx4 v3, s[48:51], s60 offen lds
    s_add_u32 m0, s61, 0x12000
    s_add_u32 s60, s95, 0xd7000
    buffer_load_dwordx4 v3, s[52:55], s60 offen lds
    s_add_u32 m0, s61, 0x13000
    s_add_u32 s60, s95, 0xec800
    buffer_load_dwordx4 v3, s[52:55], s60 offen lds
    s_add_u32 m0, s61, 0x0
    s_add_u32 s60, s58, 0x300
    buffer_load_dwordx4 v1, s[40:43], s60 offen lds
    s_add_u32 m0, s61, 0x1000
    s_add_u32 s60, s58, 0x8300
    buffer_load_dwordx4 v1, s[40:43], s60 offen lds
    s_add_u32 m0, s61, 0x2000
    s_add_u32 s60, s58, 0x10300
    buffer_load_dwordx4 v1, s[40:43], s60 offen lds
    s_add_u32 m0, s61, 0x3000
    s_add_u32 s60, s58, 0x18300
    buffer_load_dwordx4 v1, s[40:43], s60 offen lds
    s_waitcnt vmcnt(4)
    s_barrier
    s_add_u32 m0, s61, 0xc000
    s_add_u32 s60, s95, 0x102000
    buffer_load_dwordx4 v3, s[48:51], s60 offen lds
    s_add_u32 m0, s61, 0xd000
    s_add_u32 s60, s95, 0x117800
    buffer_load_dwordx4 v3, s[48:51], s60 offen lds
    s_add_u32 m0, s61, 0xe000
    s_add_u32 s60, s95, 0x102000
    buffer_load_dwordx4 v3, s[52:55], s60 offen lds
    s_add_u32 m0, s61, 0xf000
    s_add_u32 s60, s95, 0x117800
    buffer_load_dwordx4 v3, s[52:55], s60 offen lds
    s_add_u32 m0, s61, 0x4000
    s_add_u32 s60, s58, 0x380
    buffer_load_dwordx4 v1, s[40:43], s60 offen lds
    s_add_u32 m0, s61, 0x5000
    s_add_u32 s60, s58, 0x8380
    buffer_load_dwordx4 v1, s[40:43], s60 offen lds
    s_add_u32 m0, s61, 0x6000
    s_add_u32 s60, s58, 0x10380
    buffer_load_dwordx4 v1, s[40:43], s60 offen lds
    s_add_u32 m0, s61, 0x7000
    s_add_u32 s60, s58, 0x18380
    buffer_load_dwordx4 v1, s[40:43], s60 offen lds
    s_waitcnt vmcnt(4)
    s_barrier
    s_add_u32 m0, s61, 0x10000
    s_add_u32 s60, s95, 0x12d000
    buffer_load_dwordx4 v3, s[48:51], s60 offen lds
    s_add_u32 m0, s61, 0x11000
    s_add_u32 s60, s95, 0x142800
    buffer_load_dwordx4 v3, s[48:51], s60 offen lds
    s_add_u32 m0, s61, 0x12000
    s_add_u32 s60, s95, 0x12d000
    buffer_load_dwordx4 v3, s[52:55], s60 offen lds
    s_add_u32 m0, s61, 0x13000
    s_add_u32 s60, s95, 0x142800
    buffer_load_dwordx4 v3, s[52:55], s60 offen lds
    s_add_u32 m0, s61, 0x8000
    s_add_u32 s60, s58, 0x100
    buffer_load_dwordx4 v1, s[40:43], s60 offen lds
    s_add_u32 m0, s61, 0x9000
    s_add_u32 s60, s58, 0x8100
    buffer_load_dwordx4 v1, s[40:43], s60 offen lds
    s_add_u32 m0, s61, 0xa000
    s_add_u32 s60, s58, 0x10100
    buffer_load_dwordx4 v1, s[40:43], s60 offen lds
    s_add_u32 m0, s61, 0xb000
    s_add_u32 s60, s58, 0x18100
    buffer_load_dwordx4 v1, s[40:43], s60 offen lds
    s_waitcnt vmcnt(4)
    s_barrier
    s_add_u32 m0, s61, 0xc000
    s_add_u32 s60, s96, 0x0
    buffer_load_dwordx4 v3, s[48:51], s60 offen lds
    s_add_u32 m0, s61, 0xd000
    s_add_u32 s60, s96, 0x15800
    buffer_load_dwordx4 v3, s[48:51], s60 offen lds
    s_add_u32 m0, s61, 0xe000
    s_add_u32 s60, s96, 0x0
    buffer_load_dwordx4 v3, s[52:55], s60 offen lds
    s_add_u32 m0, s61, 0xf000
    s_add_u32 s60, s96, 0x15800
    buffer_load_dwordx4 v3, s[52:55], s60 offen lds
    s_add_u32 m0, s61, 0x0
    s_add_u32 s60, s58, 0x0
    buffer_load_dwordx4 v1, s[40:43], s60 offen lds
    s_add_u32 m0, s61, 0x1000
    s_add_u32 s60, s58, 0x8000
    buffer_load_dwordx4 v1, s[40:43], s60 offen lds
    s_add_u32 m0, s61, 0x2000
    s_add_u32 s60, s58, 0x10000
    buffer_load_dwordx4 v1, s[40:43], s60 offen lds
    s_add_u32 m0, s61, 0x3000
    s_add_u32 s60, s58, 0x18000
    buffer_load_dwordx4 v1, s[40:43], s60 offen lds
    s_waitcnt vmcnt(0)
    s_barrier
    s_add_u32 m0, s61, 0x10000
    s_add_u32 s60, s96, 0x2b000
    buffer_load_dwordx4 v3, s[48:51], s60 offen lds
    s_add_u32 m0, s61, 0x11000
    s_add_u32 s60, s96, 0x40800
    buffer_load_dwordx4 v3, s[48:51], s60 offen lds
    s_add_u32 m0, s61, 0x12000
    s_add_u32 s60, s96, 0x2b000
    buffer_load_dwordx4 v3, s[52:55], s60 offen lds
    s_add_u32 m0, s61, 0x13000
    s_add_u32 s60, s96, 0x40800
    buffer_load_dwordx4 v3, s[52:55], s60 offen lds
    s_add_u32 m0, s61, 0x4000
    s_add_u32 s60, s58, 0x80
    buffer_load_dwordx4 v1, s[40:43], s60 offen lds
    s_add_u32 m0, s61, 0x5000
    s_add_u32 s60, s58, 0x8080
    buffer_load_dwordx4 v1, s[40:43], s60 offen lds
    s_add_u32 m0, s61, 0x6000
    s_add_u32 s60, s58, 0x10080
    buffer_load_dwordx4 v1, s[40:43], s60 offen lds
    s_add_u32 m0, s61, 0x7000
    s_add_u32 s60, s58, 0x18080
    buffer_load_dwordx4 v1, s[40:43], s60 offen lds
    s_waitcnt vmcnt(0)
    s_barrier
    s_add_u32 m0, s61, 0xc000
    s_add_u32 s60, s96, 0x56000
    buffer_load_dwordx4 v3, s[48:51], s60 offen lds
    s_add_u32 m0, s61, 0xd000
    s_add_u32 s60, s96, 0x6b800
    buffer_load_dwordx4 v3, s[48:51], s60 offen lds
    s_add_u32 m0, s61, 0xe000
    s_add_u32 s60, s96, 0x56000
    buffer_load_dwordx4 v3, s[52:55], s60 offen lds
    s_add_u32 m0, s61, 0xf000
    s_add_u32 s60, s96, 0x6b800
    buffer_load_dwordx4 v3, s[52:55], s60 offen lds
    s_add_u32 m0, s61, 0x0
    s_add_u32 s60, s58, 0x180
    buffer_load_dwordx4 v1, s[40:43], s60 offen lds
    s_add_u32 m0, s61, 0x1000
    s_add_u32 s60, s58, 0x8180
    buffer_load_dwordx4 v1, s[40:43], s60 offen lds
    s_add_u32 m0, s61, 0x2000
    s_add_u32 s60, s58, 0x10180
    buffer_load_dwordx4 v1, s[40:43], s60 offen lds
    s_add_u32 m0, s61, 0x3000
    s_add_u32 s60, s58, 0x18180
    buffer_load_dwordx4 v1, s[40:43], s60 offen lds
    s_waitcnt vmcnt(4)
    s_barrier
    s_add_u32 m0, s61, 0x10000
    s_add_u32 s60, s96, 0x81000
    buffer_load_dwordx4 v3, s[48:51], s60 offen lds
    s_add_u32 m0, s61, 0x11000
    s_add_u32 s60, s96, 0x96800
    buffer_load_dwordx4 v3, s[48:51], s60 offen lds
    s_add_u32 m0, s61, 0x12000
    s_add_u32 s60, s96, 0x81000
    buffer_load_dwordx4 v3, s[52:55], s60 offen lds
    s_add_u32 m0, s61, 0x13000
    s_add_u32 s60, s96, 0x96800
    buffer_load_dwordx4 v3, s[52:55], s60 offen lds
    s_add_u32 m0, s61, 0x4000
    s_add_u32 s60, s58, 0x200
    buffer_load_dwordx4 v1, s[40:43], s60 offen lds
    s_add_u32 m0, s61, 0x5000
    s_add_u32 s60, s58, 0x8200
    buffer_load_dwordx4 v1, s[40:43], s60 offen lds
    s_add_u32 m0, s61, 0x6000
    s_add_u32 s60, s58, 0x10200
    buffer_load_dwordx4 v1, s[40:43], s60 offen lds
    s_add_u32 m0, s61, 0x7000
    s_add_u32 s60, s58, 0x18200
    buffer_load_dwordx4 v1, s[40:43], s60 offen lds
    s_waitcnt vmcnt(4)
    s_barrier
    s_add_u32 m0, s61, 0xc000
    s_add_u32 s60, s96, 0xac000
    buffer_load_dwordx4 v3, s[48:51], s60 offen lds
    s_add_u32 m0, s61, 0xd000
    s_add_u32 s60, s96, 0xc1800
    buffer_load_dwordx4 v3, s[48:51], s60 offen lds
    s_add_u32 m0, s61, 0xe000
    s_add_u32 s60, s96, 0xac000
    buffer_load_dwordx4 v3, s[52:55], s60 offen lds
    s_add_u32 m0, s61, 0xf000
    s_add_u32 s60, s96, 0xc1800
    buffer_load_dwordx4 v3, s[52:55], s60 offen lds
    s_add_u32 m0, s61, 0x8000
    s_add_u32 s60, s58, 0x280
    buffer_load_dwordx4 v1, s[40:43], s60 offen lds
    s_add_u32 m0, s61, 0x9000
    s_add_u32 s60, s58, 0x8280
    buffer_load_dwordx4 v1, s[40:43], s60 offen lds
    s_add_u32 m0, s61, 0xa000
    s_add_u32 s60, s58, 0x10280
    buffer_load_dwordx4 v1, s[40:43], s60 offen lds
    s_add_u32 m0, s61, 0xb000
    s_add_u32 s60, s58, 0x18280
    buffer_load_dwordx4 v1, s[40:43], s60 offen lds
    s_waitcnt vmcnt(4)
    s_barrier
    s_add_u32 m0, s61, 0x10000
    s_add_u32 s60, s96, 0xd7000
    buffer_load_dwordx4 v3, s[48:51], s60 offen lds
    s_add_u32 m0, s61, 0x11000
    s_add_u32 s60, s96, 0xec800
    buffer_load_dwordx4 v3, s[48:51], s60 offen lds
    s_add_u32 m0, s61, 0x12000
    s_add_u32 s60, s96, 0xd7000
    buffer_load_dwordx4 v3, s[52:55], s60 offen lds
    s_add_u32 m0, s61, 0x13000
    s_add_u32 s60, s96, 0xec800
    buffer_load_dwordx4 v3, s[52:55], s60 offen lds
    s_add_u32 m0, s61, 0x0
    s_add_u32 s60, s58, 0x300
    buffer_load_dwordx4 v1, s[40:43], s60 offen lds
    s_add_u32 m0, s61, 0x1000
    s_add_u32 s60, s58, 0x8300
    buffer_load_dwordx4 v1, s[40:43], s60 offen lds
    s_add_u32 m0, s61, 0x2000
    s_add_u32 s60, s58, 0x10300
    buffer_load_dwordx4 v1, s[40:43], s60 offen lds
    s_add_u32 m0, s61, 0x3000
    s_add_u32 s60, s58, 0x18300
    buffer_load_dwordx4 v1, s[40:43], s60 offen lds
    s_waitcnt vmcnt(4)
    s_barrier
    s_add_u32 m0, s61, 0xc000
    s_add_u32 s60, s96, 0x102000
    buffer_load_dwordx4 v3, s[48:51], s60 offen lds
    s_add_u32 m0, s61, 0xd000
    s_add_u32 s60, s96, 0x117800
    buffer_load_dwordx4 v3, s[48:51], s60 offen lds
    s_add_u32 m0, s61, 0xe000
    s_add_u32 s60, s96, 0x102000
    buffer_load_dwordx4 v3, s[52:55], s60 offen lds
    s_add_u32 m0, s61, 0xf000
    s_add_u32 s60, s96, 0x117800
    buffer_load_dwordx4 v3, s[52:55], s60 offen lds
    s_add_u32 m0, s61, 0x4000
    s_add_u32 s60, s58, 0x380
    buffer_load_dwordx4 v1, s[40:43], s60 offen lds
    s_add_u32 m0, s61, 0x5000
    s_add_u32 s60, s58, 0x8380
    buffer_load_dwordx4 v1, s[40:43], s60 offen lds
    s_add_u32 m0, s61, 0x6000
    s_add_u32 s60, s58, 0x10380
    buffer_load_dwordx4 v1, s[40:43], s60 offen lds
    s_add_u32 m0, s61, 0x7000
    s_add_u32 s60, s58, 0x18380
    buffer_load_dwordx4 v1, s[40:43], s60 offen lds
    s_waitcnt vmcnt(4)
    s_barrier
    s_add_u32 m0, s61, 0x10000
    s_add_u32 s60, s96, 0x12d000
    buffer_load_dwordx4 v3, s[48:51], s60 offen lds
    s_add_u32 m0, s61, 0x11000
    s_add_u32 s60, s96, 0x142800
    buffer_load_dwordx4 v3, s[48:51], s60 offen lds
    s_add_u32 m0, s61, 0x12000
    s_add_u32 s60, s96, 0x12d000
    buffer_load_dwordx4 v3, s[52:55], s60 offen lds
    s_add_u32 m0, s61, 0x13000
    s_add_u32 s60, s96, 0x142800
    buffer_load_dwordx4 v3, s[52:55], s60 offen lds
    s_add_u32 m0, s61, 0x8000
    s_add_u32 s60, s99, 0x100
    buffer_load_dwordx4 v1, s[40:43], s60 offen lds
    s_add_u32 m0, s61, 0x9000
    s_add_u32 s60, s99, 0x8100
    buffer_load_dwordx4 v1, s[40:43], s60 offen lds
    s_waitcnt vmcnt(2)
    s_barrier
    s_add_u32 m0, s61, 0xc000
    s_add_u32 s60, s100, 0x0
    buffer_load_dwordx4 v3, s[48:51], s60 offen lds
    s_add_u32 m0, s61, 0xd000
    s_add_u32 s60, s100, 0x15800
    buffer_load_dwordx4 v3, s[48:51], s60 offen lds
    s_add_u32 m0, s61, 0xe000
    s_add_u32 s60, s100, 0x0
    buffer_load_dwordx4 v3, s[52:55], s60 offen lds
    s_add_u32 m0, s61, 0xf000
    s_add_u32 s60, s100, 0x15800
    buffer_load_dwordx4 v3, s[52:55], s60 offen lds
    s_add_u32 m0, s61, 0x0
    s_add_u32 s60, s99, 0x0
    buffer_load_dwordx4 v1, s[40:43], s60 offen lds
    s_add_u32 m0, s61, 0x1000
    s_add_u32 s60, s99, 0x8000
    buffer_load_dwordx4 v1, s[40:43], s60 offen lds
    s_waitcnt vmcnt(0)
    s_barrier
    s_add_u32 m0, s61, 0x10000
    s_add_u32 s60, s100, 0x2b000
    buffer_load_dwordx4 v3, s[48:51], s60 offen lds
    s_add_u32 m0, s61, 0x11000
    s_add_u32 s60, s100, 0x40800
    buffer_load_dwordx4 v3, s[48:51], s60 offen lds
    s_add_u32 m0, s61, 0x12000
    s_add_u32 s60, s100, 0x2b000
    buffer_load_dwordx4 v3, s[52:55], s60 offen lds
    s_add_u32 m0, s61, 0x13000
    s_add_u32 s60, s100, 0x40800
    buffer_load_dwordx4 v3, s[52:55], s60 offen lds
    s_add_u32 m0, s61, 0x4000
    s_add_u32 s60, s99, 0x80
    buffer_load_dwordx4 v1, s[40:43], s60 offen lds
    s_add_u32 m0, s61, 0x5000
    s_add_u32 s60, s99, 0x8080
    buffer_load_dwordx4 v1, s[40:43], s60 offen lds
    s_waitcnt vmcnt(0)
    s_barrier
    s_add_u32 m0, s61, 0xc000
    s_add_u32 s60, s100, 0x56000
    buffer_load_dwordx4 v3, s[48:51], s60 offen lds
    s_add_u32 m0, s61, 0xd000
    s_add_u32 s60, s100, 0x6b800
    buffer_load_dwordx4 v3, s[48:51], s60 offen lds
    s_add_u32 m0, s61, 0xe000
    s_add_u32 s60, s100, 0x56000
    buffer_load_dwordx4 v3, s[52:55], s60 offen lds
    s_add_u32 m0, s61, 0xf000
    s_add_u32 s60, s100, 0x6b800
    buffer_load_dwordx4 v3, s[52:55], s60 offen lds
    s_add_u32 m0, s61, 0x0
    s_add_u32 s60, s99, 0x180
    buffer_load_dwordx4 v1, s[40:43], s60 offen lds
    s_add_u32 m0, s61, 0x1000
    s_add_u32 s60, s99, 0x8180
    buffer_load_dwordx4 v1, s[40:43], s60 offen lds
    s_waitcnt vmcnt(2)
    s_barrier
    s_add_u32 m0, s61, 0x10000
    s_add_u32 s60, s100, 0x81000
    buffer_load_dwordx4 v3, s[48:51], s60 offen lds
    s_add_u32 m0, s61, 0x11000
    s_add_u32 s60, s100, 0x96800
    buffer_load_dwordx4 v3, s[48:51], s60 offen lds
    s_add_u32 m0, s61, 0x12000
    s_add_u32 s60, s100, 0x81000
    buffer_load_dwordx4 v3, s[52:55], s60 offen lds
    s_add_u32 m0, s61, 0x13000
    s_add_u32 s60, s100, 0x96800
    buffer_load_dwordx4 v3, s[52:55], s60 offen lds
    s_add_u32 m0, s61, 0x4000
    s_add_u32 s60, s99, 0x200
    buffer_load_dwordx4 v1, s[40:43], s60 offen lds
    s_add_u32 m0, s61, 0x5000
    s_add_u32 s60, s99, 0x8200
    buffer_load_dwordx4 v1, s[40:43], s60 offen lds
    s_waitcnt vmcnt(2)
    s_barrier
    s_add_u32 m0, s61, 0xc000
    s_add_u32 s60, s100, 0xac000
    buffer_load_dwordx4 v3, s[48:51], s60 offen lds
    s_add_u32 m0, s61, 0xd000
    s_add_u32 s60, s100, 0xc1800
    buffer_load_dwordx4 v3, s[48:51], s60 offen lds
    s_add_u32 m0, s61, 0xe000
    s_add_u32 s60, s100, 0xac000
    buffer_load_dwordx4 v3, s[52:55], s60 offen lds
    s_add_u32 m0, s61, 0xf000
    s_add_u32 s60, s100, 0xc1800
    buffer_load_dwordx4 v3, s[52:55], s60 offen lds
    s_add_u32 m0, s61, 0x8000
    s_add_u32 s60, s99, 0x280
    buffer_load_dwordx4 v1, s[40:43], s60 offen lds
    s_add_u32 m0, s61, 0x9000
    s_add_u32 s60, s99, 0x8280
    buffer_load_dwordx4 v1, s[40:43], s60 offen lds
    s_waitcnt vmcnt(2)
    s_barrier
    s_add_u32 m0, s61, 0x10000
    s_add_u32 s60, s100, 0xd7000
    buffer_load_dwordx4 v3, s[48:51], s60 offen lds
    s_add_u32 m0, s61, 0x11000
    s_add_u32 s60, s100, 0xec800
    buffer_load_dwordx4 v3, s[48:51], s60 offen lds
    s_add_u32 m0, s61, 0x12000
    s_add_u32 s60, s100, 0xd7000
    buffer_load_dwordx4 v3, s[52:55], s60 offen lds
    s_add_u32 m0, s61, 0x13000
    s_add_u32 s60, s100, 0xec800
    buffer_load_dwordx4 v3, s[52:55], s60 offen lds
    s_add_u32 m0, s61, 0x0
    s_add_u32 s60, s99, 0x300
    buffer_load_dwordx4 v1, s[40:43], s60 offen lds
    s_add_u32 m0, s61, 0x1000
    s_add_u32 s60, s99, 0x8300
    buffer_load_dwordx4 v1, s[40:43], s60 offen lds
    s_waitcnt vmcnt(2)
    s_barrier
    s_add_u32 m0, s61, 0xc000
    s_add_u32 s60, s100, 0x102000
    buffer_load_dwordx4 v3, s[48:51], s60 offen lds
    s_add_u32 m0, s61, 0xd000
    s_add_u32 s60, s100, 0x117800
    buffer_load_dwordx4 v3, s[48:51], s60 offen lds
    s_add_u32 m0, s61, 0xe000
    s_add_u32 s60, s100, 0x102000
    buffer_load_dwordx4 v3, s[52:55], s60 offen lds
    s_add_u32 m0, s61, 0xf000
    s_add_u32 s60, s100, 0x117800
    buffer_load_dwordx4 v3, s[52:55], s60 offen lds
    s_add_u32 m0, s61, 0x4000
    s_add_u32 s60, s99, 0x380
    buffer_load_dwordx4 v1, s[40:43], s60 offen lds
    s_add_u32 m0, s61, 0x5000
    s_add_u32 s60, s99, 0x8380
    buffer_load_dwordx4 v1, s[40:43], s60 offen lds
    s_waitcnt vmcnt(2)
    s_barrier
    s_add_u32 m0, s61, 0x10000
    s_add_u32 s60, s100, 0x12d000
    buffer_load_dwordx4 v3, s[48:51], s60 offen lds
    s_add_u32 m0, s61, 0x11000
    s_add_u32 s60, s100, 0x142800
    buffer_load_dwordx4 v3, s[48:51], s60 offen lds
    s_add_u32 m0, s61, 0x12000
    s_add_u32 s60, s100, 0x12d000
    buffer_load_dwordx4 v3, s[52:55], s60 offen lds
    s_add_u32 m0, s61, 0x13000
    s_add_u32 s60, s100, 0x142800
    buffer_load_dwordx4 v3, s[52:55], s60 offen lds
    s_waitcnt vmcnt(0)
    s_barrier
    s_barrier
    s_branch fr_pub
fr_compute:
    s_lshr_b32 s56, s3, 1
    s_and_b32 s57, s3, 1
    v_and_b32 v58, 31, v0
    v_bfe_u32 v59, v0, 1, 3
    v_lshrrev_b32 v3, 5, v0
    v_xor_b32 v59, v59, v3
    v_lshlrev_b32 v59, 4, v59
    v_lshlrev_b32 v58, 7, v58
    v_add_u32 v58, v58, v59
    s_lshl_b32 s60, s56, 13
    v_add_u32 v3, s60, v58
    v_xor_b32 v4, 32, v3
    v_xor_b32 v5, 64, v3
    v_xor_b32 v6, 96, v3
    s_lshl_b32 s64, s57, 1
    v_bfe_u32 v58, v0, 2, 2
    v_lshrrev_b32 v59, 5, v0
    v_lshlrev_b32 v59, 3, v59
    v_add_u32 v59, v59, v58
    v_lshlrev_b32 v59, 8, v59
    v_xor_b32 v58, s64, v58
    v_lshlrev_b32 v58, 6, v58
    v_add_u32 v59, v59, v58
    v_bfe_u32 v58, v0, 4, 1
    v_lshlrev_b32 v58, 5, v58
    v_and_b32 v10, 3, v0
    v_lshlrev_b32 v10, 3, v10
    v_add3_u32 v59, v59, v58, v10
    v_add_u32 v7, 0xc000, v59
    v_xor_b32 v8, 64, v7
    v_lshrrev_b32 v58, 5, v0
    v_lshlrev_b32 v58, 3, v58
    v_bfe_u32 v59, v0, 2, 2
    v_add_u32 v58, v58, v59
    v_lshlrev_b32 v58, 7, v58
    v_bfe_u32 v59, v0, 3, 1
    v_xor_b32 v59, s57, v59
    v_lshlrev_b32 v59, 6, v59
    v_add_u32 v58, v58, v59
    v_bfe_u32 v59, v0, 4, 1
    v_lshlrev_b32 v59, 5, v59
    v_and_b32 v10, 3, v0
    v_lshlrev_b32 v10, 3, v10
    v_add3_u32 v58, v58, v59, v10
    v_add_u32 v9, 49152, v58
    s_waitcnt lgkmcnt(0)
    s_add_u32 s6, s36, 0xe2e000
    s_addc_u32 s7, s37, 0
    s_load_dword s91, s[6:7], 0
    s_mov_b32 s48, s36
    s_mov_b32 s49, s37
    s_mov_b32 s50, 0x1000000
    s_mov_b32 s51, 0x20000
    v_and_b32 v10, 7, v0
    v_mov_b32 v11, 0
    v_cmp_eq_u32 vcc, 1, v10
    v_mov_b32 v12, 0x201000
    s_nop 0
    v_cndmask_b32 v11, v11, v12, vcc
    v_cmp_eq_u32 vcc, 2, v10
    v_mov_b32 v12, 0x402000
    s_nop 0
    v_cndmask_b32 v11, v11, v12, vcc
    v_cmp_eq_u32 vcc, 3, v10
    v_mov_b32 v12, 0x603000
    s_nop 0
    v_cndmask_b32 v11, v11, v12, vcc
    v_cmp_eq_u32 vcc, 4, v10
    v_mov_b32 v12, 0x804000
    s_nop 0
    v_cndmask_b32 v11, v11, v12, vcc
    v_cmp_eq_u32 vcc, 5, v10
    v_mov_b32 v12, 0xa3a000
    s_nop 0
    v_cndmask_b32 v11, v11, v12, vcc
    v_cmp_eq_u32 vcc, 6, v10
    v_mov_b32 v12, 0xc50000
    s_nop 0
    v_cndmask_b32 v11, v11, v12, vcc
    v_cmp_eq_u32 vcc, 7, v10
    v_mov_b32 v12, 0xe80000
    s_nop 0
    v_cndmask_b32 v11, v11, v12, vcc
    s_mov_b32 s48, s36
    s_mov_b32 s49, s37
    s_mov_b32 s50, 0x1000000
    s_mov_b32 s51, 0x20000
    s_mov_b64 exec, 0xff
    buffer_load_dword v2, v11, s[48:51], 0 offen
    s_mov_b64 exec, -1
    s_cmp_ge_u32 s2, 192
    s_cbranch_scc1 fr_gstart
    s_lshl_b32 s94, s39, 4
    s_add_u32 s94, s94, s38
    s_lshl_b32 s94, s94, 7
    s_add_u32 s94, s94, 0xe00000
    s_mov_b32 s93, 1
    s_barrier
    ds_read_b128 v[10:13], v3 offset:0
    ds_read_b128 v[14:17], v3 offset:4096
    ds_read_b64_tr_b16 v[18:19], v7 offset:0
    ds_read_b64_tr_b16 v[20:21], v7 offset:1024
    ds_read_b64_tr_b16 v[22:23], v8 offset:0
    ds_read_b64_tr_b16 v[24:25], v8 offset:1024
    ds_read_b128 v[26:29], v4 offset:0
    ds_read_b128 v[30:33], v4 offset:4096
    ds_read_b64_tr_b16 v[34:35], v7 offset:4096
    ds_read_b64_tr_b16 v[36:37], v7 offset:5120
    ds_read_b64_tr_b16 v[38:39], v8 offset:4096
    ds_read_b64_tr_b16 v[40:41], v8 offset:5120
    s_cmp_ge_u32 s39, 8
    s_cbranch_scc1 fr_v
    s_waitcnt lgkmcnt(6)
    v_mfma_f32_32x32x16_bf16 v[60:75], v[18:21], v[10:13], 0
    ds_read_b128 v[42:45], v5 offset:0
    ds_read_b128 v[46:49], v5 offset:4096
    v_mfma_f32_32x32x16_bf16 v[76:91], v[22:25], v[10:13], 0
    ds_read_b64_tr_b16 v[50:51], v7 offset:8192
    ds_read_b64_tr_b16 v[52:53], v7 offset:9216
    v_mfma_f32_32x32x16_bf16 v[92:107], v[18:21], v[14:17], 0
    ds_read_b64_tr_b16 v[54:55], v8 offset:8192
    v_mfma_f32_32x32x16_bf16 v[108:123], v[22:25], v[14:17], 0
    ds_read_b64_tr_b16 v[56:57], v8 offset:9216
    s_waitcnt lgkmcnt(6)
    v_mfma_f32_32x32x16_bf16 v[60:75], v[34:37], v[26:29], v[60:75]
    ds_read_b128 v[10:13], v6 offset:0
    ds_read_b128 v[14:17], v6 offset:4096
    v_mfma_f32_32x32x16_bf16 v[76:91], v[38:41], v[26:29], v[76:91]
    ds_read_b64_tr_b16 v[18:19], v7 offset:12288
    ds_read_b64_tr_b16 v[20:21], v7 offset:13312
    v_mfma_f32_32x32x16_bf16 v[92:107], v[34:37], v[30:33], v[92:107]
    ds_read_b64_tr_b16 v[22:23], v8 offset:12288
    v_mfma_f32_32x32x16_bf16 v[108:123], v[38:41], v[30:33], v[108:123]
    ds_read_b64_tr_b16 v[24:25], v8 offset:13312
    s_waitcnt lgkmcnt(0)
    s_barrier
    v_mfma_f32_32x32x16_bf16 v[60:75], v[50:53], v[42:45], v[60:75]
    ds_read_b128 v[26:29], v3 offset:16384
    ds_read_b128 v[30:33], v3 offset:20480
    v_mfma_f32_32x32x16_bf16 v[76:91], v[54:57], v[42:45], v[76:91]
    ds_read_b64_tr_b16 v[34:35], v7 offset:16384
    ds_read_b64_tr_b16 v[36:37], v7 offset:17408
    v_mfma_f32_32x32x16_bf16 v[92:107], v[50:53], v[46:49], v[92:107]
    ds_read_b64_tr_b16 v[38:39], v8 offset:16384
    v_mfma_f32_32x32x16_bf16 v[108:123], v[54:57], v[46:49], v[108:123]
    ds_read_b64_tr_b16 v[40:41], v8 offset:17408
    v_mfma_f32_32x32x16_bf16 v[60:75], v[18:21], v[10:13], v[60:75]
    ds_read_b128 v[42:45], v4 offset:16384
    ds_read_b128 v[46:49], v4 offset:20480
    v_mfma_f32_32x32x16_bf16 v[76:91], v[22:25], v[10:13], v[76:91]
    ds_read_b64_tr_b16 v[50:51], v7 offset:20480
    ds_read_b64_tr_b16 v[52:53], v7 offset:21504
    v_mfma_f32_32x32x16_bf16 v[92:107], v[18:21], v[14:17], v[92:107]
    ds_read_b64_tr_b16 v[54:55], v8 offset:20480
    v_mfma_f32_32x32x16_bf16 v[108:123], v[22:25], v[14:17], v[108:123]
    ds_read_b64_tr_b16 v[56:57], v8 offset:21504
    s_waitcnt lgkmcnt(6)
    v_mfma_f32_32x32x16_bf16 v[60:75], v[34:37], v[26:29], v[60:75]
    ds_read_b128 v[10:13], v5 offset:16384
    ds_read_b128 v[14:17], v5 offset:20480
    v_mfma_f32_32x32x16_bf16 v[76:91], v[38:41], v[26:29], v[76:91]
    ds_read_b64_tr_b16 v[18:19], v7 offset:24576
    ds_read_b64_tr_b16 v[20:21], v7 offset:25600
    v_mfma_f32_32x32x16_bf16 v[92:107], v[34:37], v[30:33], v[92:107]
    ds_read_b64_tr_b16 v[22:23], v8 offset:24576
    v_mfma_f32_32x32x16_bf16 v[108:123], v[38:41], v[30:33], v[108:123]
    ds_read_b64_tr_b16 v[24:25], v8 offset:25600
    s_waitcnt lgkmcnt(6)
    v_mfma_f32_32x32x16_bf16 v[60:75], v[50:53], v[42:45], v[60:75]
    ds_read_b128 v[26:29], v6 offset:16384
    ds_read_b128 v[30:33], v6 offset:20480
    v_mfma_f32_32x32x16_bf16 v[76:91], v[54:57], v[42:45], v[76:91]
    ds_read_b64_tr_b16 v[34:35], v7 offset:28672
    ds_read_b64_tr_b16 v[36:37], v7 offset:29696
    v_mfma_f32_32x32x16_bf16 v[92:107], v[50:53], v[46:49], v[92:107]
    ds_read_b64_tr_b16 v[38:39], v8 offset:28672
    v_mfma_f32_32x32x16_bf16 v[108:123], v[54:57], v[46:49], v[108:123]
    ds_read_b64_tr_b16 v[40:41], v8 offset:29696
    s_waitcnt lgkmcnt(0)
    s_barrier
    v_mfma_f32_32x32x16_bf16 v[60:75], v[18:21], v[10:13], v[60:75]
    ds_read_b128 v[42:45], v3 offset:32768
    ds_read_b128 v[46:49], v3 offset:36864
    v_mfma_f32_32x32x16_bf16 v[76:91], v[22:25], v[10:13], v[76:91]
    ds_read_b64_tr_b16 v[50:51], v7 offset:0
    ds_read_b64_tr_b16 v[52:53], v7 offset:1024
    v_mfma_f32_32x32x16_bf16 v[92:107], v[18:21], v[14:17], v[92:107]
    ds_read_b64_tr_b16 v[54:55], v8 offset:0
    v_mfma_f32_32x32x16_bf16 v[108:123], v[22:25], v[14:17], v[108:123]
    ds_read_b64_tr_b16 v[56:57], v8 offset:1024
    v_mfma_f32_32x32x16_bf16 v[60:75], v[34:37], v[26:29], v[60:75]
    ds_read_b128 v[10:13], v4 offset:32768
    ds_read_b128 v[14:17], v4 offset:36864
    v_mfma_f32_32x32x16_bf16 v[76:91], v[38:41], v[26:29], v[76:91]
    ds_read_b64_tr_b16 v[18:19], v7 offset:4096
    ds_read_b64_tr_b16 v[20:21], v7 offset:5120
    v_mfma_f32_32x32x16_bf16 v[92:107], v[34:37], v[30:33], v[92:107]
    ds_read_b64_tr_b16 v[22:23], v8 offset:4096
    v_mfma_f32_32x32x16_bf16 v[108:123], v[38:41], v[30:33], v[108:123]
    ds_read_b64_tr_b16 v[24:25], v8 offset:5120
    s_waitcnt lgkmcnt(6)
    v_mfma_f32_32x32x16_bf16 v[60:75], v[50:53], v[42:45], v[60:75]
    ds_read_b128 v[26:29], v5 offset:32768
    ds_read_b128 v[30:33], v5 offset:36864
    v_mfma_f32_32x32x16_bf16 v[76:91], v[54:57], v[42:45], v[76:91]
    ds_read_b64_tr_b16 v[34:35], v7 offset:8192
    ds_read_b64_tr_b16 v[36:37], v7 offset:9216
    v_mfma_f32_32x32x16_bf16 v[92:107], v[50:53], v[46:49], v[92:107]
    ds_read_b64_tr_b16 v[38:39], v8 offset:8192
    v_mfma_f32_32x32x16_bf16 v[108:123], v[54:57], v[46:49], v[108:123]
    ds_read_b64_tr_b16 v[40:41], v8 offset:9216
    s_waitcnt lgkmcnt(6)
    v_mfma_f32_32x32x16_bf16 v[60:75], v[18:21], v[10:13], v[60:75]
    ds_read_b128 v[42:45], v6 offset:32768
    ds_read_b128 v[46:49], v6 offset:36864
    v_mfma_f32_32x32x16_bf16 v[76:91], v[22:25], v[10:13], v[76:91]
    ds_read_b64_tr_b16 v[50:51], v7 offset:12288
    ds_read_b64_tr_b16 v[52:53], v7 offset:13312
    v_mfma_f32_32x32x16_bf16 v[92:107], v[18:21], v[14:17], v[92:107]
    ds_read_b64_tr_b16 v[54:55], v8 offset:12288
    v_mfma_f32_32x32x16_bf16 v[108:123], v[22:25], v[14:17], v[108:123]
    ds_read_b64_tr_b16 v[56:57], v8 offset:13312
    s_waitcnt lgkmcnt(0)
    s_barrier
    v_mfma_f32_32x32x16_bf16 v[60:75], v[34:37], v[26:29], v[60:75]
    ds_read_b128 v[10:13], v3 offset:0
    ds_read_b128 v[14:17], v3 offset:4096
    v_mfma_f32_32x32x16_bf16 v[76:91], v[38:41], v[26:29], v[76:91]
    ds_read_b64_tr_b16 v[18:19], v7 offset:16384
    ds_read_b64_tr_b16 v[20:21], v7 offset:17408
    v_mfma_f32_32x32x16_bf16 v[92:107], v[34:37], v[30:33], v[92:107]
    ds_read_b64_tr_b16 v[22:23], v8 offset:16384
    v_mfma_f32_32x32x16_bf16 v[108:123], v[38:41], v[30:33], v[108:123]
    ds_read_b64_tr_b16 v[24:25], v8 offset:17408
    v_mfma_f32_32x32x16_bf16 v[60:75], v[50:53], v[42:45], v[60:75]
    ds_read_b128 v[26:29], v4 offset:0
    ds_read_b128 v[30:33], v4 offset:4096
    v_mfma_f32_32x32x16_bf16 v[76:91], v[54:57], v[42:45], v[76:91]
    ds_read_b64_tr_b16 v[34:35], v7 offset:20480
    ds_read_b64_tr_b16 v[36:37], v7 offset:21504
    v_mfma_f32_32x32x16_bf16 v[92:107], v[50:53], v[46:49], v[92:107]
    ds_read_b64_tr_b16 v[38:39], v8 offset:20480
    v_mfma_f32_32x32x16_bf16 v[108:123], v[54:57], v[46:49], v[108:123]
    ds_read_b64_tr_b16 v[40:41], v8 offset:21504
    s_waitcnt lgkmcnt(6)
    v_mfma_f32_32x32x16_bf16 v[60:75], v[18:21], v[10:13], v[60:75]
    ds_read_b128 v[42:45], v5 offset:0
    ds_read_b128 v[46:49], v5 offset:4096
    v_mfma_f32_32x32x16_bf16 v[76:91], v[22:25], v[10:13], v[76:91]
    ds_read_b64_tr_b16 v[50:51], v7 offset:24576
    ds_read_b64_tr_b16 v[52:53], v7 offset:25600
    v_mfma_f32_32x32x16_bf16 v[92:107], v[18:21], v[14:17], v[92:107]
    ds_read_b64_tr_b16 v[54:55], v8 offset:24576
    v_mfma_f32_32x32x16_bf16 v[108:123], v[22:25], v[14:17], v[108:123]
    ds_read_b64_tr_b16 v[56:57], v8 offset:25600
    s_waitcnt lgkmcnt(6)
    v_mfma_f32_32x32x16_bf16 v[60:75], v[34:37], v[26:29], v[60:75]
    ds_read_b128 v[10:13], v6 offset:0
    ds_read_b128 v[14:17], v6 offset:4096
    v_mfma_f32_32x32x16_bf16 v[76:91], v[38:41], v[26:29], v[76:91]
    ds_read_b64_tr_b16 v[18:19], v7 offset:28672
    ds_read_b64_tr_b16 v[20:21], v7 offset:29696
    v_mfma_f32_32x32x16_bf16 v[92:107], v[34:37], v[30:33], v[92:107]
    ds_read_b64_tr_b16 v[22:23], v8 offset:28672
    v_mfma_f32_32x32x16_bf16 v[108:123], v[38:41], v[30:33], v[108:123]
    ds_read_b64_tr_b16 v[24:25], v8 offset:29696
    s_waitcnt lgkmcnt(0)
    s_barrier
    v_mfma_f32_32x32x16_bf16 v[60:75], v[50:53], v[42:45], v[60:75]
    ds_read_b128 v[26:29], v3 offset:16384
    ds_read_b128 v[30:33], v3 offset:20480
    v_mfma_f32_32x32x16_bf16 v[76:91], v[54:57], v[42:45], v[76:91]
    ds_read_b64_tr_b16 v[34:35], v7 offset:0
    ds_read_b64_tr_b16 v[36:37], v7 offset:1024
    v_mfma_f32_32x32x16_bf16 v[92:107], v[50:53], v[46:49], v[92:107]
    ds_read_b64_tr_b16 v[38:39], v8 offset:0
    v_mfma_f32_32x32x16_bf16 v[108:123], v[54:57], v[46:49], v[108:123]
    ds_read_b64_tr_b16 v[40:41], v8 offset:1024
    v_mfma_f32_32x32x16_bf16 v[60:75], v[18:21], v[10:13], v[60:75]
    ds_read_b128 v[42:45], v4 offset:16384
    ds_read_b128 v[46:49], v4 offset:20480
    v_mfma_f32_32x32x16_bf16 v[76:91], v[22:25], v[10:13], v[76:91]
    ds_read_b64_tr_b16 v[50:51], v7 offset:4096
    ds_read_b64_tr_b16 v[52:53], v7 offset:5120
    v_mfma_f32_32x32x16_bf16 v[92:107], v[18:21], v[14:17], v[92:107]
    ds_read_b64_tr_b16 v[54:55], v8 offset:4096
    v_mfma_f32_32x32x16_bf16 v[108:123], v[22:25], v[14:17], v[108:123]
    ds_read_b64_tr_b16 v[56:57], v8 offset:5120
    s_waitcnt lgkmcnt(6)
    v_mfma_f32_32x32x16_bf16 v[60:75], v[34:37], v[26:29], v[60:75]
    ds_read_b128 v[10:13], v5 offset:16384
    ds_read_b128 v[14:17], v5 offset:20480
    v_mfma_f32_32x32x16_bf16 v[76:91], v[38:41], v[26:29], v[76:91]
    ds_read_b64_tr_b16 v[18:19], v7 offset:8192
    ds_read_b64_tr_b16 v[20:21], v7 offset:9216
    v_mfma_f32_32x32x16_bf16 v[92:107], v[34:37], v[30:33], v[92:107]
    ds_read_b64_tr_b16 v[22:23], v8 offset:8192
    v_mfma_f32_32x32x16_bf16 v[108:123], v[38:41], v[30:33], v[108:123]
    ds_read_b64_tr_b16 v[24:25], v8 offset:9216
    s_waitcnt lgkmcnt(6)
    v_mfma_f32_32x32x16_bf16 v[60:75], v[50:53], v[42:45], v[60:75]
    ds_read_b128 v[26:29], v6 offset:16384
    ds_read_b128 v[30:33], v6 offset:20480
    v_mfma_f32_32x32x16_bf16 v[76:91], v[54:57], v[42:45], v[76:91]
    ds_read_b64_tr_b16 v[34:35], v7 offset:12288
    ds_read_b64_tr_b16 v[36:37], v7 offset:13312
    v_mfma_f32_32x32x16_bf16 v[92:107], v[50:53], v[46:49], v[92:107]
    ds_read_b64_tr_b16 v[38:39], v8 offset:12288
    v_mfma_f32_32x32x16_bf16 v[108:123], v[54:57], v[46:49], v[108:123]
    ds_read_b64_tr_b16 v[40:41], v8 offset:13312
    s_waitcnt lgkmcnt(0)
    s_barrier
    v_mfma_f32_32x32x16_bf16 v[60:75], v[18:21], v[10:13], v[60:75]
    ds_read_b128 v[42:45], v3 offset:32768
    ds_read_b128 v[46:49], v3 offset:36864
    v_mfma_f32_32x32x16_bf16 v[76:91], v[22:25], v[10:13], v[76:91]
    ds_read_b64_tr_b16 v[50:51], v7 offset:16384
    ds_read_b64_tr_b16 v[52:53], v7 offset:17408
    v_mfma_f32_32x32x16_bf16 v[92:107], v[18:21], v[14:17], v[92:107]
    ds_read_b64_tr_b16 v[54:55], v8 offset:16384
    v_mfma_f32_32x32x16_bf16 v[108:123], v[22:25], v[14:17], v[108:123]
    ds_read_b64_tr_b16 v[56:57], v8 offset:17408
    v_mfma_f32_32x32x16_bf16 v[60:75], v[34:37], v[26:29], v[60:75]
    ds_read_b128 v[10:13], v4 offset:32768
    ds_read_b128 v[14:17], v4 offset:36864
    v_mfma_f32_32x32x16_bf16 v[76:91], v[38:41], v[26:29], v[76:91]
    ds_read_b64_tr_b16 v[18:19], v7 offset:20480
    ds_read_b64_tr_b16 v[20:21], v7 offset:21504
    v_mfma_f32_32x32x16_bf16 v[92:107], v[34:37], v[30:33], v[92:107]
    ds_read_b64_tr_b16 v[22:23], v8 offset:20480
    v_mfma_f32_32x32x16_bf16 v[108:123], v[38:41], v[30:33], v[108:123]
    ds_read_b64_tr_b16 v[24:25], v8 offset:21504
    s_waitcnt lgkmcnt(6)
    v_mfma_f32_32x32x16_bf16 v[60:75], v[50:53], v[42:45], v[60:75]
    ds_read_b128 v[26:29], v5 offset:32768
    ds_read_b128 v[30:33], v5 offset:36864
    v_mfma_f32_32x32x16_bf16 v[76:91], v[54:57], v[42:45], v[76:91]
    ds_read_b64_tr_b16 v[34:35], v7 offset:24576
    ds_read_b64_tr_b16 v[36:37], v7 offset:25600
    v_mfma_f32_32x32x16_bf16 v[92:107], v[50:53], v[46:49], v[92:107]
    ds_read_b64_tr_b16 v[38:39], v8 offset:24576
    v_mfma_f32_32x32x16_bf16 v[108:123], v[54:57], v[46:49], v[108:123]
    ds_read_b64_tr_b16 v[40:41], v8 offset:25600
    s_waitcnt lgkmcnt(6)
    v_mfma_f32_32x32x16_bf16 v[60:75], v[18:21], v[10:13], v[60:75]
    ds_read_b128 v[42:45], v6 offset:32768
    ds_read_b128 v[46:49], v6 offset:36864
    v_mfma_f32_32x32x16_bf16 v[76:91], v[22:25], v[10:13], v[76:91]
    ds_read_b64_tr_b16 v[50:51], v7 offset:28672
    ds_read_b64_tr_b16 v[52:53], v7 offset:29696
    v_mfma_f32_32x32x16_bf16 v[92:107], v[18:21], v[14:17], v[92:107]
    ds_read_b64_tr_b16 v[54:55], v8 offset:28672
    v_mfma_f32_32x32x16_bf16 v[108:123], v[22:25], v[14:17], v[108:123]
    ds_read_b64_tr_b16 v[56:57], v8 offset:29696
    s_waitcnt lgkmcnt(0)
    s_barrier
    v_mfma_f32_32x32x16_bf16 v[60:75], v[34:37], v[26:29], v[60:75]
    ds_read_b128 v[10:13], v3 offset:0
    ds_read_b128 v[14:17], v3 offset:4096
    v_mfma_f32_32x32x16_bf16 v[76:91], v[38:41], v[26:29], v[76:91]
    ds_read_b64_tr_b16 v[18:19], v7 offset:0
    ds_read_b64_tr_b16 v[20:21], v7 offset:1024
    v_mfma_f32_32x32x16_bf16 v[92:107], v[34:37], v[30:33], v[92:107]
    ds_read_b64_tr_b16 v[22:23], v8 offset:0
    v_mfma_f32_32x32x16_bf16 v[108:123], v[38:41], v[30:33], v[108:123]
    ds_read_b64_tr_b16 v[24:25], v8 offset:1024
    v_mfma_f32_32x32x16_bf16 v[60:75], v[50:53], v[42:45], v[60:75]
    ds_read_b128 v[26:29], v4 offset:0
    ds_read_b128 v[30:33], v4 offset:4096
    v_mfma_f32_32x32x16_bf16 v[76:91], v[54:57], v[42:45], v[76:91]
    ds_read_b64_tr_b16 v[34:35], v7 offset:4096
    ds_read_b64_tr_b16 v[36:37], v7 offset:5120
    v_mfma_f32_32x32x16_bf16 v[92:107], v[50:53], v[46:49], v[92:107]
    ds_read_b64_tr_b16 v[38:39], v8 offset:4096
    v_mfma_f32_32x32x16_bf16 v[108:123], v[54:57], v[46:49], v[108:123]
    ds_read_b64_tr_b16 v[40:41], v8 offset:5120
    s_waitcnt lgkmcnt(6)
    v_mfma_f32_32x32x16_bf16 v[60:75], v[18:21], v[10:13], v[60:75]
    ds_read_b128 v[42:45], v5 offset:0
    ds_read_b128 v[46:49], v5 offset:4096
    v_mfma_f32_32x32x16_bf16 v[76:91], v[22:25], v[10:13], v[76:91]
    ds_read_b64_tr_b16 v[50:51], v7 offset:8192
    ds_read_b64_tr_b16 v[52:53], v7 offset:9216
    v_mfma_f32_32x32x16_bf16 v[92:107], v[18:21], v[14:17], v[92:107]
    ds_read_b64_tr_b16 v[54:55], v8 offset:8192
    v_mfma_f32_32x32x16_bf16 v[108:123], v[22:25], v[14:17], v[108:123]
    ds_read_b64_tr_b16 v[56:57], v8 offset:9216
    s_waitcnt lgkmcnt(6)
    v_mfma_f32_32x32x16_bf16 v[60:75], v[34:37], v[26:29], v[60:75]
    ds_read_b128 v[10:13], v6 offset:0
    ds_read_b128 v[14:17], v6 offset:4096
    v_mfma_f32_32x32x16_bf16 v[76:91], v[38:41], v[26:29], v[76:91]
    ds_read_b64_tr_b16 v[18:19], v7 offset:12288
    ds_read_b64_tr_b16 v[20:21], v7 offset:13312
    v_mfma_f32_32x32x16_bf16 v[92:107], v[34:37], v[30:33], v[92:107]
    ds_read_b64_tr_b16 v[22:23], v8 offset:12288
    v_mfma_f32_32x32x16_bf16 v[108:123], v[38:41], v[30:33], v[108:123]
    ds_read_b64_tr_b16 v[24:25], v8 offset:13312
    s_waitcnt lgkmcnt(0)
    s_barrier
    v_mfma_f32_32x32x16_bf16 v[60:75], v[50:53], v[42:45], v[60:75]
    ds_read_b128 v[26:29], v3 offset:16384
    ds_read_b128 v[30:33], v3 offset:20480
    v_mfma_f32_32x32x16_bf16 v[76:91], v[54:57], v[42:45], v[76:91]
    ds_read_b64_tr_b16 v[34:35], v7 offset:16384
    ds_read_b64_tr_b16 v[36:37], v7 offset:17408
    v_mfma_f32_32x32x16_bf16 v[92:107], v[50:53], v[46:49], v[92:107]
    ds_read_b64_tr_b16 v[38:39], v8 offset:16384
    v_mfma_f32_32x32x16_bf16 v[108:123], v[54:57], v[46:49], v[108:123]
    ds_read_b64_tr_b16 v[40:41], v8 offset:17408
    v_mfma_f32_32x32x16_bf16 v[60:75], v[18:21], v[10:13], v[60:75]
    ds_read_b128 v[42:45], v4 offset:16384
    ds_read_b128 v[46:49], v4 offset:20480
    v_mfma_f32_32x32x16_bf16 v[76:91], v[22:25], v[10:13], v[76:91]
    ds_read_b64_tr_b16 v[50:51], v7 offset:20480
    ds_read_b64_tr_b16 v[52:53], v7 offset:21504
    v_mfma_f32_32x32x16_bf16 v[92:107], v[18:21], v[14:17], v[92:107]
    ds_read_b64_tr_b16 v[54:55], v8 offset:20480
    v_mfma_f32_32x32x16_bf16 v[108:123], v[22:25], v[14:17], v[108:123]
    ds_read_b64_tr_b16 v[56:57], v8 offset:21504
    s_waitcnt lgkmcnt(6)
    v_mfma_f32_32x32x16_bf16 v[60:75], v[34:37], v[26:29], v[60:75]
    ds_read_b128 v[10:13], v5 offset:16384
    ds_read_b128 v[14:17], v5 offset:20480
    v_mfma_f32_32x32x16_bf16 v[76:91], v[38:41], v[26:29], v[76:91]
    ds_read_b64_tr_b16 v[18:19], v7 offset:24576
    ds_read_b64_tr_b16 v[20:21], v7 offset:25600
    v_mfma_f32_32x32x16_bf16 v[92:107], v[34:37], v[30:33], v[92:107]
    ds_read_b64_tr_b16 v[22:23], v8 offset:24576
    v_mfma_f32_32x32x16_bf16 v[108:123], v[38:41], v[30:33], v[108:123]
    ds_read_b64_tr_b16 v[24:25], v8 offset:25600
    s_waitcnt lgkmcnt(6)
    v_mfma_f32_32x32x16_bf16 v[60:75], v[50:53], v[42:45], v[60:75]
    ds_read_b128 v[26:29], v6 offset:16384
    ds_read_b128 v[30:33], v6 offset:20480
    v_mfma_f32_32x32x16_bf16 v[76:91], v[54:57], v[42:45], v[76:91]
    ds_read_b64_tr_b16 v[34:35], v7 offset:28672
    ds_read_b64_tr_b16 v[36:37], v7 offset:29696
    v_mfma_f32_32x32x16_bf16 v[92:107], v[50:53], v[46:49], v[92:107]
    ds_read_b64_tr_b16 v[38:39], v8 offset:28672
    v_mfma_f32_32x32x16_bf16 v[108:123], v[54:57], v[46:49], v[108:123]
    ds_read_b64_tr_b16 v[40:41], v8 offset:29696
    s_waitcnt lgkmcnt(0)
    s_barrier
    v_mfma_f32_32x32x16_bf16 v[60:75], v[18:21], v[10:13], v[60:75]
    v_mfma_f32_32x32x16_bf16 v[76:91], v[22:25], v[10:13], v[76:91]
    v_mfma_f32_32x32x16_bf16 v[92:107], v[18:21], v[14:17], v[92:107]
    v_mfma_f32_32x32x16_bf16 v[108:123], v[22:25], v[14:17], v[108:123]
    v_mfma_f32_32x32x16_bf16 v[60:75], v[34:37], v[26:29], v[60:75]
    v_mfma_f32_32x32x16_bf16 v[76:91], v[38:41], v[26:29], v[76:91]
    v_mfma_f32_32x32x16_bf16 v[92:107], v[34:37], v[30:33], v[92:107]
    v_mfma_f32_32x32x16_bf16 v[108:123], v[38:41], v[30:33], v[108:123]
    s_waitcnt vmcnt(0)
    s_and_b32 s60, s39, 3
    s_lshl_b32 s60, s60, 3
    s_lshl_b32 s62, s57, 2
    s_add_u32 s60, s60, s62
    s_lshl_b32 s60, s60, 16
    s_lshl_b32 s62, s38, 2
    s_lshl_b32 s63, s56, 1
    s_add_u32 s62, s62, s63
    s_lshl_b32 s62, s62, 10
    s_add_u32 s60, s60, s62
    s_add_u32 s60, s60, 0x1000
    v_lshlrev_b32 v1, 4, v0
    s_cmp_lt_u32 s39, 4
    s_cselect_b32 s62, 0x3eb8aa3b, 1.0
    s_cbranch_scc1 fr_isq
    s_add_u32 s60, s60, 0x201000
    v_and_b32 v2, 0x33, v0
    v_bfe_u32 v58, v0, 2, 1
    v_lshlrev_b32 v58, 3, v58
    v_bfe_u32 v59, v0, 3, 1
    v_lshlrev_b32 v59, 2, v59
    v_or3_b32 v2, v2, v58, v59
    v_lshlrev_b32 v1, 4, v2
fr_isq:
    s_nop 4
    v_mul_f32 v60, s62, v60
    v_mul_f32 v61, s62, v61
    v_mul_f32 v62, s62, v62
    v_mul_f32 v63, s62, v63
    v_mul_f32 v64, s62, v64
    v_mul_f32 v65, s62, v65
    v_mul_f32 v66, s62, v66
    v_mul_f32 v67, s62, v67
    v_cvt_pk_bf16_f32 v60, v60, v61
    v_cvt_pk_bf16_f32 v61, v62, v63
    v_cvt_pk_bf16_f32 v62, v64, v65
    v_cvt_pk_bf16_f32 v63, v66, v67
    s_add_u32 s63, s60, 0
    buffer_store_dwordx4 v[60:63], v1, s[48:51], s63 offen sc0 sc1
    v_mul_f32 v68, s62, v68
    v_mul_f32 v69, s62, v69
    v_mul_f32 v70, s62, v70
    v_mul_f32 v71, s62, v71
    v_mul_f32 v72, s62, v72
    v_mul_f32 v73, s62, v73
    v_mul_f32 v74, s62, v74
    v_mul_f32 v75, s62, v75
    v_cvt_pk_bf16_f32 v68, v68, v69
    v_cvt_pk_bf16_f32 v69, v70, v71
    v_cvt_pk_bf16_f32 v70, v72, v73
    v_cvt_pk_bf16_f32 v71, v74, v75
    s_add_u32 s63, s60, 65536
    buffer_store_dwordx4 v[68:71], v1, s[48:51], s63 offen sc0 sc1
    v_mul_f32 v76, s62, v76
    v_mul_f32 v77, s62, v77
    v_mul_f32 v78, s62, v78
    v_mul_f32 v79, s62, v79
    v_mul_f32 v80, s62, v80
    v_mul_f32 v81, s62, v81
    v_mul_f32 v82, s62, v82
    v_mul_f32 v83, s62, v83
    v_cvt_pk_bf16_f32 v76, v76, v77
    v_cvt_pk_bf16_f32 v77, v78, v79
    v_cvt_pk_bf16_f32 v78, v80, v81
    v_cvt_pk_bf16_f32 v79, v82, v83
    s_add_u32 s63, s60, 131072
    buffer_store_dwordx4 v[76:79], v1, s[48:51], s63 offen sc0 sc1
    v_mul_f32 v84, s62, v84
    v_mul_f32 v85, s62, v85
    v_mul_f32 v86, s62, v86
    v_mul_f32 v87, s62, v87
    v_mul_f32 v88, s62, v88
    v_mul_f32 v89, s62, v89
    v_mul_f32 v90, s62, v90
    v_mul_f32 v91, s62, v91
    v_cvt_pk_bf16_f32 v84, v84, v85
    v_cvt_pk_bf16_f32 v85, v86, v87
    v_cvt_pk_bf16_f32 v86, v88, v89
    v_cvt_pk_bf16_f32 v87, v90, v91
    s_add_u32 s63, s60, 196608
    buffer_store_dwordx4 v[84:87], v1, s[48:51], s63 offen sc0 sc1
    v_mul_f32 v92, s62, v92
    v_mul_f32 v93, s62, v93
    v_mul_f32 v94, s62, v94
    v_mul_f32 v95, s62, v95
    v_mul_f32 v96, s62, v96
    v_mul_f32 v97, s62, v97
    v_mul_f32 v98, s62, v98
    v_mul_f32 v99, s62, v99
    v_cvt_pk_bf16_f32 v92, v92, v93
    v_cvt_pk_bf16_f32 v93, v94, v95
    v_cvt_pk_bf16_f32 v94, v96, v97
    v_cvt_pk_bf16_f32 v95, v98, v99
    s_add_u32 s63, s60, 1024
    buffer_store_dwordx4 v[92:95], v1, s[48:51], s63 offen sc0 sc1
    v_mul_f32 v100, s62, v100
    v_mul_f32 v101, s62, v101
    v_mul_f32 v102, s62, v102
    v_mul_f32 v103, s62, v103
    v_mul_f32 v104, s62, v104
    v_mul_f32 v105, s62, v105
    v_mul_f32 v106, s62, v106
    v_mul_f32 v107, s62, v107
    v_cvt_pk_bf16_f32 v100, v100, v101
    v_cvt_pk_bf16_f32 v101, v102, v103
    v_cvt_pk_bf16_f32 v102, v104, v105
    v_cvt_pk_bf16_f32 v103, v106, v107
    s_add_u32 s63, s60, 66560
    buffer_store_dwordx4 v[100:103], v1, s[48:51], s63 offen sc0 sc1
    v_mul_f32 v108, s62, v108
    v_mul_f32 v109, s62, v109
    v_mul_f32 v110, s62, v110
    v_mul_f32 v111, s62, v111
    v_mul_f32 v112, s62, v112
    v_mul_f32 v113, s62, v113
    v_mul_f32 v114, s62, v114
    v_mul_f32 v115, s62, v115
    v_cvt_pk_bf16_f32 v108, v108, v109
    v_cvt_pk_bf16_f32 v109, v110, v111
    v_cvt_pk_bf16_f32 v110, v112, v113
    v_cvt_pk_bf16_f32 v111, v114, v115
    s_add_u32 s63, s60, 132096
    buffer_store_dwordx4 v[108:111], v1, s[48:51], s63 offen sc0 sc1
    v_mul_f32 v116, s62, v116
    v_mul_f32 v117, s62, v117
    v_mul_f32 v118, s62, v118
    v_mul_f32 v119, s62, v119
    v_mul_f32 v120, s62, v120
    v_mul_f32 v121, s62, v121
    v_mul_f32 v122, s62, v122
    v_mul_f32 v123, s62, v123
    v_cvt_pk_bf16_f32 v116, v116, v117
    v_cvt_pk_bf16_f32 v117, v118, v119
    v_cvt_pk_bf16_f32 v118, v120, v121
    v_cvt_pk_bf16_f32 v119, v122, v123
    s_add_u32 s63, s60, 197632
    buffer_store_dwordx4 v[116:119], v1, s[48:51], s63 offen sc0 sc1
    s_branch fr_qdone
fr_v:
    s_waitcnt lgkmcnt(6)
    v_mfma_f32_32x32x16_bf16 v[60:75], v[10:13], v[18:21], 0
    ds_read_b128 v[42:45], v5 offset:0
    ds_read_b128 v[46:49], v5 offset:4096
    v_mfma_f32_32x32x16_bf16 v[76:91], v[10:13], v[22:25], 0
    ds_read_b64_tr_b16 v[50:51], v7 offset:8192
    ds_read_b64_tr_b16 v[52:53], v7 offset:9216
    v_mfma_f32_32x32x16_bf16 v[92:107], v[14:17], v[18:21], 0
    ds_read_b64_tr_b16 v[54:55], v8 offset:8192
    v_mfma_f32_32x32x16_bf16 v[108:123], v[14:17], v[22:25], 0
    ds_read_b64_tr_b16 v[56:57], v8 offset:9216
    s_waitcnt lgkmcnt(6)
    v_mfma_f32_32x32x16_bf16 v[60:75], v[26:29], v[34:37], v[60:75]
    ds_read_b128 v[10:13], v6 offset:0
    ds_read_b128 v[14:17], v6 offset:4096
    v_mfma_f32_32x32x16_bf16 v[76:91], v[26:29], v[38:41], v[76:91]
    ds_read_b64_tr_b16 v[18:19], v7 offset:12288
    ds_read_b64_tr_b16 v[20:21], v7 offset:13312
    v_mfma_f32_32x32x16_bf16 v[92:107], v[30:33], v[34:37], v[92:107]
    ds_read_b64_tr_b16 v[22:23], v8 offset:12288
    v_mfma_f32_32x32x16_bf16 v[108:123], v[30:33], v[38:41], v[108:123]
    ds_read_b64_tr_b16 v[24:25], v8 offset:13312
    s_waitcnt lgkmcnt(0)
    s_barrier
    v_mfma_f32_32x32x16_bf16 v[60:75], v[42:45], v[50:53], v[60:75]
    ds_read_b128 v[26:29], v3 offset:16384
    ds_read_b128 v[30:33], v3 offset:20480
    v_mfma_f32_32x32x16_bf16 v[76:91], v[42:45], v[54:57], v[76:91]
    ds_read_b64_tr_b16 v[34:35], v7 offset:16384
    ds_read_b64_tr_b16 v[36:37], v7 offset:17408
    v_mfma_f32_32x32x16_bf16 v[92:107], v[46:49], v[50:53], v[92:107]
    ds_read_b64_tr_b16 v[38:39], v8 offset:16384
    v_mfma_f32_32x32x16_bf16 v[108:123], v[46:49], v[54:57], v[108:123]
    ds_read_b64_tr_b16 v[40:41], v8 offset:17408
    v_mfma_f32_32x32x16_bf16 v[60:75], v[10:13], v[18:21], v[60:75]
    ds_read_b128 v[42:45], v4 offset:16384
    ds_read_b128 v[46:49], v4 offset:20480
    v_mfma_f32_32x32x16_bf16 v[76:91], v[10:13], v[22:25], v[76:91]
    ds_read_b64_tr_b16 v[50:51], v7 offset:20480
    ds_read_b64_tr_b16 v[52:53], v7 offset:21504
    v_mfma_f32_32x32x16_bf16 v[92:107], v[14:17], v[18:21], v[92:107]
    ds_read_b64_tr_b16 v[54:55], v8 offset:20480
    v_mfma_f32_32x32x16_bf16 v[108:123], v[14:17], v[22:25], v[108:123]
    ds_read_b64_tr_b16 v[56:57], v8 offset:21504
    s_waitcnt lgkmcnt(6)
    v_mfma_f32_32x32x16_bf16 v[60:75], v[26:29], v[34:37], v[60:75]
    ds_read_b128 v[10:13], v5 offset:16384
    ds_read_b128 v[14:17], v5 offset:20480
    v_mfma_f32_32x32x16_bf16 v[76:91], v[26:29], v[38:41], v[76:91]
    ds_read_b64_tr_b16 v[18:19], v7 offset:24576
    ds_read_b64_tr_b16 v[20:21], v7 offset:25600
    v_mfma_f32_32x32x16_bf16 v[92:107], v[30:33], v[34:37], v[92:107]
    ds_read_b64_tr_b16 v[22:23], v8 offset:24576
    v_mfma_f32_32x32x16_bf16 v[108:123], v[30:33], v[38:41], v[108:123]
    ds_read_b64_tr_b16 v[24:25], v8 offset:25600
    s_waitcnt lgkmcnt(6)
    v_mfma_f32_32x32x16_bf16 v[60:75], v[42:45], v[50:53], v[60:75]
    ds_read_b128 v[26:29], v6 offset:16384
    ds_read_b128 v[30:33], v6 offset:20480
    v_mfma_f32_32x32x16_bf16 v[76:91], v[42:45], v[54:57], v[76:91]
    ds_read_b64_tr_b16 v[34:35], v7 offset:28672
    ds_read_b64_tr_b16 v[36:37], v7 offset:29696
    v_mfma_f32_32x32x16_bf16 v[92:107], v[46:49], v[50:53], v[92:107]
    ds_read_b64_tr_b16 v[38:39], v8 offset:28672
    v_mfma_f32_32x32x16_bf16 v[108:123], v[46:49], v[54:57], v[108:123]
    ds_read_b64_tr_b16 v[40:41], v8 offset:29696
    s_waitcnt lgkmcnt(0)
    s_barrier
    v_mfma_f32_32x32x16_bf16 v[60:75], v[10:13], v[18:21], v[60:75]
    ds_read_b128 v[42:45], v3 offset:32768
    ds_read_b128 v[46:49], v3 offset:36864
    v_mfma_f32_32x32x16_bf16 v[76:91], v[10:13], v[22:25], v[76:91]
    ds_read_b64_tr_b16 v[50:51], v7 offset:0
    ds_read_b64_tr_b16 v[52:53], v7 offset:1024
    v_mfma_f32_32x32x16_bf16 v[92:107], v[14:17], v[18:21], v[92:107]
    ds_read_b64_tr_b16 v[54:55], v8 offset:0
    v_mfma_f32_32x32x16_bf16 v[108:123], v[14:17], v[22:25], v[108:123]
    ds_read_b64_tr_b16 v[56:57], v8 offset:1024
    v_mfma_f32_32x32x16_bf16 v[60:75], v[26:29], v[34:37], v[60:75]
    ds_read_b128 v[10:13], v4 offset:32768
    ds_read_b128 v[14:17], v4 offset:36864
    v_mfma_f32_32x32x16_bf16 v[76:91], v[26:29], v[38:41], v[76:91]
    ds_read_b64_tr_b16 v[18:19], v7 offset:4096
    ds_read_b64_tr_b16 v[20:21], v7 offset:5120
    v_mfma_f32_32x32x16_bf16 v[92:107], v[30:33], v[34:37], v[92:107]
    ds_read_b64_tr_b16 v[22:23], v8 offset:4096
    v_mfma_f32_32x32x16_bf16 v[108:123], v[30:33], v[38:41], v[108:123]
    ds_read_b64_tr_b16 v[24:25], v8 offset:5120
    s_waitcnt lgkmcnt(6)
    v_mfma_f32_32x32x16_bf16 v[60:75], v[42:45], v[50:53], v[60:75]
    ds_read_b128 v[26:29], v5 offset:32768
    ds_read_b128 v[30:33], v5 offset:36864
    v_mfma_f32_32x32x16_bf16 v[76:91], v[42:45], v[54:57], v[76:91]
    ds_read_b64_tr_b16 v[34:35], v7 offset:8192
    ds_read_b64_tr_b16 v[36:37], v7 offset:9216
    v_mfma_f32_32x32x16_bf16 v[92:107], v[46:49], v[50:53], v[92:107]
    ds_read_b64_tr_b16 v[38:39], v8 offset:8192
    v_mfma_f32_32x32x16_bf16 v[108:123], v[46:49], v[54:57], v[108:123]
    ds_read_b64_tr_b16 v[40:41], v8 offset:9216
    s_waitcnt lgkmcnt(6)
    v_mfma_f32_32x32x16_bf16 v[60:75], v[10:13], v[18:21], v[60:75]
    ds_read_b128 v[42:45], v6 offset:32768
    ds_read_b128 v[46:49], v6 offset:36864
    v_mfma_f32_32x32x16_bf16 v[76:91], v[10:13], v[22:25], v[76:91]
    ds_read_b64_tr_b16 v[50:51], v7 offset:12288
    ds_read_b64_tr_b16 v[52:53], v7 offset:13312
    v_mfma_f32_32x32x16_bf16 v[92:107], v[14:17], v[18:21], v[92:107]
    ds_read_b64_tr_b16 v[54:55], v8 offset:12288
    v_mfma_f32_32x32x16_bf16 v[108:123], v[14:17], v[22:25], v[108:123]
    ds_read_b64_tr_b16 v[56:57], v8 offset:13312
    s_waitcnt lgkmcnt(0)
    s_barrier
    v_mfma_f32_32x32x16_bf16 v[60:75], v[26:29], v[34:37], v[60:75]
    ds_read_b128 v[10:13], v3 offset:0
    ds_read_b128 v[14:17], v3 offset:4096
    v_mfma_f32_32x32x16_bf16 v[76:91], v[26:29], v[38:41], v[76:91]
    ds_read_b64_tr_b16 v[18:19], v7 offset:16384
    ds_read_b64_tr_b16 v[20:21], v7 offset:17408
    v_mfma_f32_32x32x16_bf16 v[92:107], v[30:33], v[34:37], v[92:107]
    ds_read_b64_tr_b16 v[22:23], v8 offset:16384
    v_mfma_f32_32x32x16_bf16 v[108:123], v[30:33], v[38:41], v[108:123]
    ds_read_b64_tr_b16 v[24:25], v8 offset:17408
    v_mfma_f32_32x32x16_bf16 v[60:75], v[42:45], v[50:53], v[60:75]
    ds_read_b128 v[26:29], v4 offset:0
    ds_read_b128 v[30:33], v4 offset:4096
    v_mfma_f32_32x32x16_bf16 v[76:91], v[42:45], v[54:57], v[76:91]
    ds_read_b64_tr_b16 v[34:35], v7 offset:20480
    ds_read_b64_tr_b16 v[36:37], v7 offset:21504
    v_mfma_f32_32x32x16_bf16 v[92:107], v[46:49], v[50:53], v[92:107]
    ds_read_b64_tr_b16 v[38:39], v8 offset:20480
    v_mfma_f32_32x32x16_bf16 v[108:123], v[46:49], v[54:57], v[108:123]
    ds_read_b64_tr_b16 v[40:41], v8 offset:21504
    s_waitcnt lgkmcnt(6)
    v_mfma_f32_32x32x16_bf16 v[60:75], v[10:13], v[18:21], v[60:75]
    ds_read_b128 v[42:45], v5 offset:0
    ds_read_b128 v[46:49], v5 offset:4096
    v_mfma_f32_32x32x16_bf16 v[76:91], v[10:13], v[22:25], v[76:91]
    ds_read_b64_tr_b16 v[50:51], v7 offset:24576
    ds_read_b64_tr_b16 v[52:53], v7 offset:25600
    v_mfma_f32_32x32x16_bf16 v[92:107], v[14:17], v[18:21], v[92:107]
    ds_read_b64_tr_b16 v[54:55], v8 offset:24576
    v_mfma_f32_32x32x16_bf16 v[108:123], v[14:17], v[22:25], v[108:123]
    ds_read_b64_tr_b16 v[56:57], v8 offset:25600
    s_waitcnt lgkmcnt(6)
    v_mfma_f32_32x32x16_bf16 v[60:75], v[26:29], v[34:37], v[60:75]
    ds_read_b128 v[10:13], v6 offset:0
    ds_read_b128 v[14:17], v6 offset:4096
    v_mfma_f32_32x32x16_bf16 v[76:91], v[26:29], v[38:41], v[76:91]
    ds_read_b64_tr_b16 v[18:19], v7 offset:28672
    ds_read_b64_tr_b16 v[20:21], v7 offset:29696
    v_mfma_f32_32x32x16_bf16 v[92:107], v[30:33], v[34:37], v[92:107]
    ds_read_b64_tr_b16 v[22:23], v8 offset:28672
    v_mfma_f32_32x32x16_bf16 v[108:123], v[30:33], v[38:41], v[108:123]
    ds_read_b64_tr_b16 v[24:25], v8 offset:29696
    s_waitcnt lgkmcnt(0)
    s_barrier
    v_mfma_f32_32x32x16_bf16 v[60:75], v[42:45], v[50:53], v[60:75]
    ds_read_b128 v[26:29], v3 offset:16384
    ds_read_b128 v[30:33], v3 offset:20480
    v_mfma_f32_32x32x16_bf16 v[76:91], v[42:45], v[54:57], v[76:91]
    ds_read_b64_tr_b16 v[34:35], v7 offset:0
    ds_read_b64_tr_b16 v[36:37], v7 offset:1024
    v_mfma_f32_32x32x16_bf16 v[92:107], v[46:49], v[50:53], v[92:107]
    ds_read_b64_tr_b16 v[38:39], v8 offset:0
    v_mfma_f32_32x32x16_bf16 v[108:123], v[46:49], v[54:57], v[108:123]
    ds_read_b64_tr_b16 v[40:41], v8 offset:1024
    v_mfma_f32_32x32x16_bf16 v[60:75], v[10:13], v[18:21], v[60:75]
    ds_read_b128 v[42:45], v4 offset:16384
    ds_read_b128 v[46:49], v4 offset:20480
    v_mfma_f32_32x32x16_bf16 v[76:91], v[10:13], v[22:25], v[76:91]
    ds_read_b64_tr_b16 v[50:51], v7 offset:4096
    ds_read_b64_tr_b16 v[52:53], v7 offset:5120
    v_mfma_f32_32x32x16_bf16 v[92:107], v[14:17], v[18:21], v[92:107]
    ds_read_b64_tr_b16 v[54:55], v8 offset:4096
    v_mfma_f32_32x32x16_bf16 v[108:123], v[14:17], v[22:25], v[108:123]
    ds_read_b64_tr_b16 v[56:57], v8 offset:5120
    s_waitcnt lgkmcnt(6)
    v_mfma_f32_32x32x16_bf16 v[60:75], v[26:29], v[34:37], v[60:75]
    ds_read_b128 v[10:13], v5 offset:16384
    ds_read_b128 v[14:17], v5 offset:20480
    v_mfma_f32_32x32x16_bf16 v[76:91], v[26:29], v[38:41], v[76:91]
    ds_read_b64_tr_b16 v[18:19], v7 offset:8192
    ds_read_b64_tr_b16 v[20:21], v7 offset:9216
    v_mfma_f32_32x32x16_bf16 v[92:107], v[30:33], v[34:37], v[92:107]
    ds_read_b64_tr_b16 v[22:23], v8 offset:8192
    v_mfma_f32_32x32x16_bf16 v[108:123], v[30:33], v[38:41], v[108:123]
    ds_read_b64_tr_b16 v[24:25], v8 offset:9216
    s_waitcnt lgkmcnt(6)
    v_mfma_f32_32x32x16_bf16 v[60:75], v[42:45], v[50:53], v[60:75]
    ds_read_b128 v[26:29], v6 offset:16384
    ds_read_b128 v[30:33], v6 offset:20480
    v_mfma_f32_32x32x16_bf16 v[76:91], v[42:45], v[54:57], v[76:91]
    ds_read_b64_tr_b16 v[34:35], v7 offset:12288
    ds_read_b64_tr_b16 v[36:37], v7 offset:13312
    v_mfma_f32_32x32x16_bf16 v[92:107], v[46:49], v[50:53], v[92:107]
    ds_read_b64_tr_b16 v[38:39], v8 offset:12288
    v_mfma_f32_32x32x16_bf16 v[108:123], v[46:49], v[54:57], v[108:123]
    ds_read_b64_tr_b16 v[40:41], v8 offset:13312
    s_waitcnt lgkmcnt(0)
    s_barrier
    v_mfma_f32_32x32x16_bf16 v[60:75], v[10:13], v[18:21], v[60:75]
    ds_read_b128 v[42:45], v3 offset:32768
    ds_read_b128 v[46:49], v3 offset:36864
    v_mfma_f32_32x32x16_bf16 v[76:91], v[10:13], v[22:25], v[76:91]
    ds_read_b64_tr_b16 v[50:51], v7 offset:16384
    ds_read_b64_tr_b16 v[52:53], v7 offset:17408
    v_mfma_f32_32x32x16_bf16 v[92:107], v[14:17], v[18:21], v[92:107]
    ds_read_b64_tr_b16 v[54:55], v8 offset:16384
    v_mfma_f32_32x32x16_bf16 v[108:123], v[14:17], v[22:25], v[108:123]
    ds_read_b64_tr_b16 v[56:57], v8 offset:17408
    v_mfma_f32_32x32x16_bf16 v[60:75], v[26:29], v[34:37], v[60:75]
    ds_read_b128 v[10:13], v4 offset:32768
    ds_read_b128 v[14:17], v4 offset:36864
    v_mfma_f32_32x32x16_bf16 v[76:91], v[26:29], v[38:41], v[76:91]
    ds_read_b64_tr_b16 v[18:19], v7 offset:20480
    ds_read_b64_tr_b16 v[20:21], v7 offset:21504
    v_mfma_f32_32x32x16_bf16 v[92:107], v[30:33], v[34:37], v[92:107]
    ds_read_b64_tr_b16 v[22:23], v8 offset:20480
    v_mfma_f32_32x32x16_bf16 v[108:123], v[30:33], v[38:41], v[108:123]
    ds_read_b64_tr_b16 v[24:25], v8 offset:21504
    s_waitcnt lgkmcnt(6)
    v_mfma_f32_32x32x16_bf16 v[60:75], v[42:45], v[50:53], v[60:75]
    ds_read_b128 v[26:29], v5 offset:32768
    ds_read_b128 v[30:33], v5 offset:36864
    v_mfma_f32_32x32x16_bf16 v[76:91], v[42:45], v[54:57], v[76:91]
    ds_read_b64_tr_b16 v[34:35], v7 offset:24576
    ds_read_b64_tr_b16 v[36:37], v7 offset:25600
    v_mfma_f32_32x32x16_bf16 v[92:107], v[46:49], v[50:53], v[92:107]
    ds_read_b64_tr_b16 v[38:39], v8 offset:24576
    v_mfma_f32_32x32x16_bf16 v[108:123], v[46:49], v[54:57], v[108:123]
    ds_read_b64_tr_b16 v[40:41], v8 offset:25600
    s_waitcnt lgkmcnt(6)
    v_mfma_f32_32x32x16_bf16 v[60:75], v[10:13], v[18:21], v[60:75]
    ds_read_b128 v[42:45], v6 offset:32768
    ds_read_b128 v[46:49], v6 offset:36864
    v_mfma_f32_32x32x16_bf16 v[76:91], v[10:13], v[22:25], v[76:91]
    ds_read_b64_tr_b16 v[50:51], v7 offset:28672
    ds_read_b64_tr_b16 v[52:53], v7 offset:29696
    v_mfma_f32_32x32x16_bf16 v[92:107], v[14:17], v[18:21], v[92:107]
    ds_read_b64_tr_b16 v[54:55], v8 offset:28672
    v_mfma_f32_32x32x16_bf16 v[108:123], v[14:17], v[22:25], v[108:123]
    ds_read_b64_tr_b16 v[56:57], v8 offset:29696
    s_waitcnt lgkmcnt(0)
    s_barrier
    v_mfma_f32_32x32x16_bf16 v[60:75], v[26:29], v[34:37], v[60:75]
    ds_read_b128 v[10:13], v3 offset:0
    ds_read_b128 v[14:17], v3 offset:4096
    v_mfma_f32_32x32x16_bf16 v[76:91], v[26:29], v[38:41], v[76:91]
    ds_read_b64_tr_b16 v[18:19], v7 offset:0
    ds_read_b64_tr_b16 v[20:21], v7 offset:1024
    v_mfma_f32_32x32x16_bf16 v[92:107], v[30:33], v[34:37], v[92:107]
    ds_read_b64_tr_b16 v[22:23], v8 offset:0
    v_mfma_f32_32x32x16_bf16 v[108:123], v[30:33], v[38:41], v[108:123]
    ds_read_b64_tr_b16 v[24:25], v8 offset:1024
    v_mfma_f32_32x32x16_bf16 v[60:75], v[42:45], v[50:53], v[60:75]
    ds_read_b128 v[26:29], v4 offset:0
    ds_read_b128 v[30:33], v4 offset:4096
    v_mfma_f32_32x32x16_bf16 v[76:91], v[42:45], v[54:57], v[76:91]
    ds_read_b64_tr_b16 v[34:35], v7 offset:4096
    ds_read_b64_tr_b16 v[36:37], v7 offset:5120
    v_mfma_f32_32x32x16_bf16 v[92:107], v[46:49], v[50:53], v[92:107]
    ds_read_b64_tr_b16 v[38:39], v8 offset:4096
    v_mfma_f32_32x32x16_bf16 v[108:123], v[46:49], v[54:57], v[108:123]
    ds_read_b64_tr_b16 v[40:41], v8 offset:5120
    s_waitcnt lgkmcnt(6)
    v_mfma_f32_32x32x16_bf16 v[60:75], v[10:13], v[18:21], v[60:75]
    ds_read_b128 v[42:45], v5 offset:0
    ds_read_b128 v[46:49], v5 offset:4096
    v_mfma_f32_32x32x16_bf16 v[76:91], v[10:13], v[22:25], v[76:91]
    ds_read_b64_tr_b16 v[50:51], v7 offset:8192
    ds_read_b64_tr_b16 v[52:53], v7 offset:9216
    v_mfma_f32_32x32x16_bf16 v[92:107], v[14:17], v[18:21], v[92:107]
    ds_read_b64_tr_b16 v[54:55], v8 offset:8192
    v_mfma_f32_32x32x16_bf16 v[108:123], v[14:17], v[22:25], v[108:123]
    ds_read_b64_tr_b16 v[56:57], v8 offset:9216
    s_waitcnt lgkmcnt(6)
    v_mfma_f32_32x32x16_bf16 v[60:75], v[26:29], v[34:37], v[60:75]
    ds_read_b128 v[10:13], v6 offset:0
    ds_read_b128 v[14:17], v6 offset:4096
    v_mfma_f32_32x32x16_bf16 v[76:91], v[26:29], v[38:41], v[76:91]
    ds_read_b64_tr_b16 v[18:19], v7 offset:12288
    ds_read_b64_tr_b16 v[20:21], v7 offset:13312
    v_mfma_f32_32x32x16_bf16 v[92:107], v[30:33], v[34:37], v[92:107]
    ds_read_b64_tr_b16 v[22:23], v8 offset:12288
    v_mfma_f32_32x32x16_bf16 v[108:123], v[30:33], v[38:41], v[108:123]
    ds_read_b64_tr_b16 v[24:25], v8 offset:13312
    s_waitcnt lgkmcnt(0)
    s_barrier
    v_mfma_f32_32x32x16_bf16 v[60:75], v[42:45], v[50:53], v[60:75]
    ds_read_b128 v[26:29], v3 offset:16384
    ds_read_b128 v[30:33], v3 offset:20480
    v_mfma_f32_32x32x16_bf16 v[76:91], v[42:45], v[54:57], v[76:91]
    ds_read_b64_tr_b16 v[34:35], v7 offset:16384
    ds_read_b64_tr_b16 v[36:37], v7 offset:17408
    v_mfma_f32_32x32x16_bf16 v[92:107], v[46:49], v[50:53], v[92:107]
    ds_read_b64_tr_b16 v[38:39], v8 offset:16384
    v_mfma_f32_32x32x16_bf16 v[108:123], v[46:49], v[54:57], v[108:123]
    ds_read_b64_tr_b16 v[40:41], v8 offset:17408
    v_mfma_f32_32x32x16_bf16 v[60:75], v[10:13], v[18:21], v[60:75]
    ds_read_b128 v[42:45], v4 offset:16384
    ds_read_b128 v[46:49], v4 offset:20480
    v_mfma_f32_32x32x16_bf16 v[76:91], v[10:13], v[22:25], v[76:91]
    ds_read_b64_tr_b16 v[50:51], v7 offset:20480
    ds_read_b64_tr_b16 v[52:53], v7 offset:21504
    v_mfma_f32_32x32x16_bf16 v[92:107], v[14:17], v[18:21], v[92:107]
    ds_read_b64_tr_b16 v[54:55], v8 offset:20480
    v_mfma_f32_32x32x16_bf16 v[108:123], v[14:17], v[22:25], v[108:123]
    ds_read_b64_tr_b16 v[56:57], v8 offset:21504
    s_waitcnt lgkmcnt(6)
    v_mfma_f32_32x32x16_bf16 v[60:75], v[26:29], v[34:37], v[60:75]
    ds_read_b128 v[10:13], v5 offset:16384
    ds_read_b128 v[14:17], v5 offset:20480
    v_mfma_f32_32x32x16_bf16 v[76:91], v[26:29], v[38:41], v[76:91]
    ds_read_b64_tr_b16 v[18:19], v7 offset:24576
    ds_read_b64_tr_b16 v[20:21], v7 offset:25600
    v_mfma_f32_32x32x16_bf16 v[92:107], v[30:33], v[34:37], v[92:107]
    ds_read_b64_tr_b16 v[22:23], v8 offset:24576
    v_mfma_f32_32x32x16_bf16 v[108:123], v[30:33], v[38:41], v[108:123]
    ds_read_b64_tr_b16 v[24:25], v8 offset:25600
    s_waitcnt lgkmcnt(6)
    v_mfma_f32_32x32x16_bf16 v[60:75], v[42:45], v[50:53], v[60:75]
    ds_read_b128 v[26:29], v6 offset:16384
    ds_read_b128 v[30:33], v6 offset:20480
    v_mfma_f32_32x32x16_bf16 v[76:91], v[42:45], v[54:57], v[76:91]
    ds_read_b64_tr_b16 v[34:35], v7 offset:28672
    ds_read_b64_tr_b16 v[36:37], v7 offset:29696
    v_mfma_f32_32x32x16_bf16 v[92:107], v[46:49], v[50:53], v[92:107]
    ds_read_b64_tr_b16 v[38:39], v8 offset:28672
    v_mfma_f32_32x32x16_bf16 v[108:123], v[46:49], v[54:57], v[108:123]
    ds_read_b64_tr_b16 v[40:41], v8 offset:29696
    s_waitcnt lgkmcnt(0)
    s_barrier
    v_mfma_f32_32x32x16_bf16 v[60:75], v[10:13], v[18:21], v[60:75]
    v_mfma_f32_32x32x16_bf16 v[76:91], v[10:13], v[22:25], v[76:91]
    v_mfma_f32_32x32x16_bf16 v[92:107], v[14:17], v[18:21], v[92:107]
    v_mfma_f32_32x32x16_bf16 v[108:123], v[14:17], v[22:25], v[108:123]
    v_mfma_f32_32x32x16_bf16 v[60:75], v[26:29], v[34:37], v[60:75]
    v_mfma_f32_32x32x16_bf16 v[76:91], v[26:29], v[38:41], v[76:91]
    v_mfma_f32_32x32x16_bf16 v[92:107], v[30:33], v[34:37], v[92:107]
    v_mfma_f32_32x32x16_bf16 v[108:123], v[30:33], v[38:41], v[108:123]
    s_waitcnt vmcnt(0)
    s_and_b32 s60, s39, 3
    s_lshl_b32 s60, s60, 3
    s_lshl_b32 s62, s57, 2
    s_add_u32 s60, s60, s62
    s_lshl_b32 s60, s60, 16
    s_lshl_b32 s62, s38, 2
    s_lshl_b32 s63, s56, 1
    s_add_u32 s62, s62, s63
    s_lshl_b32 s62, s62, 10
    s_add_u32 s60, s60, s62
    s_add_u32 s60, s60, 0x403000
    v_bfe_u32 v2, v0, 4, 1
    v_lshlrev_b32 v2, 16, v2
    v_lshrrev_b32 v58, 5, v0
    v_lshlrev_b32 v58, 8, v58
    v_and_b32 v59, 15, v0
    v_lshlrev_b32 v59, 4, v59
    v_add3_u32 v1, v2, v58, v59
    s_nop 4
    v_cvt_pk_bf16_f32 v60, v60, v61
    v_cvt_pk_bf16_f32 v61, v62, v63
    v_cvt_pk_bf16_f32 v62, v64, v65
    v_cvt_pk_bf16_f32 v63, v66, v67
    s_add_u32 s63, s60, 0
    buffer_store_dwordx4 v[60:63], v1, s[48:51], s63 offen sc0 sc1
    v_cvt_pk_bf16_f32 v68, v68, v69
    v_cvt_pk_bf16_f32 v69, v70, v71
    v_cvt_pk_bf16_f32 v70, v72, v73
    v_cvt_pk_bf16_f32 v71, v74, v75
    s_add_u32 s63, s60, 512
    buffer_store_dwordx4 v[68:71], v1, s[48:51], s63 offen sc0 sc1
    v_cvt_pk_bf16_f32 v76, v76, v77
    v_cvt_pk_bf16_f32 v77, v78, v79
    v_cvt_pk_bf16_f32 v78, v80, v81
    v_cvt_pk_bf16_f32 v79, v82, v83
    s_add_u32 s63, s60, 131072
    buffer_store_dwordx4 v[76:79], v1, s[48:51], s63 offen sc0 sc1
    v_cvt_pk_bf16_f32 v84, v84, v85
    v_cvt_pk_bf16_f32 v85, v86, v87
    v_cvt_pk_bf16_f32 v86, v88, v89
    v_cvt_pk_bf16_f32 v87, v90, v91
    s_add_u32 s63, s60, 131584
    buffer_store_dwordx4 v[84:87], v1, s[48:51], s63 offen sc0 sc1
    v_cvt_pk_bf16_f32 v92, v92, v93
    v_cvt_pk_bf16_f32 v93, v94, v95
    v_cvt_pk_bf16_f32 v94, v96, v97
    v_cvt_pk_bf16_f32 v95, v98, v99
    s_add_u32 s63, s60, 1024
    buffer_store_dwordx4 v[92:95], v1, s[48:51], s63 offen sc0 sc1
    v_cvt_pk_bf16_f32 v100, v100, v101
    v_cvt_pk_bf16_f32 v101, v102, v103
    v_cvt_pk_bf16_f32 v102, v104, v105
    v_cvt_pk_bf16_f32 v103, v106, v107
    s_add_u32 s63, s60, 1536
    buffer_store_dwordx4 v[100:103], v1, s[48:51], s63 offen sc0 sc1
    v_cvt_pk_bf16_f32 v108, v108, v109
    v_cvt_pk_bf16_f32 v109, v110, v111
    v_cvt_pk_bf16_f32 v110, v112, v113
    v_cvt_pk_bf16_f32 v111, v114, v115
    s_add_u32 s63, s60, 132096
    buffer_store_dwordx4 v[108:111], v1, s[48:51], s63 offen sc0 sc1
    v_cvt_pk_bf16_f32 v116, v116, v117
    v_cvt_pk_bf16_f32 v117, v118, v119
    v_cvt_pk_bf16_f32 v118, v120, v121
    v_cvt_pk_bf16_f32 v119, v122, v123
    s_add_u32 s63, s60, 132608
    buffer_store_dwordx4 v[116:119], v1, s[48:51], s63 offen sc0 sc1
fr_qdone:
    s_waitcnt vmcnt(0)
    s_barrier
    s_cmp_lg_u32 s3, 0
    s_cbranch_scc1 fr_qnp
    s_add_u32 s5, s91, 1
    v_mov_b32 v58, s5
    v_mov_b32 v59, 0
    s_mov_b64 exec, 1
    buffer_store_dword v58, v59, s[48:51], s94 offen sc0 sc1
    s_mov_b64 exec, -1
fr_qnp:
    s_mov_b32 s94, 0
    s_lshl_b32 s60, s2, 7
    s_add_u32 s60, s60, 0xe26000
    v_mov_b32 v58, s60
    s_waitcnt lgkmcnt(0)
    s_add_u32 s5, s91, 1
    s_cmp_lg_u32 s3, 0
    s_cbranch_scc1 wfd_4
    s_mov_b32 s60, 0
    s_mov_b32 s62, 0x1
    s_mov_b32 s63, 0x0
wf_1:
    s_mov_b64 exec, s[62:63]
    buffer_load_dword v8, v58, s[48:51], 0 offen sc0 sc1
    s_waitcnt vmcnt(0)
    v_cmp_eq_u32 vcc, s5, v8
    s_andn2_b64 s[62:63], s[62:63], vcc
    s_cbranch_scc0 wfd_4_x
    s_add_u32 s60, s60, 1
    s_cmp_lt_u32 s60, 32768
    s_cbranch_scc0 wfd_4_x
    s_sleep 4
    s_branch wf_1
wfd_4_x:
    s_mov_b64 exec, -1
wfd_4:
    s_barrier
    s_barrier
    ds_read_b128 v[10:13], v3 offset:0
    ds_read_b128 v[14:17], v3 offset:4096
    ds_read_b64_tr_b16 v[18:19], v9 offset:0
    ds_read_b64_tr_b16 v[20:21], v9 offset:512
    ds_read_b64_tr_b16 v[22:23], v9 offset:8192
    ds_read_b64_tr_b16 v[24:25], v9 offset:8704
    ds_read_b128 v[26:29], v4 offset:0
    ds_read_b128 v[30:33], v4 offset:4096
    ds_read_b64_tr_b16 v[34:35], v9 offset:2048
    ds_read_b64_tr_b16 v[36:37], v9 offset:2560
    ds_read_b64_tr_b16 v[38:39], v9 offset:10240
    ds_read_b64_tr_b16 v[40:41], v9 offset:10752
    s_branch fr_g2
fr_g2:
fr_lastc:
    s_setprio 0
    s_waitcnt lgkmcnt(6)
    v_mfma_f32_32x32x16_bf16 v[60:75], v[18:21], v[10:13], 0
    ds_read_b128 v[42:45], v5 offset:0
    ds_read_b128 v[46:49], v5 offset:4096
    v_mfma_f32_32x32x16_bf16 v[76:91], v[22:25], v[10:13], 0
    ds_read_b64_tr_b16 v[50:51], v9 offset:4096
    ds_read_b64_tr_b16 v[52:53], v9 offset:4608
    v_mfma_f32_32x32x16_bf16 v[92:107], v[18:21], v[14:17], 0
    ds_read_b64_tr_b16 v[54:55], v9 offset:12288
    v_mfma_f32_32x32x16_bf16 v[108:123], v[22:25], v[14:17], 0
    ds_read_b64_tr_b16 v[56:57], v9 offset:12800
    s_waitcnt lgkmcnt(6)
    v_mfma_f32_32x32x16_bf16 v[60:75], v[34:37], v[26:29], v[60:75]
    ds_read_b128 v[10:13], v6 offset:0
    ds_read_b128 v[14:17], v6 offset:4096
    v_mfma_f32_32x32x16_bf16 v[76:91], v[38:41], v[26:29], v[76:91]
    ds_read_b64_tr_b16 v[18:19], v9 offset:6144
    ds_read_b64_tr_b16 v[20:21], v9 offset:6656
    v_mfma_f32_32x32x16_bf16 v[92:107], v[34:37], v[30:33], v[92:107]
    ds_read_b64_tr_b16 v[22:23], v9 offset:14336
    v_mfma_f32_32x32x16_bf16 v[108:123], v[38:41], v[30:33], v[108:123]
    ds_read_b64_tr_b16 v[24:25], v9 offset:14848
    s_waitcnt lgkmcnt(0)
    s_barrier
    v_mfma_f32_32x32x16_bf16 v[60:75], v[50:53], v[42:45], v[60:75]
    ds_read_b128 v[26:29], v3 offset:16384
    ds_read_b128 v[30:33], v3 offset:20480
    v_mfma_f32_32x32x16_bf16 v[76:91], v[54:57], v[42:45], v[76:91]
    ds_read_b64_tr_b16 v[34:35], v9 offset:16384
    ds_read_b64_tr_b16 v[36:37], v9 offset:16896
    v_mfma_f32_32x32x16_bf16 v[92:107], v[50:53], v[46:49], v[92:107]
    ds_read_b64_tr_b16 v[38:39], v9 offset:24576
    v_mfma_f32_32x32x16_bf16 v[108:123], v[54:57], v[46:49], v[108:123]
    ds_read_b64_tr_b16 v[40:41], v9 offset:25088
    v_mfma_f32_32x32x16_bf16 v[60:75], v[18:21], v[10:13], v[60:75]
    ds_read_b128 v[42:45], v4 offset:16384
    ds_read_b128 v[46:49], v4 offset:20480
    v_mfma_f32_32x32x16_bf16 v[76:91], v[22:25], v[10:13], v[76:91]
    ds_read_b64_tr_b16 v[50:51], v9 offset:18432
    ds_read_b64_tr_b16 v[52:53], v9 offset:18944
    v_mfma_f32_32x32x16_bf16 v[92:107], v[18:21], v[14:17], v[92:107]
    ds_read_b64_tr_b16 v[54:55], v9 offset:26624
    v_mfma_f32_32x32x16_bf16 v[108:123], v[22:25], v[14:17], v[108:123]
    ds_read_b64_tr_b16 v[56:57], v9 offset:27136
    s_waitcnt lgkmcnt(6)
    v_mfma_f32_32x32x16_bf16 v[60:75], v[34:37], v[26:29], v[60:75]
    ds_read_b128 v[10:13], v5 offset:16384
    ds_read_b128 v[14:17], v5 offset:20480
    v_mfma_f32_32x32x16_bf16 v[76:91], v[38:41], v[26:29], v[76:91]
    ds_read_b64_tr_b16 v[18:19], v9 offset:20480
    ds_read_b64_tr_b16 v[20:21], v9 offset:20992
    v_mfma_f32_32x32x16_bf16 v[92:107], v[34:37], v[30:33], v[92:107]
    ds_read_b64_tr_b16 v[22:23], v9 offset:28672
    v_mfma_f32_32x32x16_bf16 v[108:123], v[38:41], v[30:33], v[108:123]
    ds_read_b64_tr_b16 v[24:25], v9 offset:29184
    s_waitcnt lgkmcnt(6)
    v_mfma_f32_32x32x16_bf16 v[60:75], v[50:53], v[42:45], v[60:75]
    ds_read_b128 v[26:29], v6 offset:16384
    ds_read_b128 v[30:33], v6 offset:20480
    v_mfma_f32_32x32x16_bf16 v[76:91], v[54:57], v[42:45], v[76:91]
    ds_read_b64_tr_b16 v[34:35], v9 offset:22528
    ds_read_b64_tr_b16 v[36:37], v9 offset:23040
    v_mfma_f32_32x32x16_bf16 v[92:107], v[50:53], v[46:49], v[92:107]
    ds_read_b64_tr_b16 v[38:39], v9 offset:30720
    v_mfma_f32_32x32x16_bf16 v[108:123], v[54:57], v[46:49], v[108:123]
    ds_read_b64_tr_b16 v[40:41], v9 offset:31232
    s_waitcnt vmcnt(0)
    s_waitcnt lgkmcnt(0)
    s_barrier
    s_cmp_eq_u32 s94, 0
    s_cbranch_scc1 pend_5
    s_cmp_lg_u32 s3, 0
    s_cbranch_scc1 pend_5
    s_add_u32 s5, s91, 1
    v_mov_b32 v58, s5
    v_mov_b32 v59, 0
    s_mov_b64 exec, 1
    buffer_store_dword v58, v59, s[48:51], s94 offen sc0 sc1
    s_mov_b64 exec, -1
pend_5:
    v_mfma_f32_32x32x16_bf16 v[60:75], v[18:21], v[10:13], v[60:75]
    ds_read_b128 v[42:45], v3 offset:32768
    ds_read_b128 v[46:49], v3 offset:36864
    v_mfma_f32_32x32x16_bf16 v[76:91], v[22:25], v[10:13], v[76:91]
    ds_read_b64_tr_b16 v[50:51], v9 offset:0
    ds_read_b64_tr_b16 v[52:53], v9 offset:512
    v_mfma_f32_32x32x16_bf16 v[92:107], v[18:21], v[14:17], v[92:107]
    ds_read_b64_tr_b16 v[54:55], v9 offset:8192
    v_mfma_f32_32x32x16_bf16 v[108:123], v[22:25], v[14:17], v[108:123]
    ds_read_b64_tr_b16 v[56:57], v9 offset:8704
    v_mfma_f32_32x32x16_bf16 v[60:75], v[34:37], v[26:29], v[60:75]
    ds_read_b128 v[10:13], v4 offset:32768
    ds_read_b128 v[14:17], v4 offset:36864
    v_mfma_f32_32x32x16_bf16 v[76:91], v[38:41], v[26:29], v[76:91]
    ds_read_b64_tr_b16 v[18:19], v9 offset:2048
    ds_read_b64_tr_b16 v[20:21], v9 offset:2560
    v_mfma_f32_32x32x16_bf16 v[92:107], v[34:37], v[30:33], v[92:107]
    ds_read_b64_tr_b16 v[22:23], v9 offset:10240
    v_mfma_f32_32x32x16_bf16 v[108:123], v[38:41], v[30:33], v[108:123]
    ds_read_b64_tr_b16 v[24:25], v9 offset:10752
    s_waitcnt lgkmcnt(6)
    v_mfma_f32_32x32x16_bf16 v[60:75], v[50:53], v[42:45], v[60:75]
    ds_read_b128 v[26:29], v5 offset:32768
    ds_read_b128 v[30:33], v5 offset:36864
    v_mfma_f32_32x32x16_bf16 v[76:91], v[54:57], v[42:45], v[76:91]
    ds_read_b64_tr_b16 v[34:35], v9 offset:4096
    ds_read_b64_tr_b16 v[36:37], v9 offset:4608
    v_mfma_f32_32x32x16_bf16 v[92:107], v[50:53], v[46:49], v[92:107]
    ds_read_b64_tr_b16 v[38:39], v9 offset:12288
    v_mfma_f32_32x32x16_bf16 v[108:123], v[54:57], v[46:49], v[108:123]
    ds_read_b64_tr_b16 v[40:41], v9 offset:12800
    s_waitcnt lgkmcnt(6)
    v_mfma_f32_32x32x16_bf16 v[60:75], v[18:21], v[10:13], v[60:75]
    ds_read_b128 v[42:45], v6 offset:32768
    ds_read_b128 v[46:49], v6 offset:36864
    v_mfma_f32_32x32x16_bf16 v[76:91], v[22:25], v[10:13], v[76:91]
    ds_read_b64_tr_b16 v[50:51], v9 offset:6144
    ds_read_b64_tr_b16 v[52:53], v9 offset:6656
    v_mfma_f32_32x32x16_bf16 v[92:107], v[18:21], v[14:17], v[92:107]
    ds_read_b64_tr_b16 v[54:55], v9 offset:14336
    v_mfma_f32_32x32x16_bf16 v[108:123], v[22:25], v[14:17], v[108:123]
    ds_read_b64_tr_b16 v[56:57], v9 offset:14848
    s_waitcnt lgkmcnt(0)
    s_barrier
    v_mfma_f32_32x32x16_bf16 v[60:75], v[34:37], v[26:29], v[60:75]
    ds_read_b128 v[10:13], v3 offset:0
    ds_read_b128 v[14:17], v3 offset:4096
    v_mfma_f32_32x32x16_bf16 v[76:91], v[38:41], v[26:29], v[76:91]
    ds_read_b64_tr_b16 v[18:19], v9 offset:16384
    ds_read_b64_tr_b16 v[20:21], v9 offset:16896
    v_mfma_f32_32x32x16_bf16 v[92:107], v[34:37], v[30:33], v[92:107]
    ds_read_b64_tr_b16 v[22:23], v9 offset:24576
    v_mfma_f32_32x32x16_bf16 v[108:123], v[38:41], v[30:33], v[108:123]
    ds_read_b64_tr_b16 v[24:25], v9 offset:25088
    v_mfma_f32_32x32x16_bf16 v[60:75], v[50:53], v[42:45], v[60:75]
    ds_read_b128 v[26:29], v4 offset:0
    ds_read_b128 v[30:33], v4 offset:4096
    v_mfma_f32_32x32x16_bf16 v[76:91], v[54:57], v[42:45], v[76:91]
    ds_read_b64_tr_b16 v[34:35], v9 offset:18432
    ds_read_b64_tr_b16 v[36:37], v9 offset:18944
    v_mfma_f32_32x32x16_bf16 v[92:107], v[50:53], v[46:49], v[92:107]
    ds_read_b64_tr_b16 v[38:39], v9 offset:26624
    v_mfma_f32_32x32x16_bf16 v[108:123], v[54:57], v[46:49], v[108:123]
    ds_read_b64_tr_b16 v[40:41], v9 offset:27136
    s_waitcnt lgkmcnt(6)
    v_mfma_f32_32x32x16_bf16 v[60:75], v[18:21], v[10:13], v[60:75]
    ds_read_b128 v[42:45], v5 offset:0
    ds_read_b128 v[46:49], v5 offset:4096
    v_mfma_f32_32x32x16_bf16 v[76:91], v[22:25], v[10:13], v[76:91]
    ds_read_b64_tr_b16 v[50:51], v9 offset:20480
    ds_read_b64_tr_b16 v[52:53], v9 offset:20992
    v_mfma_f32_32x32x16_bf16 v[92:107], v[18:21], v[14:17], v[92:107]
    ds_read_b64_tr_b16 v[54:55], v9 offset:28672
    v_mfma_f32_32x32x16_bf16 v[108:123], v[22:25], v[14:17], v[108:123]
    ds_read_b64_tr_b16 v[56:57], v9 offset:29184
    s_waitcnt lgkmcnt(6)
    v_mfma_f32_32x32x16_bf16 v[60:75], v[34:37], v[26:29], v[60:75]
    ds_read_b128 v[10:13], v6 offset:0
    ds_read_b128 v[14:17], v6 offset:4096
    v_mfma_f32_32x32x16_bf16 v[76:91], v[38:41], v[26:29], v[76:91]
    ds_read_b64_tr_b16 v[18:19], v9 offset:22528
    ds_read_b64_tr_b16 v[20:21], v9 offset:23040
    v_mfma_f32_32x32x16_bf16 v[92:107], v[34:37], v[30:33], v[92:107]
    ds_read_b64_tr_b16 v[22:23], v9 offset:30720
    v_mfma_f32_32x32x16_bf16 v[108:123], v[38:41], v[30:33], v[108:123]
    ds_read_b64_tr_b16 v[24:25], v9 offset:31232
    s_waitcnt lgkmcnt(0)
    s_barrier
    v_mfma_f32_32x32x16_bf16 v[60:75], v[50:53], v[42:45], v[60:75]
    ds_read_b128 v[26:29], v3 offset:16384
    ds_read_b128 v[30:33], v3 offset:20480
    v_mfma_f32_32x32x16_bf16 v[76:91], v[54:57], v[42:45], v[76:91]
    ds_read_b64_tr_b16 v[34:35], v9 offset:0
    ds_read_b64_tr_b16 v[36:37], v9 offset:512
    v_mfma_f32_32x32x16_bf16 v[92:107], v[50:53], v[46:49], v[92:107]
    ds_read_b64_tr_b16 v[38:39], v9 offset:8192
    v_mfma_f32_32x32x16_bf16 v[108:123], v[54:57], v[46:49], v[108:123]
    ds_read_b64_tr_b16 v[40:41], v9 offset:8704
    v_mfma_f32_32x32x16_bf16 v[60:75], v[18:21], v[10:13], v[60:75]
    ds_read_b128 v[42:45], v4 offset:16384
    ds_read_b128 v[46:49], v4 offset:20480
    v_mfma_f32_32x32x16_bf16 v[76:91], v[22:25], v[10:13], v[76:91]
    ds_read_b64_tr_b16 v[50:51], v9 offset:2048
    ds_read_b64_tr_b16 v[52:53], v9 offset:2560
    v_mfma_f32_32x32x16_bf16 v[92:107], v[18:21], v[14:17], v[92:107]
    ds_read_b64_tr_b16 v[54:55], v9 offset:10240
    v_mfma_f32_32x32x16_bf16 v[108:123], v[22:25], v[14:17], v[108:123]
    ds_read_b64_tr_b16 v[56:57], v9 offset:10752
    s_waitcnt lgkmcnt(6)
    v_mfma_f32_32x32x16_bf16 v[60:75], v[34:37], v[26:29], v[60:75]
    ds_read_b128 v[10:13], v5 offset:16384
    ds_read_b128 v[14:17], v5 offset:20480
    v_mfma_f32_32x32x16_bf16 v[76:91], v[38:41], v[26:29], v[76:91]
    ds_read_b64_tr_b16 v[18:19], v9 offset:4096
    ds_read_b64_tr_b16 v[20:21], v9 offset:4608
    v_mfma_f32_32x32x16_bf16 v[92:107], v[34:37], v[30:33], v[92:107]
    ds_read_b64_tr_b16 v[22:23], v9 offset:12288
    v_mfma_f32_32x32x16_bf16 v[108:123], v[38:41], v[30:33], v[108:123]
    ds_read_b64_tr_b16 v[24:25], v9 offset:12800
    s_waitcnt lgkmcnt(6)
    v_mfma_f32_32x32x16_bf16 v[60:75], v[50:53], v[42:45], v[60:75]
    ds_read_b128 v[26:29], v6 offset:16384
    ds_read_b128 v[30:33], v6 offset:20480
    v_mfma_f32_32x32x16_bf16 v[76:91], v[54:57], v[42:45], v[76:91]
    ds_read_b64_tr_b16 v[34:35], v9 offset:6144
    ds_read_b64_tr_b16 v[36:37], v9 offset:6656
    v_mfma_f32_32x32x16_bf16 v[92:107], v[50:53], v[46:49], v[92:107]
    ds_read_b64_tr_b16 v[38:39], v9 offset:14336
    v_mfma_f32_32x32x16_bf16 v[108:123], v[54:57], v[46:49], v[108:123]
    ds_read_b64_tr_b16 v[40:41], v9 offset:14848
    s_waitcnt lgkmcnt(0)
    s_barrier
    v_mfma_f32_32x32x16_bf16 v[60:75], v[18:21], v[10:13], v[60:75]
    ds_read_b128 v[42:45], v3 offset:32768
    ds_read_b128 v[46:49], v3 offset:36864
    v_mfma_f32_32x32x16_bf16 v[76:91], v[22:25], v[10:13], v[76:91]
    ds_read_b64_tr_b16 v[50:51], v9 offset:16384
    ds_read_b64_tr_b16 v[52:53], v9 offset:16896
    v_mfma_f32_32x32x16_bf16 v[92:107], v[18:21], v[14:17], v[92:107]
    ds_read_b64_tr_b16 v[54:55], v9 offset:24576
    v_mfma_f32_32x32x16_bf16 v[108:123], v[22:25], v[14:17], v[108:123]
    ds_read_b64_tr_b16 v[56:57], v9 offset:25088
    v_mfma_f32_32x32x16_bf16 v[60:75], v[34:37], v[26:29], v[60:75]
    ds_read_b128 v[10:13], v4 offset:32768
    ds_read_b128 v[14:17], v4 offset:36864
    v_mfma_f32_32x32x16_bf16 v[76:91], v[38:41], v[26:29], v[76:91]
    ds_read_b64_tr_b16 v[18:19], v9 offset:18432
    ds_read_b64_tr_b16 v[20:21], v9 offset:18944
    v_mfma_f32_32x32x16_bf16 v[92:107], v[34:37], v[30:33], v[92:107]
    ds_read_b64_tr_b16 v[22:23], v9 offset:26624
    v_mfma_f32_32x32x16_bf16 v[108:123], v[38:41], v[30:33], v[108:123]
    ds_read_b64_tr_b16 v[24:25], v9 offset:27136
    s_waitcnt lgkmcnt(6)
    v_mfma_f32_32x32x16_bf16 v[60:75], v[50:53], v[42:45], v[60:75]
    ds_read_b128 v[26:29], v5 offset:32768
    ds_read_b128 v[30:33], v5 offset:36864
    v_mfma_f32_32x32x16_bf16 v[76:91], v[54:57], v[42:45], v[76:91]
    ds_read_b64_tr_b16 v[34:35], v9 offset:20480
    ds_read_b64_tr_b16 v[36:37], v9 offset:20992
    v_mfma_f32_32x32x16_bf16 v[92:107], v[50:53], v[46:49], v[92:107]
    ds_read_b64_tr_b16 v[38:39], v9 offset:28672
    v_mfma_f32_32x32x16_bf16 v[108:123], v[54:57], v[46:49], v[108:123]
    ds_read_b64_tr_b16 v[40:41], v9 offset:29184
    s_waitcnt lgkmcnt(6)
    v_mfma_f32_32x32x16_bf16 v[60:75], v[18:21], v[10:13], v[60:75]
    ds_read_b128 v[42:45], v6 offset:32768
    ds_read_b128 v[46:49], v6 offset:36864
    v_mfma_f32_32x32x16_bf16 v[76:91], v[22:25], v[10:13], v[76:91]
    ds_read_b64_tr_b16 v[50:51], v9 offset:22528
    ds_read_b64_tr_b16 v[52:53], v9 offset:23040
    v_mfma_f32_32x32x16_bf16 v[92:107], v[18:21], v[14:17], v[92:107]
    ds_read_b64_tr_b16 v[54:55], v9 offset:30720
    v_mfma_f32_32x32x16_bf16 v[108:123], v[22:25], v[14:17], v[108:123]
    ds_read_b64_tr_b16 v[56:57], v9 offset:31232
    s_waitcnt lgkmcnt(0)
    s_barrier
    v_mfma_f32_32x32x16_bf16 v[60:75], v[34:37], v[26:29], v[60:75]
    ds_read_b128 v[10:13], v3 offset:0
    ds_read_b128 v[14:17], v3 offset:4096
    v_mfma_f32_32x32x16_bf16 v[76:91], v[38:41], v[26:29], v[76:91]
    ds_read_b64_tr_b16 v[18:19], v9 offset:0
    ds_read_b64_tr_b16 v[20:21], v9 offset:512
    v_mfma_f32_32x32x16_bf16 v[92:107], v[34:37], v[30:33], v[92:107]
    ds_read_b64_tr_b16 v[22:23], v9 offset:8192
    v_mfma_f32_32x32x16_bf16 v[108:123], v[38:41], v[30:33], v[108:123]
    ds_read_b64_tr_b16 v[24:25], v9 offset:8704
    v_mfma_f32_32x32x16_bf16 v[60:75], v[50:53], v[42:45], v[60:75]
    ds_read_b128 v[26:29], v4 offset:0
    ds_read_b128 v[30:33], v4 offset:4096
    v_mfma_f32_32x32x16_bf16 v[76:91], v[54:57], v[42:45], v[76:91]
    ds_read_b64_tr_b16 v[34:35], v9 offset:2048
    ds_read_b64_tr_b16 v[36:37], v9 offset:2560
    v_mfma_f32_32x32x16_bf16 v[92:107], v[50:53], v[46:49], v[92:107]
    ds_read_b64_tr_b16 v[38:39], v9 offset:10240
    v_mfma_f32_32x32x16_bf16 v[108:123], v[54:57], v[46:49], v[108:123]
    ds_read_b64_tr_b16 v[40:41], v9 offset:10752
    s_waitcnt lgkmcnt(6)
    v_mfma_f32_32x32x16_bf16 v[60:75], v[18:21], v[10:13], v[60:75]
    ds_read_b128 v[42:45], v5 offset:0
    ds_read_b128 v[46:49], v5 offset:4096
    v_mfma_f32_32x32x16_bf16 v[76:91], v[22:25], v[10:13], v[76:91]
    ds_read_b64_tr_b16 v[50:51], v9 offset:4096
    ds_read_b64_tr_b16 v[52:53], v9 offset:4608
    v_mfma_f32_32x32x16_bf16 v[92:107], v[18:21], v[14:17], v[92:107]
    ds_read_b64_tr_b16 v[54:55], v9 offset:12288
    v_mfma_f32_32x32x16_bf16 v[108:123], v[22:25], v[14:17], v[108:123]
    ds_read_b64_tr_b16 v[56:57], v9 offset:12800
    s_waitcnt lgkmcnt(6)
    v_mfma_f32_32x32x16_bf16 v[60:75], v[34:37], v[26:29], v[60:75]
    ds_read_b128 v[10:13], v6 offset:0
    ds_read_b128 v[14:17], v6 offset:4096
    v_mfma_f32_32x32x16_bf16 v[76:91], v[38:41], v[26:29], v[76:91]
    ds_read_b64_tr_b16 v[18:19], v9 offset:6144
    ds_read_b64_tr_b16 v[20:21], v9 offset:6656
    v_mfma_f32_32x32x16_bf16 v[92:107], v[34:37], v[30:33], v[92:107]
    ds_read_b64_tr_b16 v[22:23], v9 offset:14336
    v_mfma_f32_32x32x16_bf16 v[108:123], v[38:41], v[30:33], v[108:123]
    ds_read_b64_tr_b16 v[24:25], v9 offset:14848
    s_waitcnt lgkmcnt(0)
    s_barrier
    v_mfma_f32_32x32x16_bf16 v[60:75], v[50:53], v[42:45], v[60:75]
    ds_read_b128 v[26:29], v3 offset:16384
    ds_read_b128 v[30:33], v3 offset:20480
    v_mfma_f32_32x32x16_bf16 v[76:91], v[54:57], v[42:45], v[76:91]
    ds_read_b64_tr_b16 v[34:35], v9 offset:16384
    ds_read_b64_tr_b16 v[36:37], v9 offset:16896
    v_mfma_f32_32x32x16_bf16 v[92:107], v[50:53], v[46:49], v[92:107]
    ds_read_b64_tr_b16 v[38:39], v9 offset:24576
    v_mfma_f32_32x32x16_bf16 v[108:123], v[54:57], v[46:49], v[108:123]
    ds_read_b64_tr_b16 v[40:41], v9 offset:25088
    v_mfma_f32_32x32x16_bf16 v[60:75], v[18:21], v[10:13], v[60:75]
    ds_read_b128 v[42:45], v4 offset:16384
    ds_read_b128 v[46:49], v4 offset:20480
    v_mfma_f32_32x32x16_bf16 v[76:91], v[22:25], v[10:13], v[76:91]
    ds_read_b64_tr_b16 v[50:51], v9 offset:18432
    ds_read_b64_tr_b16 v[52:53], v9 offset:18944
    v_mfma_f32_32x32x16_bf16 v[92:107], v[18:21], v[14:17], v[92:107]
    ds_read_b64_tr_b16 v[54:55], v9 offset:26624
    v_mfma_f32_32x32x16_bf16 v[108:123], v[22:25], v[14:17], v[108:123]
    ds_read_b64_tr_b16 v[56:57], v9 offset:27136
    s_waitcnt lgkmcnt(6)
    v_mfma_f32_32x32x16_bf16 v[60:75], v[34:37], v[26:29], v[60:75]
    ds_read_b128 v[10:13], v5 offset:16384
    ds_read_b128 v[14:17], v5 offset:20480
    v_mfma_f32_32x32x16_bf16 v[76:91], v[38:41], v[26:29], v[76:91]
    ds_read_b64_tr_b16 v[18:19], v9 offset:20480
    ds_read_b64_tr_b16 v[20:21], v9 offset:20992
    v_mfma_f32_32x32x16_bf16 v[92:107], v[34:37], v[30:33], v[92:107]
    ds_read_b64_tr_b16 v[22:23], v9 offset:28672
    v_mfma_f32_32x32x16_bf16 v[108:123], v[38:41], v[30:33], v[108:123]
    ds_read_b64_tr_b16 v[24:25], v9 offset:29184
    s_waitcnt lgkmcnt(6)
    v_mfma_f32_32x32x16_bf16 v[60:75], v[50:53], v[42:45], v[60:75]
    ds_read_b128 v[26:29], v6 offset:16384
    ds_read_b128 v[30:33], v6 offset:20480
    v_mfma_f32_32x32x16_bf16 v[76:91], v[54:57], v[42:45], v[76:91]
    ds_read_b64_tr_b16 v[34:35], v9 offset:22528
    ds_read_b64_tr_b16 v[36:37], v9 offset:23040
    v_mfma_f32_32x32x16_bf16 v[92:107], v[50:53], v[46:49], v[92:107]
    ds_read_b64_tr_b16 v[38:39], v9 offset:30720
    v_mfma_f32_32x32x16_bf16 v[108:123], v[54:57], v[46:49], v[108:123]
    ds_read_b64_tr_b16 v[40:41], v9 offset:31232
    s_waitcnt lgkmcnt(0)
    s_barrier
    v_mfma_f32_32x32x16_bf16 v[60:75], v[18:21], v[10:13], v[60:75]
    v_mfma_f32_32x32x16_bf16 v[76:91], v[22:25], v[10:13], v[76:91]
    v_mfma_f32_32x32x16_bf16 v[92:107], v[18:21], v[14:17], v[92:107]
    v_mfma_f32_32x32x16_bf16 v[108:123], v[22:25], v[14:17], v[108:123]
    v_mfma_f32_32x32x16_bf16 v[60:75], v[34:37], v[26:29], v[60:75]
    v_mfma_f32_32x32x16_bf16 v[76:91], v[38:41], v[26:29], v[76:91]
    v_mfma_f32_32x32x16_bf16 v[92:107], v[34:37], v[30:33], v[92:107]
    v_mfma_f32_32x32x16_bf16 v[108:123], v[38:41], v[30:33], v[108:123]
    s_setprio 3
    s_lshl_b32 s62, s38, 2
    s_lshl_b32 s63, s56, 1
    s_add_u32 s62, s62, s63
    s_lshl_b32 s60, s92, 1
    s_add_u32 s60, s60, s57
    s_mul_i32 s62, s62, 89
    s_cmp_ge_u32 s60, 43
    s_cselect_b32 s64, 0, 1.0
    s_lshl_b32 s60, s60, 1
    s_add_u32 s60, s60, s62
    s_lshl_b32 s60, s60, 10
    s_add_u32 s65, s60, 0x80e000
    v_lshlrev_b32 v1, 4, v0
    v_mul_f32 v42, 0xbfb8aa3b, v60
    v_mul_f32 v43, 0xbfb8aa3b, v61
    v_mul_f32 v44, 0xbfb8aa3b, v62
    v_mul_f32 v45, 0xbfb8aa3b, v63
    v_mul_f32 v46, 0xbfb8aa3b, v64
    v_mul_f32 v47, 0xbfb8aa3b, v65
    v_mul_f32 v48, 0xbfb8aa3b, v66
    v_mul_f32 v49, 0xbfb8aa3b, v67
    v_exp_f32 v42, v42
    v_exp_f32 v43, v43
    v_exp_f32 v44, v44
    v_exp_f32 v45, v45
    v_exp_f32 v46, v46
    v_exp_f32 v47, v47
    v_exp_f32 v48, v48
    v_exp_f32 v49, v49
    v_mul_f32 v76, v60, v76
    v_mul_f32 v77, v61, v77
    v_mul_f32 v78, v62, v78
    v_mul_f32 v79, v63, v79
    v_mul_f32 v80, v64, v80
    v_mul_f32 v81, v65, v81
    v_mul_f32 v82, v66, v82
    v_mul_f32 v83, v67, v83
    v_add_f32 v42, 1.0, v42
    v_add_f32 v43, 1.0, v43
    v_add_f32 v44, 1.0, v44
    v_add_f32 v45, 1.0, v45
    v_add_f32 v46, 1.0, v46
    v_add_f32 v47, 1.0, v47
    v_add_f32 v48, 1.0, v48
    v_add_f32 v49, 1.0, v49
    v_rcp_f32 v42, v42
    v_rcp_f32 v43, v43
    v_rcp_f32 v44, v44
    v_rcp_f32 v45, v45
    v_rcp_f32 v46, v46
    v_rcp_f32 v47, v47
    v_rcp_f32 v48, v48
    v_rcp_f32 v49, v49
    v_mul_f32 v76, s64, v76
    v_mul_f32 v77, s64, v77
    v_mul_f32 v78, s64, v78
    v_mul_f32 v79, s64, v79
    v_mul_f32 v80, s64, v80
    v_mul_f32 v81, s64, v81
    v_mul_f32 v82, s64, v82
    v_mul_f32 v83, s64, v83
    v_mul_f32 v76, v76, v42
    v_mul_f32 v77, v77, v43
    v_mul_f32 v78, v78, v44
    v_mul_f32 v79, v79, v45
    v_mul_f32 v80, v80, v46
    v_mul_f32 v81, v81, v47
    v_mul_f32 v82, v82, v48
    v_mul_f32 v83, v83, v49
    v_cvt_pk_bf16_f32 v76, v76, v77
    v_cvt_pk_bf16_f32 v77, v78, v79
    v_cvt_pk_bf16_f32 v78, v80, v81
    v_cvt_pk_bf16_f32 v79, v82, v83
    s_add_u32 s63, s65, 0
    buffer_store_dwordx4 v[76:79], v1, s[48:51], s63 offen sc0 sc1
    v_mul_f32 v42, 0xbfb8aa3b, v68
    v_mul_f32 v43, 0xbfb8aa3b, v69
    v_mul_f32 v44, 0xbfb8aa3b, v70
    v_mul_f32 v45, 0xbfb8aa3b, v71
    v_mul_f32 v46, 0xbfb8aa3b, v72
    v_mul_f32 v47, 0xbfb8aa3b, v73
    v_mul_f32 v48, 0xbfb8aa3b, v74
    v_mul_f32 v49, 0xbfb8aa3b, v75
    v_exp_f32 v42, v42
    v_exp_f32 v43, v43
    v_exp_f32 v44, v44
    v_exp_f32 v45, v45
    v_exp_f32 v46, v46
    v_exp_f32 v47, v47
    v_exp_f32 v48, v48
    v_exp_f32 v49, v49
    v_mul_f32 v84, v68, v84
    v_mul_f32 v85, v69, v85
    v_mul_f32 v86, v70, v86
    v_mul_f32 v87, v71, v87
    v_mul_f32 v88, v72, v88
    v_mul_f32 v89, v73, v89
    v_mul_f32 v90, v74, v90
    v_mul_f32 v91, v75, v91
    v_add_f32 v42, 1.0, v42
    v_add_f32 v43, 1.0, v43
    v_add_f32 v44, 1.0, v44
    v_add_f32 v45, 1.0, v45
    v_add_f32 v46, 1.0, v46
    v_add_f32 v47, 1.0, v47
    v_add_f32 v48, 1.0, v48
    v_add_f32 v49, 1.0, v49
    v_rcp_f32 v42, v42
    v_rcp_f32 v43, v43
    v_rcp_f32 v44, v44
    v_rcp_f32 v45, v45
    v_rcp_f32 v46, v46
    v_rcp_f32 v47, v47
    v_rcp_f32 v48, v48
    v_rcp_f32 v49, v49
    v_mul_f32 v84, s64, v84
    v_mul_f32 v85, s64, v85
    v_mul_f32 v86, s64, v86
    v_mul_f32 v87, s64, v87
    v_mul_f32 v88, s64, v88
    v_mul_f32 v89, s64, v89
    v_mul_f32 v90, s64, v90
    v_mul_f32 v91, s64, v91
    v_mul_f32 v84, v84, v42
    v_mul_f32 v85, v85, v43
    v_mul_f32 v86, v86, v44
    v_mul_f32 v87, v87, v45
    v_mul_f32 v88, v88, v46
    v_mul_f32 v89, v89, v47
    v_mul_f32 v90, v90, v48
    v_mul_f32 v91, v91, v49
    v_cvt_pk_bf16_f32 v84, v84, v85
    v_cvt_pk_bf16_f32 v85, v86, v87
    v_cvt_pk_bf16_f32 v86, v88, v89
    v_cvt_pk_bf16_f32 v87, v90, v91
    s_add_u32 s63, s65, 1024
    buffer_store_dwordx4 v[84:87], v1, s[48:51], s63 offen sc0 sc1
    v_mul_f32 v42, 0xbfb8aa3b, v92
    v_mul_f32 v43, 0xbfb8aa3b, v93
    v_mul_f32 v44, 0xbfb8aa3b, v94
    v_mul_f32 v45, 0xbfb8aa3b, v95
    v_mul_f32 v46, 0xbfb8aa3b, v96
    v_mul_f32 v47, 0xbfb8aa3b, v97
    v_mul_f32 v48, 0xbfb8aa3b, v98
    v_mul_f32 v49, 0xbfb8aa3b, v99
    v_exp_f32 v42, v42
    v_exp_f32 v43, v43
    v_exp_f32 v44, v44
    v_exp_f32 v45, v45
    v_exp_f32 v46, v46
    v_exp_f32 v47, v47
    v_exp_f32 v48, v48
    v_exp_f32 v49, v49
    v_mul_f32 v108, v92, v108
    v_mul_f32 v109, v93, v109
    v_mul_f32 v110, v94, v110
    v_mul_f32 v111, v95, v111
    v_mul_f32 v112, v96, v112
    v_mul_f32 v113, v97, v113
    v_mul_f32 v114, v98, v114
    v_mul_f32 v115, v99, v115
    v_add_f32 v42, 1.0, v42
    v_add_f32 v43, 1.0, v43
    v_add_f32 v44, 1.0, v44
    v_add_f32 v45, 1.0, v45
    v_add_f32 v46, 1.0, v46
    v_add_f32 v47, 1.0, v47
    v_add_f32 v48, 1.0, v48
    v_add_f32 v49, 1.0, v49
    v_rcp_f32 v42, v42
    v_rcp_f32 v43, v43
    v_rcp_f32 v44, v44
    v_rcp_f32 v45, v45
    v_rcp_f32 v46, v46
    v_rcp_f32 v47, v47
    v_rcp_f32 v48, v48
    v_rcp_f32 v49, v49
    v_mul_f32 v108, s64, v108
    v_mul_f32 v109, s64, v109
    v_mul_f32 v110, s64, v110
    v_mul_f32 v111, s64, v111
    v_mul_f32 v112, s64, v112
    v_mul_f32 v113, s64, v113
    v_mul_f32 v114, s64, v114
    v_mul_f32 v115, s64, v115
    v_mul_f32 v108, v108, v42
    v_mul_f32 v109, v109, v43
    v_mul_f32 v110, v110, v44
    v_mul_f32 v111, v111, v45
    v_mul_f32 v112, v112, v46
    v_mul_f32 v113, v113, v47
    v_mul_f32 v114, v114, v48
    v_mul_f32 v115, v115, v49
    v_cvt_pk_bf16_f32 v108, v108, v109
    v_cvt_pk_bf16_f32 v109, v110, v111
    v_cvt_pk_bf16_f32 v110, v112, v113
    v_cvt_pk_bf16_f32 v111, v114, v115
    s_add_u32 s63, s65, 91136
    buffer_store_dwordx4 v[108:111], v1, s[48:51], s63 offen sc0 sc1
    v_mul_f32 v42, 0xbfb8aa3b, v100
    v_mul_f32 v43, 0xbfb8aa3b, v101
    v_mul_f32 v44, 0xbfb8aa3b, v102
    v_mul_f32 v45, 0xbfb8aa3b, v103
    v_mul_f32 v46, 0xbfb8aa3b, v104
    v_mul_f32 v47, 0xbfb8aa3b, v105
    v_mul_f32 v48, 0xbfb8aa3b, v106
    v_mul_f32 v49, 0xbfb8aa3b, v107
    v_exp_f32 v42, v42
    v_exp_f32 v43, v43
    v_exp_f32 v44, v44
    v_exp_f32 v45, v45
    v_exp_f32 v46, v46
    v_exp_f32 v47, v47
    v_exp_f32 v48, v48
    v_exp_f32 v49, v49
    v_mul_f32 v116, v100, v116
    v_mul_f32 v117, v101, v117
    v_mul_f32 v118, v102, v118
    v_mul_f32 v119, v103, v119
    v_mul_f32 v120, v104, v120
    v_mul_f32 v121, v105, v121
    v_mul_f32 v122, v106, v122
    v_mul_f32 v123, v107, v123
    v_add_f32 v42, 1.0, v42
    v_add_f32 v43, 1.0, v43
    v_add_f32 v44, 1.0, v44
    v_add_f32 v45, 1.0, v45
    v_add_f32 v46, 1.0, v46
    v_add_f32 v47, 1.0, v47
    v_add_f32 v48, 1.0, v48
    v_add_f32 v49, 1.0, v49
    v_rcp_f32 v42, v42
    v_rcp_f32 v43, v43
    v_rcp_f32 v44, v44
    v_rcp_f32 v45, v45
    v_rcp_f32 v46, v46
    v_rcp_f32 v47, v47
    v_rcp_f32 v48, v48
    v_rcp_f32 v49, v49
    v_mul_f32 v116, s64, v116
    v_mul_f32 v117, s64, v117
    v_mul_f32 v118, s64, v118
    v_mul_f32 v119, s64, v119
    v_mul_f32 v120, s64, v120
    v_mul_f32 v121, s64, v121
    v_mul_f32 v122, s64, v122
    v_mul_f32 v123, s64, v123
    v_mul_f32 v116, v116, v42
    v_mul_f32 v117, v117, v43
    v_mul_f32 v118, v118, v44
    v_mul_f32 v119, v119, v45
    v_mul_f32 v120, v120, v46
    v_mul_f32 v121, v121, v47
    v_mul_f32 v122, v122, v48
    v_mul_f32 v123, v123, v49
    v_cvt_pk_bf16_f32 v116, v116, v117
    v_cvt_pk_bf16_f32 v117, v118, v119
    v_cvt_pk_bf16_f32 v118, v120, v121
    v_cvt_pk_bf16_f32 v119, v122, v123
    s_add_u32 s63, s65, 92160
    buffer_store_dwordx4 v[116:119], v1, s[48:51], s63 offen sc0 sc1
    s_lshl_b32 s64, s38, 5
    s_add_u32 s64, s64, s92
    s_branch fr_pub
fr_gstart:
    s_mov_b32 s40, s16
    s_mov_b32 s41, s17
    s_mov_b32 s42, 0x200000
    s_mov_b32 s43, 0x20000
    s_mov_b32 s44, s30
    s_mov_b32 s45, s31
    s_mov_b32 s46, 0x400
    s_mov_b32 s47, 0x20000
    s_and_b32 s60, s2, 7
    s_lshl_b32 s66, s60, 3
    s_lshr_b32 s60, s2, 3
    s_sub_u32 s60, s60, 24
    s_add_u32 s66, s66, s60
    s_lshl_b32 s65, s66, 2
    s_add_u32 s65, s65, s3
    s_lshl_b32 s61, s65, 13
    v_lshlrev_b32 v58, 4, v0
    buffer_load_dwordx4 v[100:103], v58, s[44:47], 0 offen
    s_add_u32 s62, s61, 0
    buffer_load_dwordx4 v[60:63], v58, s[40:43], s62 offen
    s_add_u32 s62, s61, 1024
    buffer_load_dwordx4 v[64:67], v58, s[40:43], s62 offen
    s_add_u32 s62, s61, 2048
    buffer_load_dwordx4 v[68:71], v58, s[40:43], s62 offen
    s_add_u32 s62, s61, 3072
    buffer_load_dwordx4 v[72:75], v58, s[40:43], s62 offen
    s_add_u32 s62, s61, 4096
    buffer_load_dwordx4 v[76:79], v58, s[40:43], s62 offen
    s_add_u32 s62, s61, 5120
    buffer_load_dwordx4 v[80:83], v58, s[40:43], s62 offen
    s_add_u32 s62, s61, 6144
    buffer_load_dwordx4 v[84:87], v58, s[40:43], s62 offen
    s_add_u32 s62, s61, 7168
    buffer_load_dwordx4 v[88:91], v58, s[40:43], s62 offen
    s_waitcnt vmcnt(0)
    v_mov_b32 v104, 0
    v_mov_b32 v105, 0
    v_mov_b32 v106, 0
    v_mov_b32 v107, 0
    v_mov_b32 v108, 0
    v_mov_b32 v109, 0
    v_mov_b32 v110, 0
    v_mov_b32 v111, 0
    v_dot2_f32_bf16 v104, v60, v100, v104
    v_dot2_f32_bf16 v105, v64, v100, v105
    v_dot2_f32_bf16 v106, v68, v100, v106
    v_dot2_f32_bf16 v107, v72, v100, v107
    v_dot2_f32_bf16 v108, v76, v100, v108
    v_dot2_f32_bf16 v109, v80, v100, v109
    v_dot2_f32_bf16 v110, v84, v100, v110
    v_dot2_f32_bf16 v111, v88, v100, v111
    v_dot2_f32_bf16 v104, v61, v101, v104
    v_dot2_f32_bf16 v105, v65, v101, v105
    v_dot2_f32_bf16 v106, v69, v101, v106
    v_dot2_f32_bf16 v107, v73, v101, v107
    v_dot2_f32_bf16 v108, v77, v101, v108
    v_dot2_f32_bf16 v109, v81, v101, v109
    v_dot2_f32_bf16 v110, v85, v101, v110
    v_dot2_f32_bf16 v111, v89, v101, v111
    v_dot2_f32_bf16 v104, v62, v102, v104
    v_dot2_f32_bf16 v105, v66, v102, v105
    v_dot2_f32_bf16 v106, v70, v102, v106
    v_dot2_f32_bf16 v107, v74, v102, v107
    v_dot2_f32_bf16 v108, v78, v102, v108
    v_dot2_f32_bf16 v109, v82, v102, v109
    v_dot2_f32_bf16 v110, v86, v102, v110
    v_dot2_f32_bf16 v111, v90, v102, v111
    v_dot2_f32_bf16 v104, v63, v103, v104
    v_dot2_f32_bf16 v105, v67, v103, v105
    v_dot2_f32_bf16 v106, v71, v103, v106
    v_dot2_f32_bf16 v107, v75, v103, v107
    v_dot2_f32_bf16 v108, v79, v103, v108
    v_dot2_f32_bf16 v109, v83, v103, v109
    v_dot2_f32_bf16 v110, v87, v103, v110
    v_dot2_f32_bf16 v111, v91, v103, v111
    s_nop 2
    v_add_f32_dpp v104, v104, v104 row_shr:1 row_mask:0xf bank_mask:0xf bound_ctrl:0
    v_add_f32_dpp v105, v105, v105 row_shr:1 row_mask:0xf bank_mask:0xf bound_ctrl:0
    v_add_f32_dpp v106, v106, v106 row_shr:1 row_mask:0xf bank_mask:0xf bound_ctrl:0
    v_add_f32_dpp v107, v107, v107 row_shr:1 row_mask:0xf bank_mask:0xf bound_ctrl:0
    v_add_f32_dpp v108, v108, v108 row_shr:1 row_mask:0xf bank_mask:0xf bound_ctrl:0
    v_add_f32_dpp v109, v109, v109 row_shr:1 row_mask:0xf bank_mask:0xf bound_ctrl:0
    v_add_f32_dpp v110, v110, v110 row_shr:1 row_mask:0xf bank_mask:0xf bound_ctrl:0
    v_add_f32_dpp v111, v111, v111 row_shr:1 row_mask:0xf bank_mask:0xf bound_ctrl:0
    v_add_f32_dpp v104, v104, v104 row_shr:2 row_mask:0xf bank_mask:0xf bound_ctrl:0
    v_add_f32_dpp v105, v105, v105 row_shr:2 row_mask:0xf bank_mask:0xf bound_ctrl:0
    v_add_f32_dpp v106, v106, v106 row_shr:2 row_mask:0xf bank_mask:0xf bound_ctrl:0
    v_add_f32_dpp v107, v107, v107 row_shr:2 row_mask:0xf bank_mask:0xf bound_ctrl:0
    v_add_f32_dpp v108, v108, v108 row_shr:2 row_mask:0xf bank_mask:0xf bound_ctrl:0
    v_add_f32_dpp v109, v109, v109 row_shr:2 row_mask:0xf bank_mask:0xf bound_ctrl:0
    v_add_f32_dpp v110, v110, v110 row_shr:2 row_mask:0xf bank_mask:0xf bound_ctrl:0
    v_add_f32_dpp v111, v111, v111 row_shr:2 row_mask:0xf bank_mask:0xf bound_ctrl:0
    v_add_f32_dpp v104, v104, v104 row_shr:4 row_mask:0xf bank_mask:0xf bound_ctrl:0
    v_add_f32_dpp v105, v105, v105 row_shr:4 row_mask:0xf bank_mask:0xf bound_ctrl:0
    v_add_f32_dpp v106, v106, v106 row_shr:4 row_mask:0xf bank_mask:0xf bound_ctrl:0
    v_add_f32_dpp v107, v107, v107 row_shr:4 row_mask:0xf bank_mask:0xf bound_ctrl:0
    v_add_f32_dpp v108, v108, v108 row_shr:4 row_mask:0xf bank_mask:0xf bound_ctrl:0
    v_add_f32_dpp v109, v109, v109 row_shr:4 row_mask:0xf bank_mask:0xf bound_ctrl:0
    v_add_f32_dpp v110, v110, v110 row_shr:4 row_mask:0xf bank_mask:0xf bound_ctrl:0
    v_add_f32_dpp v111, v111, v111 row_shr:4 row_mask:0xf bank_mask:0xf bound_ctrl:0
    v_add_f32_dpp v104, v104, v104 row_shr:8 row_mask:0xf bank_mask:0xf bound_ctrl:0
    v_add_f32_dpp v105, v105, v105 row_shr:8 row_mask:0xf bank_mask:0xf bound_ctrl:0
    v_add_f32_dpp v106, v106, v106 row_shr:8 row_mask:0xf bank_mask:0xf bound_ctrl:0
    v_add_f32_dpp v107, v107, v107 row_shr:8 row_mask:0xf bank_mask:0xf bound_ctrl:0
    v_add_f32_dpp v108, v108, v108 row_shr:8 row_mask:0xf bank_mask:0xf bound_ctrl:0
    v_add_f32_dpp v109, v109, v109 row_shr:8 row_mask:0xf bank_mask:0xf bound_ctrl:0
    v_add_f32_dpp v110, v110, v110 row_shr:8 row_mask:0xf bank_mask:0xf bound_ctrl:0
    v_add_f32_dpp v111, v111, v111 row_shr:8 row_mask:0xf bank_mask:0xf bound_ctrl:0
    v_add_f32_dpp v104, v104, v104 row_bcast:15 row_mask:0xa bank_mask:0xf
    v_add_f32_dpp v105, v105, v105 row_bcast:15 row_mask:0xa bank_mask:0xf
    v_add_f32_dpp v106, v106, v106 row_bcast:15 row_mask:0xa bank_mask:0xf
    v_add_f32_dpp v107, v107, v107 row_bcast:15 row_mask:0xa bank_mask:0xf
    v_add_f32_dpp v108, v108, v108 row_bcast:15 row_mask:0xa bank_mask:0xf
    v_add_f32_dpp v109, v109, v109 row_bcast:15 row_mask:0xa bank_mask:0xf
    v_add_f32_dpp v110, v110, v110 row_bcast:15 row_mask:0xa bank_mask:0xf
    v_add_f32_dpp v111, v111, v111 row_bcast:15 row_mask:0xa bank_mask:0xf
    v_add_f32_dpp v104, v104, v104 row_bcast:31 row_mask:0xc bank_mask:0xf
    v_add_f32_dpp v105, v105, v105 row_bcast:31 row_mask:0xc bank_mask:0xf
    v_add_f32_dpp v106, v106, v106 row_bcast:31 row_mask:0xc bank_mask:0xf
    v_add_f32_dpp v107, v107, v107 row_bcast:31 row_mask:0xc bank_mask:0xf
    v_add_f32_dpp v108, v108, v108 row_bcast:31 row_mask:0xc bank_mask:0xf
    v_add_f32_dpp v109, v109, v109 row_bcast:31 row_mask:0xc bank_mask:0xf
    v_add_f32_dpp v110, v110, v110 row_bcast:31 row_mask:0xc bank_mask:0xf
    v_add_f32_dpp v111, v111, v111 row_bcast:31 row_mask:0xc bank_mask:0xf
    v_mul_f32 v104, 0xbfb8aa3b, v104
    v_mul_f32 v105, 0xbfb8aa3b, v105
    v_mul_f32 v106, 0xbfb8aa3b, v106
    v_mul_f32 v107, 0xbfb8aa3b, v107
    v_mul_f32 v108, 0xbfb8aa3b, v108
    v_mul_f32 v109, 0xbfb8aa3b, v109
    v_mul_f32 v110, 0xbfb8aa3b, v110
    v_mul_f32 v111, 0xbfb8aa3b, v111
    v_exp_f32 v104, v104
    v_exp_f32 v105, v105
    v_exp_f32 v106, v106
    v_exp_f32 v107, v107
    v_exp_f32 v108, v108
    v_exp_f32 v109, v109
    v_exp_f32 v110, v110
    v_exp_f32 v111, v111
    v_add_f32 v104, 1.0, v104
    v_add_f32 v105, 1.0, v105
    v_add_f32 v106, 1.0, v106
    v_add_f32 v107, 1.0, v107
    v_add_f32 v108, 1.0, v108
    v_add_f32 v109, 1.0, v109
    v_add_f32 v110, 1.0, v110
    v_add_f32 v111, 1.0, v111
    v_rcp_f32 v104, v104
    v_rcp_f32 v105, v105
    v_rcp_f32 v106, v106
    v_rcp_f32 v107, v107
    v_rcp_f32 v108, v108
    v_rcp_f32 v109, v109
    v_rcp_f32 v110, v110
    v_rcp_f32 v111, v111
    s_mov_b32 s62, 0
    s_mov_b32 s63, 0x80000000
    s_mov_b64 exec, s[62:63]
    s_lshl_b32 s61, s65, 7
    s_add_u32 s61, s61, 0x805000
    v_mov_b32 v58, 0
    buffer_store_dwordx4 v[104:107], v58, s[48:51], s61 offen sc0 sc1
    buffer_store_dwordx4 v[108:111], v58, s[48:51], s61 offen offset:16 sc0 sc1
    s_mov_b64 exec, -1
    s_lshl_b32 s94, s66, 7
    s_add_u32 s94, s94, 0xe1e000
    s_lshl_b32 s60, s56, 12
    v_subrev_u32 v124, s60, v3
    v_subrev_u32 v125, s60, v4
    v_subrev_u32 v126, s60, v5
    v_subrev_u32 v127, s60, v6
    s_barrier
    ds_read_b128 v[10:13], v3 offset:0
    ds_read_b128 v[14:17], v3 offset:4096
    ds_read_b64_tr_b16 v[18:19], v9 offset:0
    ds_read_b64_tr_b16 v[20:21], v9 offset:512
    ds_read_b64_tr_b16 v[22:23], v9 offset:8192
    ds_read_b64_tr_b16 v[24:25], v9 offset:8704
    ds_read_b128 v[26:29], v4 offset:0
    ds_read_b128 v[30:33], v4 offset:4096
    ds_read_b64_tr_b16 v[34:35], v9 offset:2048
    ds_read_b64_tr_b16 v[36:37], v9 offset:2560
    ds_read_b64_tr_b16 v[38:39], v9 offset:10240
    ds_read_b64_tr_b16 v[40:41], v9 offset:10752
    s_setprio 0
    s_waitcnt lgkmcnt(6)
    v_mfma_f32_32x32x16_bf16 v[60:75], v[18:21], v[10:13], 0
    ds_read_b128 v[42:45], v5 offset:0
    ds_read_b128 v[46:49], v5 offset:4096
    v_mfma_f32_32x32x16_bf16 v[76:91], v[22:25], v[10:13], 0
    ds_read_b64_tr_b16 v[50:51], v9 offset:4096
    ds_read_b64_tr_b16 v[52:53], v9 offset:4608
    v_mfma_f32_32x32x16_bf16 v[92:107], v[18:21], v[14:17], 0
    ds_read_b64_tr_b16 v[54:55], v9 offset:12288
    v_mfma_f32_32x32x16_bf16 v[108:123], v[22:25], v[14:17], 0
    ds_read_b64_tr_b16 v[56:57], v9 offset:12800
    s_waitcnt lgkmcnt(6)
    v_mfma_f32_32x32x16_bf16 v[60:75], v[34:37], v[26:29], v[60:75]
    ds_read_b128 v[10:13], v6 offset:0
    ds_read_b128 v[14:17], v6 offset:4096
    v_mfma_f32_32x32x16_bf16 v[76:91], v[38:41], v[26:29], v[76:91]
    ds_read_b64_tr_b16 v[18:19], v9 offset:6144
    ds_read_b64_tr_b16 v[20:21], v9 offset:6656
    v_mfma_f32_32x32x16_bf16 v[92:107], v[34:37], v[30:33], v[92:107]
    ds_read_b64_tr_b16 v[22:23], v9 offset:14336
    v_mfma_f32_32x32x16_bf16 v[108:123], v[38:41], v[30:33], v[108:123]
    ds_read_b64_tr_b16 v[24:25], v9 offset:14848
    s_waitcnt lgkmcnt(0)
    s_barrier
    v_mfma_f32_32x32x16_bf16 v[60:75], v[50:53], v[42:45], v[60:75]
    ds_read_b128 v[26:29], v3 offset:16384
    ds_read_b128 v[30:33], v3 offset:20480
    v_mfma_f32_32x32x16_bf16 v[76:91], v[54:57], v[42:45], v[76:91]
    ds_read_b64_tr_b16 v[34:35], v9 offset:16384
    ds_read_b64_tr_b16 v[36:37], v9 offset:16896
    v_mfma_f32_32x32x16_bf16 v[92:107], v[50:53], v[46:49], v[92:107]
    ds_read_b64_tr_b16 v[38:39], v9 offset:24576
    v_mfma_f32_32x32x16_bf16 v[108:123], v[54:57], v[46:49], v[108:123]
    ds_read_b64_tr_b16 v[40:41], v9 offset:25088
    v_mfma_f32_32x32x16_bf16 v[60:75], v[18:21], v[10:13], v[60:75]
    ds_read_b128 v[42:45], v4 offset:16384
    ds_read_b128 v[46:49], v4 offset:20480
    v_mfma_f32_32x32x16_bf16 v[76:91], v[22:25], v[10:13], v[76:91]
    ds_read_b64_tr_b16 v[50:51], v9 offset:18432
    ds_read_b64_tr_b16 v[52:53], v9 offset:18944
    v_mfma_f32_32x32x16_bf16 v[92:107], v[18:21], v[14:17], v[92:107]
    ds_read_b64_tr_b16 v[54:55], v9 offset:26624
    v_mfma_f32_32x32x16_bf16 v[108:123], v[22:25], v[14:17], v[108:123]
    ds_read_b64_tr_b16 v[56:57], v9 offset:27136
    s_waitcnt lgkmcnt(6)
    v_mfma_f32_32x32x16_bf16 v[60:75], v[34:37], v[26:29], v[60:75]
    ds_read_b128 v[10:13], v5 offset:16384
    ds_read_b128 v[14:17], v5 offset:20480
    v_mfma_f32_32x32x16_bf16 v[76:91], v[38:41], v[26:29], v[76:91]
    ds_read_b64_tr_b16 v[18:19], v9 offset:20480
    ds_read_b64_tr_b16 v[20:21], v9 offset:20992
    v_mfma_f32_32x32x16_bf16 v[92:107], v[34:37], v[30:33], v[92:107]
    ds_read_b64_tr_b16 v[22:23], v9 offset:28672
    v_mfma_f32_32x32x16_bf16 v[108:123], v[38:41], v[30:33], v[108:123]
    ds_read_b64_tr_b16 v[24:25], v9 offset:29184
    s_waitcnt lgkmcnt(6)
    v_mfma_f32_32x32x16_bf16 v[60:75], v[50:53], v[42:45], v[60:75]
    ds_read_b128 v[26:29], v6 offset:16384
    ds_read_b128 v[30:33], v6 offset:20480
    v_mfma_f32_32x32x16_bf16 v[76:91], v[54:57], v[42:45], v[76:91]
    ds_read_b64_tr_b16 v[34:35], v9 offset:22528
    ds_read_b64_tr_b16 v[36:37], v9 offset:23040
    v_mfma_f32_32x32x16_bf16 v[92:107], v[50:53], v[46:49], v[92:107]
    ds_read_b64_tr_b16 v[38:39], v9 offset:30720
    v_mfma_f32_32x32x16_bf16 v[108:123], v[54:57], v[46:49], v[108:123]
    ds_read_b64_tr_b16 v[40:41], v9 offset:31232
    s_waitcnt vmcnt(0)
    s_waitcnt lgkmcnt(0)
    s_barrier
    s_cmp_eq_u32 s94, 0
    s_cbranch_scc1 pend_6
    s_cmp_lg_u32 s3, 0
    s_cbranch_scc1 pend_6
    s_add_u32 s5, s91, 1
    v_mov_b32 v58, s5
    v_mov_b32 v59, 0
    s_mov_b64 exec, 1
    buffer_store_dword v58, v59, s[48:51], s94 offen sc0 sc1
    s_mov_b64 exec, -1
pend_6:
    v_mfma_f32_32x32x16_bf16 v[60:75], v[18:21], v[10:13], v[60:75]
    ds_read_b128 v[42:45], v3 offset:32768
    ds_read_b128 v[46:49], v3 offset:36864
    v_mfma_f32_32x32x16_bf16 v[76:91], v[22:25], v[10:13], v[76:91]
    ds_read_b64_tr_b16 v[50:51], v9 offset:0
    ds_read_b64_tr_b16 v[52:53], v9 offset:512
    v_mfma_f32_32x32x16_bf16 v[92:107], v[18:21], v[14:17], v[92:107]
    ds_read_b64_tr_b16 v[54:55], v9 offset:8192
    v_mfma_f32_32x32x16_bf16 v[108:123], v[22:25], v[14:17], v[108:123]
    ds_read_b64_tr_b16 v[56:57], v9 offset:8704
    v_mfma_f32_32x32x16_bf16 v[60:75], v[34:37], v[26:29], v[60:75]
    ds_read_b128 v[10:13], v4 offset:32768
    ds_read_b128 v[14:17], v4 offset:36864
    v_mfma_f32_32x32x16_bf16 v[76:91], v[38:41], v[26:29], v[76:91]
    ds_read_b64_tr_b16 v[18:19], v9 offset:2048
    ds_read_b64_tr_b16 v[20:21], v9 offset:2560
    v_mfma_f32_32x32x16_bf16 v[92:107], v[34:37], v[30:33], v[92:107]
    ds_read_b64_tr_b16 v[22:23], v9 offset:10240
    v_mfma_f32_32x32x16_bf16 v[108:123], v[38:41], v[30:33], v[108:123]
    ds_read_b64_tr_b16 v[24:25], v9 offset:10752
    s_waitcnt lgkmcnt(6)
    v_mfma_f32_32x32x16_bf16 v[60:75], v[50:53], v[42:45], v[60:75]
    ds_read_b128 v[26:29], v5 offset:32768
    ds_read_b128 v[30:33], v5 offset:36864
    v_mfma_f32_32x32x16_bf16 v[76:91], v[54:57], v[42:45], v[76:91]
    ds_read_b64_tr_b16 v[34:35], v9 offset:4096
    ds_read_b64_tr_b16 v[36:37], v9 offset:4608
    v_mfma_f32_32x32x16_bf16 v[92:107], v[50:53], v[46:49], v[92:107]
    ds_read_b64_tr_b16 v[38:39], v9 offset:12288
    v_mfma_f32_32x32x16_bf16 v[108:123], v[54:57], v[46:49], v[108:123]
    ds_read_b64_tr_b16 v[40:41], v9 offset:12800
    s_waitcnt lgkmcnt(6)
    v_mfma_f32_32x32x16_bf16 v[60:75], v[18:21], v[10:13], v[60:75]
    ds_read_b128 v[42:45], v6 offset:32768
    ds_read_b128 v[46:49], v6 offset:36864
    v_mfma_f32_32x32x16_bf16 v[76:91], v[22:25], v[10:13], v[76:91]
    ds_read_b64_tr_b16 v[50:51], v9 offset:6144
    ds_read_b64_tr_b16 v[52:53], v9 offset:6656
    v_mfma_f32_32x32x16_bf16 v[92:107], v[18:21], v[14:17], v[92:107]
    ds_read_b64_tr_b16 v[54:55], v9 offset:14336
    v_mfma_f32_32x32x16_bf16 v[108:123], v[22:25], v[14:17], v[108:123]
    ds_read_b64_tr_b16 v[56:57], v9 offset:14848
    s_waitcnt lgkmcnt(0)
    s_barrier
    v_mfma_f32_32x32x16_bf16 v[60:75], v[34:37], v[26:29], v[60:75]
    ds_read_b128 v[10:13], v3 offset:0
    ds_read_b128 v[14:17], v3 offset:4096
    v_mfma_f32_32x32x16_bf16 v[76:91], v[38:41], v[26:29], v[76:91]
    ds_read_b64_tr_b16 v[18:19], v9 offset:16384
    ds_read_b64_tr_b16 v[20:21], v9 offset:16896
    v_mfma_f32_32x32x16_bf16 v[92:107], v[34:37], v[30:33], v[92:107]
    ds_read_b64_tr_b16 v[22:23], v9 offset:24576
    v_mfma_f32_32x32x16_bf16 v[108:123], v[38:41], v[30:33], v[108:123]
    ds_read_b64_tr_b16 v[24:25], v9 offset:25088
    v_mfma_f32_32x32x16_bf16 v[60:75], v[50:53], v[42:45], v[60:75]
    ds_read_b128 v[26:29], v4 offset:0
    ds_read_b128 v[30:33], v4 offset:4096
    v_mfma_f32_32x32x16_bf16 v[76:91], v[54:57], v[42:45], v[76:91]
    ds_read_b64_tr_b16 v[34:35], v9 offset:18432
    ds_read_b64_tr_b16 v[36:37], v9 offset:18944
    v_mfma_f32_32x32x16_bf16 v[92:107], v[50:53], v[46:49], v[92:107]
    ds_read_b64_tr_b16 v[38:39], v9 offset:26624
    v_mfma_f32_32x32x16_bf16 v[108:123], v[54:57], v[46:49], v[108:123]
    ds_read_b64_tr_b16 v[40:41], v9 offset:27136
    s_waitcnt lgkmcnt(6)
    v_mfma_f32_32x32x16_bf16 v[60:75], v[18:21], v[10:13], v[60:75]
    ds_read_b128 v[42:45], v5 offset:0
    ds_read_b128 v[46:49], v5 offset:4096
    v_mfma_f32_32x32x16_bf16 v[76:91], v[22:25], v[10:13], v[76:91]
    ds_read_b64_tr_b16 v[50:51], v9 offset:20480
    ds_read_b64_tr_b16 v[52:53], v9 offset:20992
    v_mfma_f32_32x32x16_bf16 v[92:107], v[18:21], v[14:17], v[92:107]
    ds_read_b64_tr_b16 v[54:55], v9 offset:28672
    v_mfma_f32_32x32x16_bf16 v[108:123], v[22:25], v[14:17], v[108:123]
    ds_read_b64_tr_b16 v[56:57], v9 offset:29184
    s_waitcnt lgkmcnt(6)
    v_mfma_f32_32x32x16_bf16 v[60:75], v[34:37], v[26:29], v[60:75]
    ds_read_b128 v[10:13], v6 offset:0
    ds_read_b128 v[14:17], v6 offset:4096
    v_mfma_f32_32x32x16_bf16 v[76:91], v[38:41], v[26:29], v[76:91]
    ds_read_b64_tr_b16 v[18:19], v9 offset:22528
    ds_read_b64_tr_b16 v[20:21], v9 offset:23040
    v_mfma_f32_32x32x16_bf16 v[92:107], v[34:37], v[30:33], v[92:107]
    ds_read_b64_tr_b16 v[22:23], v9 offset:30720
    v_mfma_f32_32x32x16_bf16 v[108:123], v[38:41], v[30:33], v[108:123]
    ds_read_b64_tr_b16 v[24:25], v9 offset:31232
    s_waitcnt lgkmcnt(0)
    s_barrier
    v_mfma_f32_32x32x16_bf16 v[60:75], v[50:53], v[42:45], v[60:75]
    ds_read_b128 v[26:29], v3 offset:16384
    ds_read_b128 v[30:33], v3 offset:20480
    v_mfma_f32_32x32x16_bf16 v[76:91], v[54:57], v[42:45], v[76:91]
    ds_read_b64_tr_b16 v[34:35], v9 offset:0
    ds_read_b64_tr_b16 v[36:37], v9 offset:512
    v_mfma_f32_32x32x16_bf16 v[92:107], v[50:53], v[46:49], v[92:107]
    ds_read_b64_tr_b16 v[38:39], v9 offset:8192
    v_mfma_f32_32x32x16_bf16 v[108:123], v[54:57], v[46:49], v[108:123]
    ds_read_b64_tr_b16 v[40:41], v9 offset:8704
    v_mfma_f32_32x32x16_bf16 v[60:75], v[18:21], v[10:13], v[60:75]
    ds_read_b128 v[42:45], v4 offset:16384
    ds_read_b128 v[46:49], v4 offset:20480
    v_mfma_f32_32x32x16_bf16 v[76:91], v[22:25], v[10:13], v[76:91]
    ds_read_b64_tr_b16 v[50:51], v9 offset:2048
    ds_read_b64_tr_b16 v[52:53], v9 offset:2560
    v_mfma_f32_32x32x16_bf16 v[92:107], v[18:21], v[14:17], v[92:107]
    ds_read_b64_tr_b16 v[54:55], v9 offset:10240
    v_mfma_f32_32x32x16_bf16 v[108:123], v[22:25], v[14:17], v[108:123]
    ds_read_b64_tr_b16 v[56:57], v9 offset:10752
    s_waitcnt lgkmcnt(6)
    v_mfma_f32_32x32x16_bf16 v[60:75], v[34:37], v[26:29], v[60:75]
    ds_read_b128 v[10:13], v5 offset:16384
    ds_read_b128 v[14:17], v5 offset:20480
    v_mfma_f32_32x32x16_bf16 v[76:91], v[38:41], v[26:29], v[76:91]
    ds_read_b64_tr_b16 v[18:19], v9 offset:4096
    ds_read_b64_tr_b16 v[20:21], v9 offset:4608
    v_mfma_f32_32x32x16_bf16 v[92:107], v[34:37], v[30:33], v[92:107]
    ds_read_b64_tr_b16 v[22:23], v9 offset:12288
    v_mfma_f32_32x32x16_bf16 v[108:123], v[38:41], v[30:33], v[108:123]
    ds_read_b64_tr_b16 v[24:25], v9 offset:12800
    s_waitcnt lgkmcnt(6)
    v_mfma_f32_32x32x16_bf16 v[60:75], v[50:53], v[42:45], v[60:75]
    ds_read_b128 v[26:29], v6 offset:16384
    ds_read_b128 v[30:33], v6 offset:20480
    v_mfma_f32_32x32x16_bf16 v[76:91], v[54:57], v[42:45], v[76:91]
    ds_read_b64_tr_b16 v[34:35], v9 offset:6144
    ds_read_b64_tr_b16 v[36:37], v9 offset:6656
    v_mfma_f32_32x32x16_bf16 v[92:107], v[50:53], v[46:49], v[92:107]
    ds_read_b64_tr_b16 v[38:39], v9 offset:14336
    v_mfma_f32_32x32x16_bf16 v[108:123], v[54:57], v[46:49], v[108:123]
    ds_read_b64_tr_b16 v[40:41], v9 offset:14848
    s_waitcnt lgkmcnt(0)
    s_barrier
    v_mfma_f32_32x32x16_bf16 v[60:75], v[18:21], v[10:13], v[60:75]
    ds_read_b128 v[42:45], v3 offset:32768
    ds_read_b128 v[46:49], v3 offset:36864
    v_mfma_f32_32x32x16_bf16 v[76:91], v[22:25], v[10:13], v[76:91]
    ds_read_b64_tr_b16 v[50:51], v9 offset:16384
    ds_read_b64_tr_b16 v[52:53], v9 offset:16896
    v_mfma_f32_32x32x16_bf16 v[92:107], v[18:21], v[14:17], v[92:107]
    ds_read_b64_tr_b16 v[54:55], v9 offset:24576
    v_mfma_f32_32x32x16_bf16 v[108:123], v[22:25], v[14:17], v[108:123]
    ds_read_b64_tr_b16 v[56:57], v9 offset:25088
    v_mfma_f32_32x32x16_bf16 v[60:75], v[34:37], v[26:29], v[60:75]
    ds_read_b128 v[10:13], v4 offset:32768
    ds_read_b128 v[14:17], v4 offset:36864
    v_mfma_f32_32x32x16_bf16 v[76:91], v[38:41], v[26:29], v[76:91]
    ds_read_b64_tr_b16 v[18:19], v9 offset:18432
    ds_read_b64_tr_b16 v[20:21], v9 offset:18944
    v_mfma_f32_32x32x16_bf16 v[92:107], v[34:37], v[30:33], v[92:107]
    ds_read_b64_tr_b16 v[22:23], v9 offset:26624
    v_mfma_f32_32x32x16_bf16 v[108:123], v[38:41], v[30:33], v[108:123]
    ds_read_b64_tr_b16 v[24:25], v9 offset:27136
    s_waitcnt lgkmcnt(6)
    v_mfma_f32_32x32x16_bf16 v[60:75], v[50:53], v[42:45], v[60:75]
    ds_read_b128 v[26:29], v5 offset:32768
    ds_read_b128 v[30:33], v5 offset:36864
    v_mfma_f32_32x32x16_bf16 v[76:91], v[54:57], v[42:45], v[76:91]
    ds_read_b64_tr_b16 v[34:35], v9 offset:20480
    ds_read_b64_tr_b16 v[36:37], v9 offset:20992
    v_mfma_f32_32x32x16_bf16 v[92:107], v[50:53], v[46:49], v[92:107]
    ds_read_b64_tr_b16 v[38:39], v9 offset:28672
    v_mfma_f32_32x32x16_bf16 v[108:123], v[54:57], v[46:49], v[108:123]
    ds_read_b64_tr_b16 v[40:41], v9 offset:29184
    s_waitcnt lgkmcnt(6)
    v_mfma_f32_32x32x16_bf16 v[60:75], v[18:21], v[10:13], v[60:75]
    ds_read_b128 v[42:45], v6 offset:32768
    ds_read_b128 v[46:49], v6 offset:36864
    v_mfma_f32_32x32x16_bf16 v[76:91], v[22:25], v[10:13], v[76:91]
    ds_read_b64_tr_b16 v[50:51], v9 offset:22528
    ds_read_b64_tr_b16 v[52:53], v9 offset:23040
    v_mfma_f32_32x32x16_bf16 v[92:107], v[18:21], v[14:17], v[92:107]
    ds_read_b64_tr_b16 v[54:55], v9 offset:30720
    v_mfma_f32_32x32x16_bf16 v[108:123], v[22:25], v[14:17], v[108:123]
    ds_read_b64_tr_b16 v[56:57], v9 offset:31232
    s_waitcnt lgkmcnt(0)
    s_barrier
    v_mfma_f32_32x32x16_bf16 v[60:75], v[34:37], v[26:29], v[60:75]
    ds_read_b128 v[10:13], v3 offset:0
    ds_read_b128 v[14:17], v3 offset:4096
    v_mfma_f32_32x32x16_bf16 v[76:91], v[38:41], v[26:29], v[76:91]
    ds_read_b64_tr_b16 v[18:19], v9 offset:0
    ds_read_b64_tr_b16 v[20:21], v9 offset:512
    v_mfma_f32_32x32x16_bf16 v[92:107], v[34:37], v[30:33], v[92:107]
    ds_read_b64_tr_b16 v[22:23], v9 offset:8192
    v_mfma_f32_32x32x16_bf16 v[108:123], v[38:41], v[30:33], v[108:123]
    ds_read_b64_tr_b16 v[24:25], v9 offset:8704
    v_mfma_f32_32x32x16_bf16 v[60:75], v[50:53], v[42:45], v[60:75]
    ds_read_b128 v[26:29], v4 offset:0
    ds_read_b128 v[30:33], v4 offset:4096
    v_mfma_f32_32x32x16_bf16 v[76:91], v[54:57], v[42:45], v[76:91]
    ds_read_b64_tr_b16 v[34:35], v9 offset:2048
    ds_read_b64_tr_b16 v[36:37], v9 offset:2560
    v_mfma_f32_32x32x16_bf16 v[92:107], v[50:53], v[46:49], v[92:107]
    ds_read_b64_tr_b16 v[38:39], v9 offset:10240
    v_mfma_f32_32x32x16_bf16 v[108:123], v[54:57], v[46:49], v[108:123]
    ds_read_b64_tr_b16 v[40:41], v9 offset:10752
    s_waitcnt lgkmcnt(6)
    v_mfma_f32_32x32x16_bf16 v[60:75], v[18:21], v[10:13], v[60:75]
    ds_read_b128 v[42:45], v5 offset:0
    ds_read_b128 v[46:49], v5 offset:4096
    v_mfma_f32_32x32x16_bf16 v[76:91], v[22:25], v[10:13], v[76:91]
    ds_read_b64_tr_b16 v[50:51], v9 offset:4096
    ds_read_b64_tr_b16 v[52:53], v9 offset:4608
    v_mfma_f32_32x32x16_bf16 v[92:107], v[18:21], v[14:17], v[92:107]
    ds_read_b64_tr_b16 v[54:55], v9 offset:12288
    v_mfma_f32_32x32x16_bf16 v[108:123], v[22:25], v[14:17], v[108:123]
    ds_read_b64_tr_b16 v[56:57], v9 offset:12800
    s_waitcnt lgkmcnt(6)
    v_mfma_f32_32x32x16_bf16 v[60:75], v[34:37], v[26:29], v[60:75]
    ds_read_b128 v[10:13], v6 offset:0
    ds_read_b128 v[14:17], v6 offset:4096
    v_mfma_f32_32x32x16_bf16 v[76:91], v[38:41], v[26:29], v[76:91]
    ds_read_b64_tr_b16 v[18:19], v9 offset:6144
    ds_read_b64_tr_b16 v[20:21], v9 offset:6656
    v_mfma_f32_32x32x16_bf16 v[92:107], v[34:37], v[30:33], v[92:107]
    ds_read_b64_tr_b16 v[22:23], v9 offset:14336
    v_mfma_f32_32x32x16_bf16 v[108:123], v[38:41], v[30:33], v[108:123]
    ds_read_b64_tr_b16 v[24:25], v9 offset:14848
    s_waitcnt lgkmcnt(0)
    s_barrier
    v_mfma_f32_32x32x16_bf16 v[60:75], v[50:53], v[42:45], v[60:75]
    ds_read_b128 v[26:29], v3 offset:16384
    ds_read_b128 v[30:33], v3 offset:20480
    v_mfma_f32_32x32x16_bf16 v[76:91], v[54:57], v[42:45], v[76:91]
    ds_read_b64_tr_b16 v[34:35], v9 offset:16384
    ds_read_b64_tr_b16 v[36:37], v9 offset:16896
    v_mfma_f32_32x32x16_bf16 v[92:107], v[50:53], v[46:49], v[92:107]
    ds_read_b64_tr_b16 v[38:39], v9 offset:24576
    v_mfma_f32_32x32x16_bf16 v[108:123], v[54:57], v[46:49], v[108:123]
    ds_read_b64_tr_b16 v[40:41], v9 offset:25088
    v_mfma_f32_32x32x16_bf16 v[60:75], v[18:21], v[10:13], v[60:75]
    ds_read_b128 v[42:45], v4 offset:16384
    ds_read_b128 v[46:49], v4 offset:20480
    v_mfma_f32_32x32x16_bf16 v[76:91], v[22:25], v[10:13], v[76:91]
    ds_read_b64_tr_b16 v[50:51], v9 offset:18432
    ds_read_b64_tr_b16 v[52:53], v9 offset:18944
    v_mfma_f32_32x32x16_bf16 v[92:107], v[18:21], v[14:17], v[92:107]
    ds_read_b64_tr_b16 v[54:55], v9 offset:26624
    v_mfma_f32_32x32x16_bf16 v[108:123], v[22:25], v[14:17], v[108:123]
    ds_read_b64_tr_b16 v[56:57], v9 offset:27136
    s_waitcnt lgkmcnt(6)
    v_mfma_f32_32x32x16_bf16 v[60:75], v[34:37], v[26:29], v[60:75]
    ds_read_b128 v[10:13], v5 offset:16384
    ds_read_b128 v[14:17], v5 offset:20480
    v_mfma_f32_32x32x16_bf16 v[76:91], v[38:41], v[26:29], v[76:91]
    ds_read_b64_tr_b16 v[18:19], v9 offset:20480
    ds_read_b64_tr_b16 v[20:21], v9 offset:20992
    v_mfma_f32_32x32x16_bf16 v[92:107], v[34:37], v[30:33], v[92:107]
    ds_read_b64_tr_b16 v[22:23], v9 offset:28672
    v_mfma_f32_32x32x16_bf16 v[108:123], v[38:41], v[30:33], v[108:123]
    ds_read_b64_tr_b16 v[24:25], v9 offset:29184
    s_waitcnt lgkmcnt(6)
    v_mfma_f32_32x32x16_bf16 v[60:75], v[50:53], v[42:45], v[60:75]
    ds_read_b128 v[26:29], v6 offset:16384
    ds_read_b128 v[30:33], v6 offset:20480
    v_mfma_f32_32x32x16_bf16 v[76:91], v[54:57], v[42:45], v[76:91]
    ds_read_b64_tr_b16 v[34:35], v9 offset:22528
    ds_read_b64_tr_b16 v[36:37], v9 offset:23040
    v_mfma_f32_32x32x16_bf16 v[92:107], v[50:53], v[46:49], v[92:107]
    ds_read_b64_tr_b16 v[38:39], v9 offset:30720
    v_mfma_f32_32x32x16_bf16 v[108:123], v[54:57], v[46:49], v[108:123]
    ds_read_b64_tr_b16 v[40:41], v9 offset:31232
    s_waitcnt lgkmcnt(0)
    s_barrier
    v_mfma_f32_32x32x16_bf16 v[60:75], v[18:21], v[10:13], v[60:75]
    v_mfma_f32_32x32x16_bf16 v[76:91], v[22:25], v[10:13], v[76:91]
    v_mfma_f32_32x32x16_bf16 v[92:107], v[18:21], v[14:17], v[92:107]
    v_mfma_f32_32x32x16_bf16 v[108:123], v[22:25], v[14:17], v[108:123]
    v_mfma_f32_32x32x16_bf16 v[60:75], v[34:37], v[26:29], v[60:75]
    ds_read_b128 v[10:13], v3 offset:0
    ds_read_b128 v[14:17], v3 offset:4096
    v_mfma_f32_32x32x16_bf16 v[76:91], v[38:41], v[26:29], v[76:91]
    ds_read_b64_tr_b16 v[18:19], v9 offset:0
    ds_read_b64_tr_b16 v[20:21], v9 offset:512
    v_mfma_f32_32x32x16_bf16 v[92:107], v[34:37], v[30:33], v[92:107]
    ds_read_b64_tr_b16 v[22:23], v9 offset:8192
    v_mfma_f32_32x32x16_bf16 v[108:123], v[38:41], v[30:33], v[108:123]
    ds_read_b64_tr_b16 v[24:25], v9 offset:8704
    ds_read_b128 v[26:29], v4 offset:0
    ds_read_b128 v[30:33], v4 offset:4096
    ds_read_b64_tr_b16 v[34:35], v9 offset:2048
    ds_read_b64_tr_b16 v[36:37], v9 offset:2560
    ds_read_b64_tr_b16 v[38:39], v9 offset:10240
    ds_read_b64_tr_b16 v[40:41], v9 offset:10752
    s_setprio 3
    s_lshl_b32 s62, s38, 2
    s_lshl_b32 s63, s56, 1
    s_add_u32 s62, s62, s63
    s_lshl_b32 s60, s92, 1
    s_add_u32 s60, s60, s57
    s_mul_i32 s62, s62, 89
    s_cmp_ge_u32 s60, 43
    s_cselect_b32 s64, 0, 1.0
    s_lshl_b32 s60, s60, 1
    s_add_u32 s60, s60, s62
    s_lshl_b32 s60, s60, 10
    s_add_u32 s65, s60, 0x80e000
    v_lshlrev_b32 v1, 4, v0
    v_mul_f32 v42, 0xbfb8aa3b, v60
    v_mul_f32 v43, 0xbfb8aa3b, v61
    v_mul_f32 v44, 0xbfb8aa3b, v62
    v_mul_f32 v45, 0xbfb8aa3b, v63
    v_mul_f32 v46, 0xbfb8aa3b, v64
    v_mul_f32 v47, 0xbfb8aa3b, v65
    v_mul_f32 v48, 0xbfb8aa3b, v66
    v_mul_f32 v49, 0xbfb8aa3b, v67
    v_exp_f32 v42, v42
    v_exp_f32 v43, v43
    v_exp_f32 v44, v44
    v_exp_f32 v45, v45
    v_exp_f32 v46, v46
    v_exp_f32 v47, v47
    v_exp_f32 v48, v48
    v_exp_f32 v49, v49
    v_mul_f32 v76, v60, v76
    v_mul_f32 v77, v61, v77
    v_mul_f32 v78, v62, v78
    v_mul_f32 v79, v63, v79
    v_mul_f32 v80, v64, v80
    v_mul_f32 v81, v65, v81
    v_mul_f32 v82, v66, v82
    v_mul_f32 v83, v67, v83
    v_add_f32 v42, 1.0, v42
    v_add_f32 v43, 1.0, v43
    v_add_f32 v44, 1.0, v44
    v_add_f32 v45, 1.0, v45
    v_add_f32 v46, 1.0, v46
    v_add_f32 v47, 1.0, v47
    v_add_f32 v48, 1.0, v48
    v_add_f32 v49, 1.0, v49
    v_rcp_f32 v42, v42
    v_rcp_f32 v43, v43
    v_rcp_f32 v44, v44
    v_rcp_f32 v45, v45
    v_rcp_f32 v46, v46
    v_rcp_f32 v47, v47
    v_rcp_f32 v48, v48
    v_rcp_f32 v49, v49
    v_mul_f32 v76, s64, v76
    v_mul_f32 v77, s64, v77
    v_mul_f32 v78, s64, v78
    v_mul_f32 v79, s64, v79
    v_mul_f32 v80, s64, v80
    v_mul_f32 v81, s64, v81
    v_mul_f32 v82, s64, v82
    v_mul_f32 v83, s64, v83
    v_mul_f32 v76, v76, v42
    v_mul_f32 v77, v77, v43
    v_mul_f32 v78, v78, v44
    v_mul_f32 v79, v79, v45
    v_mul_f32 v80, v80, v46
    v_mul_f32 v81, v81, v47
    v_mul_f32 v82, v82, v48
    v_mul_f32 v83, v83, v49
    v_cvt_pk_bf16_f32 v76, v76, v77
    v_cvt_pk_bf16_f32 v77, v78, v79
    v_cvt_pk_bf16_f32 v78, v80, v81
    v_cvt_pk_bf16_f32 v79, v82, v83
    s_add_u32 s63, s65, 0
    buffer_store_dwordx4 v[76:79], v1, s[48:51], s63 offen sc0 sc1
    v_mul_f32 v42, 0xbfb8aa3b, v68
    v_mul_f32 v43, 0xbfb8aa3b, v69
    v_mul_f32 v44, 0xbfb8aa3b, v70
    v_mul_f32 v45, 0xbfb8aa3b, v71
    v_mul_f32 v46, 0xbfb8aa3b, v72
    v_mul_f32 v47, 0xbfb8aa3b, v73
    v_mul_f32 v48, 0xbfb8aa3b, v74
    v_mul_f32 v49, 0xbfb8aa3b, v75
    v_exp_f32 v42, v42
    v_exp_f32 v43, v43
    v_exp_f32 v44, v44
    v_exp_f32 v45, v45
    v_exp_f32 v46, v46
    v_exp_f32 v47, v47
    v_exp_f32 v48, v48
    v_exp_f32 v49, v49
    v_mul_f32 v84, v68, v84
    v_mul_f32 v85, v69, v85
    v_mul_f32 v86, v70, v86
    v_mul_f32 v87, v71, v87
    v_mul_f32 v88, v72, v88
    v_mul_f32 v89, v73, v89
    v_mul_f32 v90, v74, v90
    v_mul_f32 v91, v75, v91
    v_add_f32 v42, 1.0, v42
    v_add_f32 v43, 1.0, v43
    v_add_f32 v44, 1.0, v44
    v_add_f32 v45, 1.0, v45
    v_add_f32 v46, 1.0, v46
    v_add_f32 v47, 1.0, v47
    v_add_f32 v48, 1.0, v48
    v_add_f32 v49, 1.0, v49
    v_rcp_f32 v42, v42
    v_rcp_f32 v43, v43
    v_rcp_f32 v44, v44
    v_rcp_f32 v45, v45
    v_rcp_f32 v46, v46
    v_rcp_f32 v47, v47
    v_rcp_f32 v48, v48
    v_rcp_f32 v49, v49
    v_mul_f32 v84, s64, v84
    v_mul_f32 v85, s64, v85
    v_mul_f32 v86, s64, v86
    v_mul_f32 v87, s64, v87
    v_mul_f32 v88, s64, v88
    v_mul_f32 v89, s64, v89
    v_mul_f32 v90, s64, v90
    v_mul_f32 v91, s64, v91
    v_mul_f32 v84, v84, v42
    v_mul_f32 v85, v85, v43
    v_mul_f32 v86, v86, v44
    v_mul_f32 v87, v87, v45
    v_mul_f32 v88, v88, v46
    v_mul_f32 v89, v89, v47
    v_mul_f32 v90, v90, v48
    v_mul_f32 v91, v91, v49
    v_cvt_pk_bf16_f32 v84, v84, v85
    v_cvt_pk_bf16_f32 v85, v86, v87
    v_cvt_pk_bf16_f32 v86, v88, v89
    v_cvt_pk_bf16_f32 v87, v90, v91
    s_add_u32 s63, s65, 1024
    buffer_store_dwordx4 v[84:87], v1, s[48:51], s63 offen sc0 sc1
    v_mul_f32 v42, 0xbfb8aa3b, v92
    v_mul_f32 v43, 0xbfb8aa3b, v93
    v_mul_f32 v44, 0xbfb8aa3b, v94
    v_mul_f32 v45, 0xbfb8aa3b, v95
    v_mul_f32 v46, 0xbfb8aa3b, v96
    v_mul_f32 v47, 0xbfb8aa3b, v97
    v_mul_f32 v48, 0xbfb8aa3b, v98
    v_mul_f32 v49, 0xbfb8aa3b, v99
    v_exp_f32 v42, v42
    v_exp_f32 v43, v43
    v_exp_f32 v44, v44
    v_exp_f32 v45, v45
    v_exp_f32 v46, v46
    v_exp_f32 v47, v47
    v_exp_f32 v48, v48
    v_exp_f32 v49, v49
    v_mul_f32 v108, v92, v108
    v_mul_f32 v109, v93, v109
    v_mul_f32 v110, v94, v110
    v_mul_f32 v111, v95, v111
    v_mul_f32 v112, v96, v112
    v_mul_f32 v113, v97, v113
    v_mul_f32 v114, v98, v114
    v_mul_f32 v115, v99, v115
    v_add_f32 v42, 1.0, v42
    v_add_f32 v43, 1.0, v43
    v_add_f32 v44, 1.0, v44
    v_add_f32 v45, 1.0, v45
    v_add_f32 v46, 1.0, v46
    v_add_f32 v47, 1.0, v47
    v_add_f32 v48, 1.0, v48
    v_add_f32 v49, 1.0, v49
    v_rcp_f32 v42, v42
    v_rcp_f32 v43, v43
    v_rcp_f32 v44, v44
    v_rcp_f32 v45, v45
    v_rcp_f32 v46, v46
    v_rcp_f32 v47, v47
    v_rcp_f32 v48, v48
    v_rcp_f32 v49, v49
    v_mul_f32 v108, s64, v108
    v_mul_f32 v109, s64, v109
    v_mul_f32 v110, s64, v110
    v_mul_f32 v111, s64, v111
    v_mul_f32 v112, s64, v112
    v_mul_f32 v113, s64, v113
    v_mul_f32 v114, s64, v114
    v_mul_f32 v115, s64, v115
    v_mul_f32 v108, v108, v42
    v_mul_f32 v109, v109, v43
    v_mul_f32 v110, v110, v44
    v_mul_f32 v111, v111, v45
    v_mul_f32 v112, v112, v46
    v_mul_f32 v113, v113, v47
    v_mul_f32 v114, v114, v48
    v_mul_f32 v115, v115, v49
    v_cvt_pk_bf16_f32 v108, v108, v109
    v_cvt_pk_bf16_f32 v109, v110, v111
    v_cvt_pk_bf16_f32 v110, v112, v113
    v_cvt_pk_bf16_f32 v111, v114, v115
    s_add_u32 s63, s65, 91136
    buffer_store_dwordx4 v[108:111], v1, s[48:51], s63 offen sc0 sc1
    v_mul_f32 v42, 0xbfb8aa3b, v100
    v_mul_f32 v43, 0xbfb8aa3b, v101
    v_mul_f32 v44, 0xbfb8aa3b, v102
    v_mul_f32 v45, 0xbfb8aa3b, v103
    v_mul_f32 v46, 0xbfb8aa3b, v104
    v_mul_f32 v47, 0xbfb8aa3b, v105
    v_mul_f32 v48, 0xbfb8aa3b, v106
    v_mul_f32 v49, 0xbfb8aa3b, v107
    v_exp_f32 v42, v42
    v_exp_f32 v43, v43
    v_exp_f32 v44, v44
    v_exp_f32 v45, v45
    v_exp_f32 v46, v46
    v_exp_f32 v47, v47
    v_exp_f32 v48, v48
    v_exp_f32 v49, v49
    v_mul_f32 v116, v100, v116
    v_mul_f32 v117, v101, v117
    v_mul_f32 v118, v102, v118
    v_mul_f32 v119, v103, v119
    v_mul_f32 v120, v104, v120
    v_mul_f32 v121, v105, v121
    v_mul_f32 v122, v106, v122
    v_mul_f32 v123, v107, v123
    v_add_f32 v42, 1.0, v42
    v_add_f32 v43, 1.0, v43
    v_add_f32 v44, 1.0, v44
    v_add_f32 v45, 1.0, v45
    v_add_f32 v46, 1.0, v46
    v_add_f32 v47, 1.0, v47
    v_add_f32 v48, 1.0, v48
    v_add_f32 v49, 1.0, v49
    v_rcp_f32 v42, v42
    v_rcp_f32 v43, v43
    v_rcp_f32 v44, v44
    v_rcp_f32 v45, v45
    v_rcp_f32 v46, v46
    v_rcp_f32 v47, v47
    v_rcp_f32 v48, v48
    v_rcp_f32 v49, v49
    v_mul_f32 v116, s64, v116
    v_mul_f32 v117, s64, v117
    v_mul_f32 v118, s64, v118
    v_mul_f32 v119, s64, v119
    v_mul_f32 v120, s64, v120
    v_mul_f32 v121, s64, v121
    v_mul_f32 v122, s64, v122
    v_mul_f32 v123, s64, v123
    v_mul_f32 v116, v116, v42
    v_mul_f32 v117, v117, v43
    v_mul_f32 v118, v118, v44
    v_mul_f32 v119, v119, v45
    v_mul_f32 v120, v120, v46
    v_mul_f32 v121, v121, v47
    v_mul_f32 v122, v122, v48
    v_mul_f32 v123, v123, v49
    v_cvt_pk_bf16_f32 v116, v116, v117
    v_cvt_pk_bf16_f32 v117, v118, v119
    v_cvt_pk_bf16_f32 v118, v120, v121
    v_cvt_pk_bf16_f32 v119, v122, v123
    s_add_u32 s63, s65, 92160
    buffer_store_dwordx4 v[116:119], v1, s[48:51], s63 offen sc0 sc1
    s_lshl_b32 s64, s38, 5
    s_add_u32 s64, s64, s92
    s_lshl_b32 s94, s64, 7
    s_add_u32 s94, s94, 0xe06000
    s_add_u32 s92, s92, 1
    s_setprio 0
    s_waitcnt lgkmcnt(6)
    v_mfma_f32_32x32x16_bf16 v[60:75], v[18:21], v[10:13], 0
    ds_read_b128 v[42:45], v5 offset:0
    ds_read_b128 v[46:49], v5 offset:4096
    v_mfma_f32_32x32x16_bf16 v[76:91], v[22:25], v[10:13], 0
    ds_read_b64_tr_b16 v[50:51], v9 offset:4096
    ds_read_b64_tr_b16 v[52:53], v9 offset:4608
    v_mfma_f32_32x32x16_bf16 v[92:107], v[18:21], v[14:17], 0
    ds_read_b64_tr_b16 v[54:55], v9 offset:12288
    v_mfma_f32_32x32x16_bf16 v[108:123], v[22:25], v[14:17], 0
    ds_read_b64_tr_b16 v[56:57], v9 offset:12800
    s_waitcnt lgkmcnt(6)
    v_mfma_f32_32x32x16_bf16 v[60:75], v[34:37], v[26:29], v[60:75]
    ds_read_b128 v[10:13], v6 offset:0
    ds_read_b128 v[14:17], v6 offset:4096
    v_mfma_f32_32x32x16_bf16 v[76:91], v[38:41], v[26:29], v[76:91]
    ds_read_b64_tr_b16 v[18:19], v9 offset:6144
    ds_read_b64_tr_b16 v[20:21], v9 offset:6656
    v_mfma_f32_32x32x16_bf16 v[92:107], v[34:37], v[30:33], v[92:107]
    ds_read_b64_tr_b16 v[22:23], v9 offset:14336
    v_mfma_f32_32x32x16_bf16 v[108:123], v[38:41], v[30:33], v[108:123]
    ds_read_b64_tr_b16 v[24:25], v9 offset:14848
    s_waitcnt lgkmcnt(0)
    s_barrier
    v_mfma_f32_32x32x16_bf16 v[60:75], v[50:53], v[42:45], v[60:75]
    ds_read_b128 v[26:29], v3 offset:16384
    ds_read_b128 v[30:33], v3 offset:20480
    v_mfma_f32_32x32x16_bf16 v[76:91], v[54:57], v[42:45], v[76:91]
    ds_read_b64_tr_b16 v[34:35], v9 offset:16384
    ds_read_b64_tr_b16 v[36:37], v9 offset:16896
    v_mfma_f32_32x32x16_bf16 v[92:107], v[50:53], v[46:49], v[92:107]
    ds_read_b64_tr_b16 v[38:39], v9 offset:24576
    v_mfma_f32_32x32x16_bf16 v[108:123], v[54:57], v[46:49], v[108:123]
    ds_read_b64_tr_b16 v[40:41], v9 offset:25088
    v_mfma_f32_32x32x16_bf16 v[60:75], v[18:21], v[10:13], v[60:75]
    ds_read_b128 v[42:45], v4 offset:16384
    ds_read_b128 v[46:49], v4 offset:20480
    v_mfma_f32_32x32x16_bf16 v[76:91], v[22:25], v[10:13], v[76:91]
    ds_read_b64_tr_b16 v[50:51], v9 offset:18432
    ds_read_b64_tr_b16 v[52:53], v9 offset:18944
    v_mfma_f32_32x32x16_bf16 v[92:107], v[18:21], v[14:17], v[92:107]
    ds_read_b64_tr_b16 v[54:55], v9 offset:26624
    v_mfma_f32_32x32x16_bf16 v[108:123], v[22:25], v[14:17], v[108:123]
    ds_read_b64_tr_b16 v[56:57], v9 offset:27136
    s_waitcnt lgkmcnt(6)
    v_mfma_f32_32x32x16_bf16 v[60:75], v[34:37], v[26:29], v[60:75]
    ds_read_b128 v[10:13], v5 offset:16384
    ds_read_b128 v[14:17], v5 offset:20480
    v_mfma_f32_32x32x16_bf16 v[76:91], v[38:41], v[26:29], v[76:91]
    ds_read_b64_tr_b16 v[18:19], v9 offset:20480
    ds_read_b64_tr_b16 v[20:21], v9 offset:20992
    v_mfma_f32_32x32x16_bf16 v[92:107], v[34:37], v[30:33], v[92:107]
    ds_read_b64_tr_b16 v[22:23], v9 offset:28672
    v_mfma_f32_32x32x16_bf16 v[108:123], v[38:41], v[30:33], v[108:123]
    ds_read_b64_tr_b16 v[24:25], v9 offset:29184
    s_waitcnt lgkmcnt(6)
    v_mfma_f32_32x32x16_bf16 v[60:75], v[50:53], v[42:45], v[60:75]
    ds_read_b128 v[26:29], v6 offset:16384
    ds_read_b128 v[30:33], v6 offset:20480
    v_mfma_f32_32x32x16_bf16 v[76:91], v[54:57], v[42:45], v[76:91]
    ds_read_b64_tr_b16 v[34:35], v9 offset:22528
    ds_read_b64_tr_b16 v[36:37], v9 offset:23040
    v_mfma_f32_32x32x16_bf16 v[92:107], v[50:53], v[46:49], v[92:107]
    ds_read_b64_tr_b16 v[38:39], v9 offset:30720
    v_mfma_f32_32x32x16_bf16 v[108:123], v[54:57], v[46:49], v[108:123]
    ds_read_b64_tr_b16 v[40:41], v9 offset:31232
    s_waitcnt vmcnt(0)
    s_waitcnt lgkmcnt(0)
    s_barrier
    s_cmp_eq_u32 s94, 0
    s_cbranch_scc1 pend_7
    s_cmp_lg_u32 s3, 0
    s_cbranch_scc1 pend_7
    s_add_u32 s5, s91, 1
    v_mov_b32 v58, s5
    v_mov_b32 v59, 0
    s_mov_b64 exec, 1
    buffer_store_dword v58, v59, s[48:51], s94 offen sc0 sc1
    s_mov_b64 exec, -1
pend_7:
    v_mfma_f32_32x32x16_bf16 v[60:75], v[18:21], v[10:13], v[60:75]
    ds_read_b128 v[42:45], v3 offset:32768
    ds_read_b128 v[46:49], v3 offset:36864
    v_mfma_f32_32x32x16_bf16 v[76:91], v[22:25], v[10:13], v[76:91]
    ds_read_b64_tr_b16 v[50:51], v9 offset:0
    ds_read_b64_tr_b16 v[52:53], v9 offset:512
    v_mfma_f32_32x32x16_bf16 v[92:107], v[18:21], v[14:17], v[92:107]
    ds_read_b64_tr_b16 v[54:55], v9 offset:8192
    v_mfma_f32_32x32x16_bf16 v[108:123], v[22:25], v[14:17], v[108:123]
    ds_read_b64_tr_b16 v[56:57], v9 offset:8704
    v_mfma_f32_32x32x16_bf16 v[60:75], v[34:37], v[26:29], v[60:75]
    ds_read_b128 v[10:13], v4 offset:32768
    ds_read_b128 v[14:17], v4 offset:36864
    v_mfma_f32_32x32x16_bf16 v[76:91], v[38:41], v[26:29], v[76:91]
    ds_read_b64_tr_b16 v[18:19], v9 offset:2048
    ds_read_b64_tr_b16 v[20:21], v9 offset:2560
    v_mfma_f32_32x32x16_bf16 v[92:107], v[34:37], v[30:33], v[92:107]
    ds_read_b64_tr_b16 v[22:23], v9 offset:10240
    v_mfma_f32_32x32x16_bf16 v[108:123], v[38:41], v[30:33], v[108:123]
    ds_read_b64_tr_b16 v[24:25], v9 offset:10752
    s_waitcnt lgkmcnt(6)
    v_mfma_f32_32x32x16_bf16 v[60:75], v[50:53], v[42:45], v[60:75]
    ds_read_b128 v[26:29], v5 offset:32768
    ds_read_b128 v[30:33], v5 offset:36864
    v_mfma_f32_32x32x16_bf16 v[76:91], v[54:57], v[42:45], v[76:91]
    ds_read_b64_tr_b16 v[34:35], v9 offset:4096
    ds_read_b64_tr_b16 v[36:37], v9 offset:4608
    v_mfma_f32_32x32x16_bf16 v[92:107], v[50:53], v[46:49], v[92:107]
    ds_read_b64_tr_b16 v[38:39], v9 offset:12288
    v_mfma_f32_32x32x16_bf16 v[108:123], v[54:57], v[46:49], v[108:123]
    ds_read_b64_tr_b16 v[40:41], v9 offset:12800
    s_waitcnt lgkmcnt(6)
    v_mfma_f32_32x32x16_bf16 v[60:75], v[18:21], v[10:13], v[60:75]
    ds_read_b128 v[42:45], v6 offset:32768
    ds_read_b128 v[46:49], v6 offset:36864
    v_mfma_f32_32x32x16_bf16 v[76:91], v[22:25], v[10:13], v[76:91]
    ds_read_b64_tr_b16 v[50:51], v9 offset:6144
    ds_read_b64_tr_b16 v[52:53], v9 offset:6656
    v_mfma_f32_32x32x16_bf16 v[92:107], v[18:21], v[14:17], v[92:107]
    ds_read_b64_tr_b16 v[54:55], v9 offset:14336
    v_mfma_f32_32x32x16_bf16 v[108:123], v[22:25], v[14:17], v[108:123]
    ds_read_b64_tr_b16 v[56:57], v9 offset:14848
    s_waitcnt lgkmcnt(0)
    s_barrier
    v_mfma_f32_32x32x16_bf16 v[60:75], v[34:37], v[26:29], v[60:75]
    ds_read_b128 v[10:13], v3 offset:0
    ds_read_b128 v[14:17], v3 offset:4096
    v_mfma_f32_32x32x16_bf16 v[76:91], v[38:41], v[26:29], v[76:91]
    ds_read_b64_tr_b16 v[18:19], v9 offset:16384
    ds_read_b64_tr_b16 v[20:21], v9 offset:16896
    v_mfma_f32_32x32x16_bf16 v[92:107], v[34:37], v[30:33], v[92:107]
    ds_read_b64_tr_b16 v[22:23], v9 offset:24576
    v_mfma_f32_32x32x16_bf16 v[108:123], v[38:41], v[30:33], v[108:123]
    ds_read_b64_tr_b16 v[24:25], v9 offset:25088
    v_mfma_f32_32x32x16_bf16 v[60:75], v[50:53], v[42:45], v[60:75]
    ds_read_b128 v[26:29], v4 offset:0
    ds_read_b128 v[30:33], v4 offset:4096
    v_mfma_f32_32x32x16_bf16 v[76:91], v[54:57], v[42:45], v[76:91]
    ds_read_b64_tr_b16 v[34:35], v9 offset:18432
    ds_read_b64_tr_b16 v[36:37], v9 offset:18944
    v_mfma_f32_32x32x16_bf16 v[92:107], v[50:53], v[46:49], v[92:107]
    ds_read_b64_tr_b16 v[38:39], v9 offset:26624
    v_mfma_f32_32x32x16_bf16 v[108:123], v[54:57], v[46:49], v[108:123]
    ds_read_b64_tr_b16 v[40:41], v9 offset:27136
    s_waitcnt lgkmcnt(6)
    v_mfma_f32_32x32x16_bf16 v[60:75], v[18:21], v[10:13], v[60:75]
    ds_read_b128 v[42:45], v5 offset:0
    ds_read_b128 v[46:49], v5 offset:4096
    v_mfma_f32_32x32x16_bf16 v[76:91], v[22:25], v[10:13], v[76:91]
    ds_read_b64_tr_b16 v[50:51], v9 offset:20480
    ds_read_b64_tr_b16 v[52:53], v9 offset:20992
    v_mfma_f32_32x32x16_bf16 v[92:107], v[18:21], v[14:17], v[92:107]
    ds_read_b64_tr_b16 v[54:55], v9 offset:28672
    v_mfma_f32_32x32x16_bf16 v[108:123], v[22:25], v[14:17], v[108:123]
    ds_read_b64_tr_b16 v[56:57], v9 offset:29184
    s_waitcnt lgkmcnt(6)
    v_mfma_f32_32x32x16_bf16 v[60:75], v[34:37], v[26:29], v[60:75]
    ds_read_b128 v[10:13], v6 offset:0
    ds_read_b128 v[14:17], v6 offset:4096
    v_mfma_f32_32x32x16_bf16 v[76:91], v[38:41], v[26:29], v[76:91]
    ds_read_b64_tr_b16 v[18:19], v9 offset:22528
    ds_read_b64_tr_b16 v[20:21], v9 offset:23040
    v_mfma_f32_32x32x16_bf16 v[92:107], v[34:37], v[30:33], v[92:107]
    ds_read_b64_tr_b16 v[22:23], v9 offset:30720
    v_mfma_f32_32x32x16_bf16 v[108:123], v[38:41], v[30:33], v[108:123]
    ds_read_b64_tr_b16 v[24:25], v9 offset:31232
    s_waitcnt lgkmcnt(0)
    s_barrier
    v_mfma_f32_32x32x16_bf16 v[60:75], v[50:53], v[42:45], v[60:75]
    ds_read_b128 v[26:29], v3 offset:16384
    ds_read_b128 v[30:33], v3 offset:20480
    v_mfma_f32_32x32x16_bf16 v[76:91], v[54:57], v[42:45], v[76:91]
    ds_read_b64_tr_b16 v[34:35], v9 offset:0
    ds_read_b64_tr_b16 v[36:37], v9 offset:512
    v_mfma_f32_32x32x16_bf16 v[92:107], v[50:53], v[46:49], v[92:107]
    ds_read_b64_tr_b16 v[38:39], v9 offset:8192
    v_mfma_f32_32x32x16_bf16 v[108:123], v[54:57], v[46:49], v[108:123]
    ds_read_b64_tr_b16 v[40:41], v9 offset:8704
    v_mfma_f32_32x32x16_bf16 v[60:75], v[18:21], v[10:13], v[60:75]
    ds_read_b128 v[42:45], v4 offset:16384
    ds_read_b128 v[46:49], v4 offset:20480
    v_mfma_f32_32x32x16_bf16 v[76:91], v[22:25], v[10:13], v[76:91]
    ds_read_b64_tr_b16 v[50:51], v9 offset:2048
    ds_read_b64_tr_b16 v[52:53], v9 offset:2560
    v_mfma_f32_32x32x16_bf16 v[92:107], v[18:21], v[14:17], v[92:107]
    ds_read_b64_tr_b16 v[54:55], v9 offset:10240
    v_mfma_f32_32x32x16_bf16 v[108:123], v[22:25], v[14:17], v[108:123]
    ds_read_b64_tr_b16 v[56:57], v9 offset:10752
    s_waitcnt lgkmcnt(6)
    v_mfma_f32_32x32x16_bf16 v[60:75], v[34:37], v[26:29], v[60:75]
    ds_read_b128 v[10:13], v5 offset:16384
    ds_read_b128 v[14:17], v5 offset:20480
    v_mfma_f32_32x32x16_bf16 v[76:91], v[38:41], v[26:29], v[76:91]
    ds_read_b64_tr_b16 v[18:19], v9 offset:4096
    ds_read_b64_tr_b16 v[20:21], v9 offset:4608
    v_mfma_f32_32x32x16_bf16 v[92:107], v[34:37], v[30:33], v[92:107]
    ds_read_b64_tr_b16 v[22:23], v9 offset:12288
    v_mfma_f32_32x32x16_bf16 v[108:123], v[38:41], v[30:33], v[108:123]
    ds_read_b64_tr_b16 v[24:25], v9 offset:12800
    s_waitcnt lgkmcnt(6)
    v_mfma_f32_32x32x16_bf16 v[60:75], v[50:53], v[42:45], v[60:75]
    ds_read_b128 v[26:29], v6 offset:16384
    ds_read_b128 v[30:33], v6 offset:20480
    v_mfma_f32_32x32x16_bf16 v[76:91], v[54:57], v[42:45], v[76:91]
    ds_read_b64_tr_b16 v[34:35], v9 offset:6144
    ds_read_b64_tr_b16 v[36:37], v9 offset:6656
    v_mfma_f32_32x32x16_bf16 v[92:107], v[50:53], v[46:49], v[92:107]
    ds_read_b64_tr_b16 v[38:39], v9 offset:14336
    v_mfma_f32_32x32x16_bf16 v[108:123], v[54:57], v[46:49], v[108:123]
    ds_read_b64_tr_b16 v[40:41], v9 offset:14848
    s_waitcnt lgkmcnt(0)
    s_barrier
    v_mfma_f32_32x32x16_bf16 v[60:75], v[18:21], v[10:13], v[60:75]
    ds_read_b128 v[42:45], v3 offset:32768
    ds_read_b128 v[46:49], v3 offset:36864
    v_mfma_f32_32x32x16_bf16 v[76:91], v[22:25], v[10:13], v[76:91]
    ds_read_b64_tr_b16 v[50:51], v9 offset:16384
    ds_read_b64_tr_b16 v[52:53], v9 offset:16896
    v_mfma_f32_32x32x16_bf16 v[92:107], v[18:21], v[14:17], v[92:107]
    ds_read_b64_tr_b16 v[54:55], v9 offset:24576
    v_mfma_f32_32x32x16_bf16 v[108:123], v[22:25], v[14:17], v[108:123]
    ds_read_b64_tr_b16 v[56:57], v9 offset:25088
    v_mfma_f32_32x32x16_bf16 v[60:75], v[34:37], v[26:29], v[60:75]
    ds_read_b128 v[10:13], v4 offset:32768
    ds_read_b128 v[14:17], v4 offset:36864
    v_mfma_f32_32x32x16_bf16 v[76:91], v[38:41], v[26:29], v[76:91]
    ds_read_b64_tr_b16 v[18:19], v9 offset:18432
    ds_read_b64_tr_b16 v[20:21], v9 offset:18944
    v_mfma_f32_32x32x16_bf16 v[92:107], v[34:37], v[30:33], v[92:107]
    ds_read_b64_tr_b16 v[22:23], v9 offset:26624
    v_mfma_f32_32x32x16_bf16 v[108:123], v[38:41], v[30:33], v[108:123]
    ds_read_b64_tr_b16 v[24:25], v9 offset:27136
    s_waitcnt lgkmcnt(6)
    v_mfma_f32_32x32x16_bf16 v[60:75], v[50:53], v[42:45], v[60:75]
    ds_read_b128 v[26:29], v5 offset:32768
    ds_read_b128 v[30:33], v5 offset:36864
    v_mfma_f32_32x32x16_bf16 v[76:91], v[54:57], v[42:45], v[76:91]
    ds_read_b64_tr_b16 v[34:35], v9 offset:20480
    ds_read_b64_tr_b16 v[36:37], v9 offset:20992
    v_mfma_f32_32x32x16_bf16 v[92:107], v[50:53], v[46:49], v[92:107]
    ds_read_b64_tr_b16 v[38:39], v9 offset:28672
    v_mfma_f32_32x32x16_bf16 v[108:123], v[54:57], v[46:49], v[108:123]
    ds_read_b64_tr_b16 v[40:41], v9 offset:29184
    s_waitcnt lgkmcnt(6)
    v_mfma_f32_32x32x16_bf16 v[60:75], v[18:21], v[10:13], v[60:75]
    ds_read_b128 v[42:45], v6 offset:32768
    ds_read_b128 v[46:49], v6 offset:36864
    v_mfma_f32_32x32x16_bf16 v[76:91], v[22:25], v[10:13], v[76:91]
    ds_read_b64_tr_b16 v[50:51], v9 offset:22528
    ds_read_b64_tr_b16 v[52:53], v9 offset:23040
    v_mfma_f32_32x32x16_bf16 v[92:107], v[18:21], v[14:17], v[92:107]
    ds_read_b64_tr_b16 v[54:55], v9 offset:30720
    v_mfma_f32_32x32x16_bf16 v[108:123], v[22:25], v[14:17], v[108:123]
    ds_read_b64_tr_b16 v[56:57], v9 offset:31232
    s_waitcnt lgkmcnt(0)
    s_barrier
    v_mfma_f32_32x32x16_bf16 v[60:75], v[34:37], v[26:29], v[60:75]
    ds_read_b128 v[10:13], v3 offset:0
    ds_read_b128 v[14:17], v3 offset:4096
    v_mfma_f32_32x32x16_bf16 v[76:91], v[38:41], v[26:29], v[76:91]
    ds_read_b64_tr_b16 v[18:19], v9 offset:0
    ds_read_b64_tr_b16 v[20:21], v9 offset:512
    v_mfma_f32_32x32x16_bf16 v[92:107], v[34:37], v[30:33], v[92:107]
    ds_read_b64_tr_b16 v[22:23], v9 offset:8192
    v_mfma_f32_32x32x16_bf16 v[108:123], v[38:41], v[30:33], v[108:123]
    ds_read_b64_tr_b16 v[24:25], v9 offset:8704
    v_mfma_f32_32x32x16_bf16 v[60:75], v[50:53], v[42:45], v[60:75]
    ds_read_b128 v[26:29], v4 offset:0
    ds_read_b128 v[30:33], v4 offset:4096
    v_mfma_f32_32x32x16_bf16 v[76:91], v[54:57], v[42:45], v[76:91]
    ds_read_b64_tr_b16 v[34:35], v9 offset:2048
    ds_read_b64_tr_b16 v[36:37], v9 offset:2560
    v_mfma_f32_32x32x16_bf16 v[92:107], v[50:53], v[46:49], v[92:107]
    ds_read_b64_tr_b16 v[38:39], v9 offset:10240
    v_mfma_f32_32x32x16_bf16 v[108:123], v[54:57], v[46:49], v[108:123]
    ds_read_b64_tr_b16 v[40:41], v9 offset:10752
    s_waitcnt lgkmcnt(6)
    v_mfma_f32_32x32x16_bf16 v[60:75], v[18:21], v[10:13], v[60:75]
    ds_read_b128 v[42:45], v5 offset:0
    ds_read_b128 v[46:49], v5 offset:4096
    v_mfma_f32_32x32x16_bf16 v[76:91], v[22:25], v[10:13], v[76:91]
    ds_read_b64_tr_b16 v[50:51], v9 offset:4096
    ds_read_b64_tr_b16 v[52:53], v9 offset:4608
    v_mfma_f32_32x32x16_bf16 v[92:107], v[18:21], v[14:17], v[92:107]
    ds_read_b64_tr_b16 v[54:55], v9 offset:12288
    v_mfma_f32_32x32x16_bf16 v[108:123], v[22:25], v[14:17], v[108:123]
    ds_read_b64_tr_b16 v[56:57], v9 offset:12800
    s_waitcnt lgkmcnt(6)
    v_mfma_f32_32x32x16_bf16 v[60:75], v[34:37], v[26:29], v[60:75]
    ds_read_b128 v[10:13], v6 offset:0
    ds_read_b128 v[14:17], v6 offset:4096
    v_mfma_f32_32x32x16_bf16 v[76:91], v[38:41], v[26:29], v[76:91]
    ds_read_b64_tr_b16 v[18:19], v9 offset:6144
    ds_read_b64_tr_b16 v[20:21], v9 offset:6656
    v_mfma_f32_32x32x16_bf16 v[92:107], v[34:37], v[30:33], v[92:107]
    ds_read_b64_tr_b16 v[22:23], v9 offset:14336
    v_mfma_f32_32x32x16_bf16 v[108:123], v[38:41], v[30:33], v[108:123]
    ds_read_b64_tr_b16 v[24:25], v9 offset:14848
    s_waitcnt lgkmcnt(0)
    s_barrier
    v_mfma_f32_32x32x16_bf16 v[60:75], v[50:53], v[42:45], v[60:75]
    ds_read_b128 v[26:29], v3 offset:16384
    ds_read_b128 v[30:33], v3 offset:20480
    v_mfma_f32_32x32x16_bf16 v[76:91], v[54:57], v[42:45], v[76:91]
    ds_read_b64_tr_b16 v[34:35], v9 offset:16384
    ds_read_b64_tr_b16 v[36:37], v9 offset:16896
    v_mfma_f32_32x32x16_bf16 v[92:107], v[50:53], v[46:49], v[92:107]
    ds_read_b64_tr_b16 v[38:39], v9 offset:24576
    v_mfma_f32_32x32x16_bf16 v[108:123], v[54:57], v[46:49], v[108:123]
    ds_read_b64_tr_b16 v[40:41], v9 offset:25088
    v_mfma_f32_32x32x16_bf16 v[60:75], v[18:21], v[10:13], v[60:75]
    ds_read_b128 v[42:45], v4 offset:16384
    ds_read_b128 v[46:49], v4 offset:20480
    v_mfma_f32_32x32x16_bf16 v[76:91], v[22:25], v[10:13], v[76:91]
    ds_read_b64_tr_b16 v[50:51], v9 offset:18432
    ds_read_b64_tr_b16 v[52:53], v9 offset:18944
    v_mfma_f32_32x32x16_bf16 v[92:107], v[18:21], v[14:17], v[92:107]
    ds_read_b64_tr_b16 v[54:55], v9 offset:26624
    v_mfma_f32_32x32x16_bf16 v[108:123], v[22:25], v[14:17], v[108:123]
    ds_read_b64_tr_b16 v[56:57], v9 offset:27136
    s_waitcnt lgkmcnt(6)
    v_mfma_f32_32x32x16_bf16 v[60:75], v[34:37], v[26:29], v[60:75]
    ds_read_b128 v[10:13], v5 offset:16384
    ds_read_b128 v[14:17], v5 offset:20480
    v_mfma_f32_32x32x16_bf16 v[76:91], v[38:41], v[26:29], v[76:91]
    ds_read_b64_tr_b16 v[18:19], v9 offset:20480
    ds_read_b64_tr_b16 v[20:21], v9 offset:20992
    v_mfma_f32_32x32x16_bf16 v[92:107], v[34:37], v[30:33], v[92:107]
    ds_read_b64_tr_b16 v[22:23], v9 offset:28672
    v_mfma_f32_32x32x16_bf16 v[108:123], v[38:41], v[30:33], v[108:123]
    ds_read_b64_tr_b16 v[24:25], v9 offset:29184
    s_waitcnt lgkmcnt(6)
    v_mfma_f32_32x32x16_bf16 v[60:75], v[50:53], v[42:45], v[60:75]
    ds_read_b128 v[26:29], v6 offset:16384
    ds_read_b128 v[30:33], v6 offset:20480
    v_mfma_f32_32x32x16_bf16 v[76:91], v[54:57], v[42:45], v[76:91]
    ds_read_b64_tr_b16 v[34:35], v9 offset:22528
    ds_read_b64_tr_b16 v[36:37], v9 offset:23040
    v_mfma_f32_32x32x16_bf16 v[92:107], v[50:53], v[46:49], v[92:107]
    ds_read_b64_tr_b16 v[38:39], v9 offset:30720
    v_mfma_f32_32x32x16_bf16 v[108:123], v[54:57], v[46:49], v[108:123]
    ds_read_b64_tr_b16 v[40:41], v9 offset:31232
    s_waitcnt lgkmcnt(0)
    s_barrier
    v_mfma_f32_32x32x16_bf16 v[60:75], v[18:21], v[10:13], v[60:75]
    v_mfma_f32_32x32x16_bf16 v[76:91], v[22:25], v[10:13], v[76:91]
    v_mfma_f32_32x32x16_bf16 v[92:107], v[18:21], v[14:17], v[92:107]
    v_mfma_f32_32x32x16_bf16 v[108:123], v[22:25], v[14:17], v[108:123]
    v_mfma_f32_32x32x16_bf16 v[60:75], v[34:37], v[26:29], v[60:75]
    ds_read_b128 v[10:13], v124 offset:0
    ds_read_b64_tr_b16 v[18:19], v9 offset:0
    v_mfma_f32_32x32x16_bf16 v[76:91], v[38:41], v[26:29], v[76:91]
    ds_read_b64_tr_b16 v[20:21], v9 offset:512
    v_mfma_f32_32x32x16_bf16 v[92:107], v[34:37], v[30:33], v[92:107]
    ds_read_b64_tr_b16 v[22:23], v9 offset:8192
    v_mfma_f32_32x32x16_bf16 v[108:123], v[38:41], v[30:33], v[108:123]
    ds_read_b64_tr_b16 v[24:25], v9 offset:8704
    ds_read_b128 v[26:29], v125 offset:0
    ds_read_b64_tr_b16 v[34:35], v9 offset:2048
    ds_read_b64_tr_b16 v[36:37], v9 offset:2560
    ds_read_b64_tr_b16 v[38:39], v9 offset:10240
    ds_read_b64_tr_b16 v[40:41], v9 offset:10752
    s_setprio 3
    s_lshl_b32 s62, s38, 2
    s_lshl_b32 s63, s56, 1
    s_add_u32 s62, s62, s63
    s_lshl_b32 s60, s92, 1
    s_add_u32 s60, s60, s57
    s_mul_i32 s62, s62, 89
    s_cmp_ge_u32 s60, 43
    s_cselect_b32 s64, 0, 1.0
    s_lshl_b32 s60, s60, 1
    s_add_u32 s60, s60, s62
    s_lshl_b32 s60, s60, 10
    s_add_u32 s65, s60, 0x80e000
    v_lshlrev_b32 v1, 4, v0
    v_mul_f32 v42, 0xbfb8aa3b, v60
    v_mul_f32 v43, 0xbfb8aa3b, v61
    v_mul_f32 v44, 0xbfb8aa3b, v62
    v_mul_f32 v45, 0xbfb8aa3b, v63
    v_mul_f32 v46, 0xbfb8aa3b, v64
    v_mul_f32 v47, 0xbfb8aa3b, v65
    v_mul_f32 v48, 0xbfb8aa3b, v66
    v_mul_f32 v49, 0xbfb8aa3b, v67
    v_exp_f32 v42, v42
    v_exp_f32 v43, v43
    v_exp_f32 v44, v44
    v_exp_f32 v45, v45
    v_exp_f32 v46, v46
    v_exp_f32 v47, v47
    v_exp_f32 v48, v48
    v_exp_f32 v49, v49
    v_mul_f32 v76, v60, v76
    v_mul_f32 v77, v61, v77
    v_mul_f32 v78, v62, v78
    v_mul_f32 v79, v63, v79
    v_mul_f32 v80, v64, v80
    v_mul_f32 v81, v65, v81
    v_mul_f32 v82, v66, v82
    v_mul_f32 v83, v67, v83
    v_add_f32 v42, 1.0, v42
    v_add_f32 v43, 1.0, v43
    v_add_f32 v44, 1.0, v44
    v_add_f32 v45, 1.0, v45
    v_add_f32 v46, 1.0, v46
    v_add_f32 v47, 1.0, v47
    v_add_f32 v48, 1.0, v48
    v_add_f32 v49, 1.0, v49
    v_rcp_f32 v42, v42
    v_rcp_f32 v43, v43
    v_rcp_f32 v44, v44
    v_rcp_f32 v45, v45
    v_rcp_f32 v46, v46
    v_rcp_f32 v47, v47
    v_rcp_f32 v48, v48
    v_rcp_f32 v49, v49
    v_mul_f32 v76, s64, v76
    v_mul_f32 v77, s64, v77
    v_mul_f32 v78, s64, v78
    v_mul_f32 v79, s64, v79
    v_mul_f32 v80, s64, v80
    v_mul_f32 v81, s64, v81
    v_mul_f32 v82, s64, v82
    v_mul_f32 v83, s64, v83
    v_mul_f32 v76, v76, v42
    v_mul_f32 v77, v77, v43
    v_mul_f32 v78, v78, v44
    v_mul_f32 v79, v79, v45
    v_mul_f32 v80, v80, v46
    v_mul_f32 v81, v81, v47
    v_mul_f32 v82, v82, v48
    v_mul_f32 v83, v83, v49
    v_cvt_pk_bf16_f32 v76, v76, v77
    v_cvt_pk_bf16_f32 v77, v78, v79
    v_cvt_pk_bf16_f32 v78, v80, v81
    v_cvt_pk_bf16_f32 v79, v82, v83
    s_add_u32 s63, s65, 0
    buffer_store_dwordx4 v[76:79], v1, s[48:51], s63 offen sc0 sc1
    v_mul_f32 v42, 0xbfb8aa3b, v68
    v_mul_f32 v43, 0xbfb8aa3b, v69
    v_mul_f32 v44, 0xbfb8aa3b, v70
    v_mul_f32 v45, 0xbfb8aa3b, v71
    v_mul_f32 v46, 0xbfb8aa3b, v72
    v_mul_f32 v47, 0xbfb8aa3b, v73
    v_mul_f32 v48, 0xbfb8aa3b, v74
    v_mul_f32 v49, 0xbfb8aa3b, v75
    v_exp_f32 v42, v42
    v_exp_f32 v43, v43
    v_exp_f32 v44, v44
    v_exp_f32 v45, v45
    v_exp_f32 v46, v46
    v_exp_f32 v47, v47
    v_exp_f32 v48, v48
    v_exp_f32 v49, v49
    v_mul_f32 v84, v68, v84
    v_mul_f32 v85, v69, v85
    v_mul_f32 v86, v70, v86
    v_mul_f32 v87, v71, v87
    v_mul_f32 v88, v72, v88
    v_mul_f32 v89, v73, v89
    v_mul_f32 v90, v74, v90
    v_mul_f32 v91, v75, v91
    v_add_f32 v42, 1.0, v42
    v_add_f32 v43, 1.0, v43
    v_add_f32 v44, 1.0, v44
    v_add_f32 v45, 1.0, v45
    v_add_f32 v46, 1.0, v46
    v_add_f32 v47, 1.0, v47
    v_add_f32 v48, 1.0, v48
    v_add_f32 v49, 1.0, v49
    v_rcp_f32 v42, v42
    v_rcp_f32 v43, v43
    v_rcp_f32 v44, v44
    v_rcp_f32 v45, v45
    v_rcp_f32 v46, v46
    v_rcp_f32 v47, v47
    v_rcp_f32 v48, v48
    v_rcp_f32 v49, v49
    v_mul_f32 v84, s64, v84
    v_mul_f32 v85, s64, v85
    v_mul_f32 v86, s64, v86
    v_mul_f32 v87, s64, v87
    v_mul_f32 v88, s64, v88
    v_mul_f32 v89, s64, v89
    v_mul_f32 v90, s64, v90
    v_mul_f32 v91, s64, v91
    v_mul_f32 v84, v84, v42
    v_mul_f32 v85, v85, v43
    v_mul_f32 v86, v86, v44
    v_mul_f32 v87, v87, v45
    v_mul_f32 v88, v88, v46
    v_mul_f32 v89, v89, v47
    v_mul_f32 v90, v90, v48
    v_mul_f32 v91, v91, v49
    v_cvt_pk_bf16_f32 v84, v84, v85
    v_cvt_pk_bf16_f32 v85, v86, v87
    v_cvt_pk_bf16_f32 v86, v88, v89
    v_cvt_pk_bf16_f32 v87, v90, v91
    s_add_u32 s63, s65, 1024
    buffer_store_dwordx4 v[84:87], v1, s[48:51], s63 offen sc0 sc1
    v_mul_f32 v42, 0xbfb8aa3b, v92
    v_mul_f32 v43, 0xbfb8aa3b, v93
    v_mul_f32 v44, 0xbfb8aa3b, v94
    v_mul_f32 v45, 0xbfb8aa3b, v95
    v_mul_f32 v46, 0xbfb8aa3b, v96
    v_mul_f32 v47, 0xbfb8aa3b, v97
    v_mul_f32 v48, 0xbfb8aa3b, v98
    v_mul_f32 v49, 0xbfb8aa3b, v99
    v_exp_f32 v42, v42
    v_exp_f32 v43, v43
    v_exp_f32 v44, v44
    v_exp_f32 v45, v45
    v_exp_f32 v46, v46
    v_exp_f32 v47, v47
    v_exp_f32 v48, v48
    v_exp_f32 v49, v49
    v_mul_f32 v108, v92, v108
    v_mul_f32 v109, v93, v109
    v_mul_f32 v110, v94, v110
    v_mul_f32 v111, v95, v111
    v_mul_f32 v112, v96, v112
    v_mul_f32 v113, v97, v113
    v_mul_f32 v114, v98, v114
    v_mul_f32 v115, v99, v115
    v_add_f32 v42, 1.0, v42
    v_add_f32 v43, 1.0, v43
    v_add_f32 v44, 1.0, v44
    v_add_f32 v45, 1.0, v45
    v_add_f32 v46, 1.0, v46
    v_add_f32 v47, 1.0, v47
    v_add_f32 v48, 1.0, v48
    v_add_f32 v49, 1.0, v49
    v_rcp_f32 v42, v42
    v_rcp_f32 v43, v43
    v_rcp_f32 v44, v44
    v_rcp_f32 v45, v45
    v_rcp_f32 v46, v46
    v_rcp_f32 v47, v47
    v_rcp_f32 v48, v48
    v_rcp_f32 v49, v49
    v_mul_f32 v108, s64, v108
    v_mul_f32 v109, s64, v109
    v_mul_f32 v110, s64, v110
    v_mul_f32 v111, s64, v111
    v_mul_f32 v112, s64, v112
    v_mul_f32 v113, s64, v113
    v_mul_f32 v114, s64, v114
    v_mul_f32 v115, s64, v115
    v_mul_f32 v108, v108, v42
    v_mul_f32 v109, v109, v43
    v_mul_f32 v110, v110, v44
    v_mul_f32 v111, v111, v45
    v_mul_f32 v112, v112, v46
    v_mul_f32 v113, v113, v47
    v_mul_f32 v114, v114, v48
    v_mul_f32 v115, v115, v49
    v_cvt_pk_bf16_f32 v108, v108, v109
    v_cvt_pk_bf16_f32 v109, v110, v111
    v_cvt_pk_bf16_f32 v110, v112, v113
    v_cvt_pk_bf16_f32 v111, v114, v115
    s_add_u32 s63, s65, 91136
    buffer_store_dwordx4 v[108:111], v1, s[48:51], s63 offen sc0 sc1
    v_mul_f32 v42, 0xbfb8aa3b, v100
    v_mul_f32 v43, 0xbfb8aa3b, v101
    v_mul_f32 v44, 0xbfb8aa3b, v102
    v_mul_f32 v45, 0xbfb8aa3b, v103
    v_mul_f32 v46, 0xbfb8aa3b, v104
    v_mul_f32 v47, 0xbfb8aa3b, v105
    v_mul_f32 v48, 0xbfb8aa3b, v106
    v_mul_f32 v49, 0xbfb8aa3b, v107
    v_exp_f32 v42, v42
    v_exp_f32 v43, v43
    v_exp_f32 v44, v44
    v_exp_f32 v45, v45
    v_exp_f32 v46, v46
    v_exp_f32 v47, v47
    v_exp_f32 v48, v48
    v_exp_f32 v49, v49
    v_mul_f32 v116, v100, v116
    v_mul_f32 v117, v101, v117
    v_mul_f32 v118, v102, v118
    v_mul_f32 v119, v103, v119
    v_mul_f32 v120, v104, v120
    v_mul_f32 v121, v105, v121
    v_mul_f32 v122, v106, v122
    v_mul_f32 v123, v107, v123
    v_add_f32 v42, 1.0, v42
    v_add_f32 v43, 1.0, v43
    v_add_f32 v44, 1.0, v44
    v_add_f32 v45, 1.0, v45
    v_add_f32 v46, 1.0, v46
    v_add_f32 v47, 1.0, v47
    v_add_f32 v48, 1.0, v48
    v_add_f32 v49, 1.0, v49
    v_rcp_f32 v42, v42
    v_rcp_f32 v43, v43
    v_rcp_f32 v44, v44
    v_rcp_f32 v45, v45
    v_rcp_f32 v46, v46
    v_rcp_f32 v47, v47
    v_rcp_f32 v48, v48
    v_rcp_f32 v49, v49
    v_mul_f32 v116, s64, v116
    v_mul_f32 v117, s64, v117
    v_mul_f32 v118, s64, v118
    v_mul_f32 v119, s64, v119
    v_mul_f32 v120, s64, v120
    v_mul_f32 v121, s64, v121
    v_mul_f32 v122, s64, v122
    v_mul_f32 v123, s64, v123
    v_mul_f32 v116, v116, v42
    v_mul_f32 v117, v117, v43
    v_mul_f32 v118, v118, v44
    v_mul_f32 v119, v119, v45
    v_mul_f32 v120, v120, v46
    v_mul_f32 v121, v121, v47
    v_mul_f32 v122, v122, v48
    v_mul_f32 v123, v123, v49
    v_cvt_pk_bf16_f32 v116, v116, v117
    v_cvt_pk_bf16_f32 v117, v118, v119
    v_cvt_pk_bf16_f32 v118, v120, v121
    v_cvt_pk_bf16_f32 v119, v122, v123
    s_add_u32 s63, s65, 92160
    buffer_store_dwordx4 v[116:119], v1, s[48:51], s63 offen sc0 sc1
    s_lshl_b32 s64, s38, 5
    s_add_u32 s64, s64, s92
    s_lshl_b32 s94, s64, 7
    s_add_u32 s94, s94, 0xe06000
    s_setprio 0
    s_waitcnt lgkmcnt(5)
    v_mfma_f32_32x32x16_bf16 v[60:75], v[18:21], v[10:13], 0
    ds_read_b128 v[42:45], v126 offset:0
    ds_read_b64_tr_b16 v[50:51], v9 offset:4096
    ds_read_b64_tr_b16 v[52:53], v9 offset:4608
    v_mfma_f32_32x32x16_bf16 v[76:91], v[22:25], v[10:13], 0
    ds_read_b64_tr_b16 v[54:55], v9 offset:12288
    ds_read_b64_tr_b16 v[56:57], v9 offset:12800
    s_waitcnt lgkmcnt(5)
    v_mfma_f32_32x32x16_bf16 v[60:75], v[34:37], v[26:29], v[60:75]
    ds_read_b128 v[10:13], v127 offset:0
    ds_read_b64_tr_b16 v[18:19], v9 offset:6144
    ds_read_b64_tr_b16 v[20:21], v9 offset:6656
    v_mfma_f32_32x32x16_bf16 v[76:91], v[38:41], v[26:29], v[76:91]
    ds_read_b64_tr_b16 v[22:23], v9 offset:14336
    ds_read_b64_tr_b16 v[24:25], v9 offset:14848
    s_waitcnt lgkmcnt(0)
    s_barrier
    v_mfma_f32_32x32x16_bf16 v[60:75], v[50:53], v[42:45], v[60:75]
    ds_read_b128 v[26:29], v124 offset:16384
    ds_read_b64_tr_b16 v[34:35], v9 offset:16384
    ds_read_b64_tr_b16 v[36:37], v9 offset:16896
    v_mfma_f32_32x32x16_bf16 v[76:91], v[54:57], v[42:45], v[76:91]
    ds_read_b64_tr_b16 v[38:39], v9 offset:24576
    ds_read_b64_tr_b16 v[40:41], v9 offset:25088
    v_mfma_f32_32x32x16_bf16 v[60:75], v[18:21], v[10:13], v[60:75]
    ds_read_b128 v[42:45], v125 offset:16384
    ds_read_b64_tr_b16 v[50:51], v9 offset:18432
    ds_read_b64_tr_b16 v[52:53], v9 offset:18944
    v_mfma_f32_32x32x16_bf16 v[76:91], v[22:25], v[10:13], v[76:91]
    ds_read_b64_tr_b16 v[54:55], v9 offset:26624
    ds_read_b64_tr_b16 v[56:57], v9 offset:27136
    s_waitcnt lgkmcnt(5)
    v_mfma_f32_32x32x16_bf16 v[60:75], v[34:37], v[26:29], v[60:75]
    ds_read_b128 v[10:13], v126 offset:16384
    ds_read_b64_tr_b16 v[18:19], v9 offset:20480
    ds_read_b64_tr_b16 v[20:21], v9 offset:20992
    v_mfma_f32_32x32x16_bf16 v[76:91], v[38:41], v[26:29], v[76:91]
    ds_read_b64_tr_b16 v[22:23], v9 offset:28672
    ds_read_b64_tr_b16 v[24:25], v9 offset:29184
    s_waitcnt lgkmcnt(5)
    v_mfma_f32_32x32x16_bf16 v[60:75], v[50:53], v[42:45], v[60:75]
    ds_read_b128 v[26:29], v127 offset:16384
    ds_read_b64_tr_b16 v[34:35], v9 offset:22528
    ds_read_b64_tr_b16 v[36:37], v9 offset:23040
    v_mfma_f32_32x32x16_bf16 v[76:91], v[54:57], v[42:45], v[76:91]
    ds_read_b64_tr_b16 v[38:39], v9 offset:30720
    ds_read_b64_tr_b16 v[40:41], v9 offset:31232
    s_waitcnt vmcnt(0)
    s_waitcnt lgkmcnt(0)
    s_barrier
    s_cmp_eq_u32 s94, 0
    s_cbranch_scc1 pend_8
    s_cmp_lg_u32 s3, 0
    s_cbranch_scc1 pend_8
    s_add_u32 s5, s91, 1
    v_mov_b32 v58, s5
    v_mov_b32 v59, 0
    s_mov_b64 exec, 1
    buffer_store_dword v58, v59, s[48:51], s94 offen sc0 sc1
    s_mov_b64 exec, -1
pend_8:
    v_mfma_f32_32x32x16_bf16 v[60:75], v[18:21], v[10:13], v[60:75]
    ds_read_b128 v[42:45], v124 offset:32768
    ds_read_b64_tr_b16 v[50:51], v9 offset:0
    ds_read_b64_tr_b16 v[52:53], v9 offset:512
    v_mfma_f32_32x32x16_bf16 v[76:91], v[22:25], v[10:13], v[76:91]
    ds_read_b64_tr_b16 v[54:55], v9 offset:8192
    ds_read_b64_tr_b16 v[56:57], v9 offset:8704
    v_mfma_f32_32x32x16_bf16 v[60:75], v[34:37], v[26:29], v[60:75]
    ds_read_b128 v[10:13], v125 offset:32768
    ds_read_b64_tr_b16 v[18:19], v9 offset:2048
    ds_read_b64_tr_b16 v[20:21], v9 offset:2560
    v_mfma_f32_32x32x16_bf16 v[76:91], v[38:41], v[26:29], v[76:91]
    ds_read_b64_tr_b16 v[22:23], v9 offset:10240
    ds_read_b64_tr_b16 v[24:25], v9 offset:10752
    s_waitcnt lgkmcnt(5)
    v_mfma_f32_32x32x16_bf16 v[60:75], v[50:53], v[42:45], v[60:75]
    ds_read_b128 v[26:29], v126 offset:32768
    ds_read_b64_tr_b16 v[34:35], v9 offset:4096
    ds_read_b64_tr_b16 v[36:37], v9 offset:4608
    v_mfma_f32_32x32x16_bf16 v[76:91], v[54:57], v[42:45], v[76:91]
    ds_read_b64_tr_b16 v[38:39], v9 offset:12288
    ds_read_b64_tr_b16 v[40:41], v9 offset:12800
    s_waitcnt lgkmcnt(5)
    v_mfma_f32_32x32x16_bf16 v[60:75], v[18:21], v[10:13], v[60:75]
    ds_read_b128 v[42:45], v127 offset:32768
    ds_read_b64_tr_b16 v[50:51], v9 offset:6144
    ds_read_b64_tr_b16 v[52:53], v9 offset:6656
    v_mfma_f32_32x32x16_bf16 v[76:91], v[22:25], v[10:13], v[76:91]
    ds_read_b64_tr_b16 v[54:55], v9 offset:14336
    ds_read_b64_tr_b16 v[56:57], v9 offset:14848
    s_waitcnt lgkmcnt(0)
    s_barrier
    v_mfma_f32_32x32x16_bf16 v[60:75], v[34:37], v[26:29], v[60:75]
    ds_read_b128 v[10:13], v124 offset:0
    ds_read_b64_tr_b16 v[18:19], v9 offset:16384
    ds_read_b64_tr_b16 v[20:21], v9 offset:16896
    v_mfma_f32_32x32x16_bf16 v[76:91], v[38:41], v[26:29], v[76:91]
    ds_read_b64_tr_b16 v[22:23], v9 offset:24576
    ds_read_b64_tr_b16 v[24:25], v9 offset:25088
    v_mfma_f32_32x32x16_bf16 v[60:75], v[50:53], v[42:45], v[60:75]
    ds_read_b128 v[26:29], v125 offset:0
    ds_read_b64_tr_b16 v[34:35], v9 offset:18432
    ds_read_b64_tr_b16 v[36:37], v9 offset:18944
    v_mfma_f32_32x32x16_bf16 v[76:91], v[54:57], v[42:45], v[76:91]
    ds_read_b64_tr_b16 v[38:39], v9 offset:26624
    ds_read_b64_tr_b16 v[40:41], v9 offset:27136
    s_waitcnt lgkmcnt(5)
    v_mfma_f32_32x32x16_bf16 v[60:75], v[18:21], v[10:13], v[60:75]
    ds_read_b128 v[42:45], v126 offset:0
    ds_read_b64_tr_b16 v[50:51], v9 offset:20480
    ds_read_b64_tr_b16 v[52:53], v9 offset:20992
    v_mfma_f32_32x32x16_bf16 v[76:91], v[22:25], v[10:13], v[76:91]
    ds_read_b64_tr_b16 v[54:55], v9 offset:28672
    ds_read_b64_tr_b16 v[56:57], v9 offset:29184
    s_waitcnt lgkmcnt(5)
    v_mfma_f32_32x32x16_bf16 v[60:75], v[34:37], v[26:29], v[60:75]
    ds_read_b128 v[10:13], v127 offset:0
    ds_read_b64_tr_b16 v[18:19], v9 offset:22528
    ds_read_b64_tr_b16 v[20:21], v9 offset:23040
    v_mfma_f32_32x32x16_bf16 v[76:91], v[38:41], v[26:29], v[76:91]
    ds_read_b64_tr_b16 v[22:23], v9 offset:30720
    ds_read_b64_tr_b16 v[24:25], v9 offset:31232
    s_waitcnt lgkmcnt(0)
    s_barrier
    v_mfma_f32_32x32x16_bf16 v[60:75], v[50:53], v[42:45], v[60:75]
    ds_read_b128 v[26:29], v124 offset:16384
    ds_read_b64_tr_b16 v[34:35], v9 offset:0
    ds_read_b64_tr_b16 v[36:37], v9 offset:512
    v_mfma_f32_32x32x16_bf16 v[76:91], v[54:57], v[42:45], v[76:91]
    ds_read_b64_tr_b16 v[38:39], v9 offset:8192
    ds_read_b64_tr_b16 v[40:41], v9 offset:8704
    v_mfma_f32_32x32x16_bf16 v[60:75], v[18:21], v[10:13], v[60:75]
    ds_read_b128 v[42:45], v125 offset:16384
    ds_read_b64_tr_b16 v[50:51], v9 offset:2048
    ds_read_b64_tr_b16 v[52:53], v9 offset:2560
    v_mfma_f32_32x32x16_bf16 v[76:91], v[22:25], v[10:13], v[76:91]
    ds_read_b64_tr_b16 v[54:55], v9 offset:10240
    ds_read_b64_tr_b16 v[56:57], v9 offset:10752
    s_waitcnt lgkmcnt(5)
    v_mfma_f32_32x32x16_bf16 v[60:75], v[34:37], v[26:29], v[60:75]
    ds_read_b128 v[10:13], v126 offset:16384
    ds_read_b64_tr_b16 v[18:19], v9 offset:4096
    ds_read_b64_tr_b16 v[20:21], v9 offset:4608
    v_mfma_f32_32x32x16_bf16 v[76:91], v[38:41], v[26:29], v[76:91]
    ds_read_b64_tr_b16 v[22:23], v9 offset:12288
    ds_read_b64_tr_b16 v[24:25], v9 offset:12800
    s_waitcnt lgkmcnt(5)
    v_mfma_f32_32x32x16_bf16 v[60:75], v[50:53], v[42:45], v[60:75]
    ds_read_b128 v[26:29], v127 offset:16384
    ds_read_b64_tr_b16 v[34:35], v9 offset:6144
    ds_read_b64_tr_b16 v[36:37], v9 offset:6656
    v_mfma_f32_32x32x16_bf16 v[76:91], v[54:57], v[42:45], v[76:91]
    ds_read_b64_tr_b16 v[38:39], v9 offset:14336
    ds_read_b64_tr_b16 v[40:41], v9 offset:14848
    s_waitcnt lgkmcnt(0)
    s_barrier
    v_mfma_f32_32x32x16_bf16 v[60:75], v[18:21], v[10:13], v[60:75]
    ds_read_b128 v[42:45], v124 offset:32768
    ds_read_b64_tr_b16 v[50:51], v9 offset:16384
    ds_read_b64_tr_b16 v[52:53], v9 offset:16896
    v_mfma_f32_32x32x16_bf16 v[76:91], v[22:25], v[10:13], v[76:91]
    ds_read_b64_tr_b16 v[54:55], v9 offset:24576
    ds_read_b64_tr_b16 v[56:57], v9 offset:25088
    v_mfma_f32_32x32x16_bf16 v[60:75], v[34:37], v[26:29], v[60:75]
    ds_read_b128 v[10:13], v125 offset:32768
    ds_read_b64_tr_b16 v[18:19], v9 offset:18432
    ds_read_b64_tr_b16 v[20:21], v9 offset:18944
    v_mfma_f32_32x32x16_bf16 v[76:91], v[38:41], v[26:29], v[76:91]
    ds_read_b64_tr_b16 v[22:23], v9 offset:26624
    ds_read_b64_tr_b16 v[24:25], v9 offset:27136
    s_waitcnt lgkmcnt(5)
    v_mfma_f32_32x32x16_bf16 v[60:75], v[50:53], v[42:45], v[60:75]
    ds_read_b128 v[26:29], v126 offset:32768
    ds_read_b64_tr_b16 v[34:35], v9 offset:20480
    ds_read_b64_tr_b16 v[36:37], v9 offset:20992
    v_mfma_f32_32x32x16_bf16 v[76:91], v[54:57], v[42:45], v[76:91]
    ds_read_b64_tr_b16 v[38:39], v9 offset:28672
    ds_read_b64_tr_b16 v[40:41], v9 offset:29184
    s_waitcnt lgkmcnt(5)
    v_mfma_f32_32x32x16_bf16 v[60:75], v[18:21], v[10:13], v[60:75]
    ds_read_b128 v[42:45], v127 offset:32768
    ds_read_b64_tr_b16 v[50:51], v9 offset:22528
    ds_read_b64_tr_b16 v[52:53], v9 offset:23040
    v_mfma_f32_32x32x16_bf16 v[76:91], v[22:25], v[10:13], v[76:91]
    ds_read_b64_tr_b16 v[54:55], v9 offset:30720
    ds_read_b64_tr_b16 v[56:57], v9 offset:31232
    s_waitcnt lgkmcnt(0)
    s_barrier
    v_mfma_f32_32x32x16_bf16 v[60:75], v[34:37], v[26:29], v[60:75]
    ds_read_b128 v[10:13], v124 offset:0
    ds_read_b64_tr_b16 v[18:19], v9 offset:0
    ds_read_b64_tr_b16 v[20:21], v9 offset:512
    v_mfma_f32_32x32x16_bf16 v[76:91], v[38:41], v[26:29], v[76:91]
    ds_read_b64_tr_b16 v[22:23], v9 offset:8192
    ds_read_b64_tr_b16 v[24:25], v9 offset:8704
    v_mfma_f32_32x32x16_bf16 v[60:75], v[50:53], v[42:45], v[60:75]
    ds_read_b128 v[26:29], v125 offset:0
    ds_read_b64_tr_b16 v[34:35], v9 offset:2048
    ds_read_b64_tr_b16 v[36:37], v9 offset:2560
    v_mfma_f32_32x32x16_bf16 v[76:91], v[54:57], v[42:45], v[76:91]
    ds_read_b64_tr_b16 v[38:39], v9 offset:10240
    ds_read_b64_tr_b16 v[40:41], v9 offset:10752
    s_waitcnt lgkmcnt(5)
    v_mfma_f32_32x32x16_bf16 v[60:75], v[18:21], v[10:13], v[60:75]
    ds_read_b128 v[42:45], v126 offset:0
    ds_read_b64_tr_b16 v[50:51], v9 offset:4096
    ds_read_b64_tr_b16 v[52:53], v9 offset:4608
    v_mfma_f32_32x32x16_bf16 v[76:91], v[22:25], v[10:13], v[76:91]
    ds_read_b64_tr_b16 v[54:55], v9 offset:12288
    ds_read_b64_tr_b16 v[56:57], v9 offset:12800
    s_waitcnt lgkmcnt(5)
    v_mfma_f32_32x32x16_bf16 v[60:75], v[34:37], v[26:29], v[60:75]
    ds_read_b128 v[10:13], v127 offset:0
    ds_read_b64_tr_b16 v[18:19], v9 offset:6144
    ds_read_b64_tr_b16 v[20:21], v9 offset:6656
    v_mfma_f32_32x32x16_bf16 v[76:91], v[38:41], v[26:29], v[76:91]
    ds_read_b64_tr_b16 v[22:23], v9 offset:14336
    ds_read_b64_tr_b16 v[24:25], v9 offset:14848
    s_waitcnt lgkmcnt(0)
    s_barrier
    v_mfma_f32_32x32x16_bf16 v[60:75], v[50:53], v[42:45], v[60:75]
    ds_read_b128 v[26:29], v124 offset:16384
    ds_read_b64_tr_b16 v[34:35], v9 offset:16384
    ds_read_b64_tr_b16 v[36:37], v9 offset:16896
    v_mfma_f32_32x32x16_bf16 v[76:91], v[54:57], v[42:45], v[76:91]
    ds_read_b64_tr_b16 v[38:39], v9 offset:24576
    ds_read_b64_tr_b16 v[40:41], v9 offset:25088
    v_mfma_f32_32x32x16_bf16 v[60:75], v[18:21], v[10:13], v[60:75]
    ds_read_b128 v[42:45], v125 offset:16384
    ds_read_b64_tr_b16 v[50:51], v9 offset:18432
    ds_read_b64_tr_b16 v[52:53], v9 offset:18944
    v_mfma_f32_32x32x16_bf16 v[76:91], v[22:25], v[10:13], v[76:91]
    ds_read_b64_tr_b16 v[54:55], v9 offset:26624
    ds_read_b64_tr_b16 v[56:57], v9 offset:27136
    s_waitcnt lgkmcnt(5)
    v_mfma_f32_32x32x16_bf16 v[60:75], v[34:37], v[26:29], v[60:75]
    ds_read_b128 v[10:13], v126 offset:16384
    ds_read_b64_tr_b16 v[18:19], v9 offset:20480
    ds_read_b64_tr_b16 v[20:21], v9 offset:20992
    v_mfma_f32_32x32x16_bf16 v[76:91], v[38:41], v[26:29], v[76:91]
    ds_read_b64_tr_b16 v[22:23], v9 offset:28672
    ds_read_b64_tr_b16 v[24:25], v9 offset:29184
    s_waitcnt lgkmcnt(5)
    v_mfma_f32_32x32x16_bf16 v[60:75], v[50:53], v[42:45], v[60:75]
    ds_read_b128 v[26:29], v127 offset:16384
    ds_read_b64_tr_b16 v[34:35], v9 offset:22528
    ds_read_b64_tr_b16 v[36:37], v9 offset:23040
    v_mfma_f32_32x32x16_bf16 v[76:91], v[54:57], v[42:45], v[76:91]
    ds_read_b64_tr_b16 v[38:39], v9 offset:30720
    ds_read_b64_tr_b16 v[40:41], v9 offset:31232
    s_waitcnt lgkmcnt(0)
    s_barrier
    v_mfma_f32_32x32x16_bf16 v[60:75], v[18:21], v[10:13], v[60:75]
    v_mfma_f32_32x32x16_bf16 v[76:91], v[22:25], v[10:13], v[76:91]
    v_mfma_f32_32x32x16_bf16 v[60:75], v[34:37], v[26:29], v[60:75]
    v_mfma_f32_32x32x16_bf16 v[76:91], v[38:41], v[26:29], v[76:91]
    s_setprio 3
    s_lshl_b32 s62, s38, 2
    s_lshl_b32 s63, s98, 1
    s_add_u32 s62, s62, s63
    s_add_u32 s62, s62, s56
    s_lshl_b32 s60, s97, 1
    s_add_u32 s60, s60, s57
    s_mul_i32 s62, s62, 89
    s_cmp_ge_u32 s60, 43
    s_cselect_b32 s64, 0, 1.0
    s_lshl_b32 s60, s60, 1
    s_add_u32 s60, s60, s62
    s_lshl_b32 s60, s60, 10
    s_add_u32 s65, s60, 0x80e000
    v_lshlrev_b32 v1, 4, v0
    v_mul_f32 v42, 0xbfb8aa3b, v60
    v_mul_f32 v43, 0xbfb8aa3b, v61
    v_mul_f32 v44, 0xbfb8aa3b, v62
    v_mul_f32 v45, 0xbfb8aa3b, v63
    v_mul_f32 v46, 0xbfb8aa3b, v64
    v_mul_f32 v47, 0xbfb8aa3b, v65
    v_mul_f32 v48, 0xbfb8aa3b, v66
    v_mul_f32 v49, 0xbfb8aa3b, v67
    v_exp_f32 v42, v42
    v_exp_f32 v43, v43
    v_exp_f32 v44, v44
    v_exp_f32 v45, v45
    v_exp_f32 v46, v46
    v_exp_f32 v47, v47
    v_exp_f32 v48, v48
    v_exp_f32 v49, v49
    v_mul_f32 v76, v60, v76
    v_mul_f32 v77, v61, v77
    v_mul_f32 v78, v62, v78
    v_mul_f32 v79, v63, v79
    v_mul_f32 v80, v64, v80
    v_mul_f32 v81, v65, v81
    v_mul_f32 v82, v66, v82
    v_mul_f32 v83, v67, v83
    v_add_f32 v42, 1.0, v42
    v_add_f32 v43, 1.0, v43
    v_add_f32 v44, 1.0, v44
    v_add_f32 v45, 1.0, v45
    v_add_f32 v46, 1.0, v46
    v_add_f32 v47, 1.0, v47
    v_add_f32 v48, 1.0, v48
    v_add_f32 v49, 1.0, v49
    v_rcp_f32 v42, v42
    v_rcp_f32 v43, v43
    v_rcp_f32 v44, v44
    v_rcp_f32 v45, v45
    v_rcp_f32 v46, v46
    v_rcp_f32 v47, v47
    v_rcp_f32 v48, v48
    v_rcp_f32 v49, v49
    v_mul_f32 v76, s64, v76
    v_mul_f32 v77, s64, v77
    v_mul_f32 v78, s64, v78
    v_mul_f32 v79, s64, v79
    v_mul_f32 v80, s64, v80
    v_mul_f32 v81, s64, v81
    v_mul_f32 v82, s64, v82
    v_mul_f32 v83, s64, v83
    v_mul_f32 v76, v76, v42
    v_mul_f32 v77, v77, v43
    v_mul_f32 v78, v78, v44
    v_mul_f32 v79, v79, v45
    v_mul_f32 v80, v80, v46
    v_mul_f32 v81, v81, v47
    v_mul_f32 v82, v82, v48
    v_mul_f32 v83, v83, v49
    v_cvt_pk_bf16_f32 v76, v76, v77
    v_cvt_pk_bf16_f32 v77, v78, v79
    v_cvt_pk_bf16_f32 v78, v80, v81
    v_cvt_pk_bf16_f32 v79, v82, v83
    s_add_u32 s63, s65, 0
    buffer_store_dwordx4 v[76:79], v1, s[48:51], s63 offen sc0 sc1
    v_mul_f32 v42, 0xbfb8aa3b, v68
    v_mul_f32 v43, 0xbfb8aa3b, v69
    v_mul_f32 v44, 0xbfb8aa3b, v70
    v_mul_f32 v45, 0xbfb8aa3b, v71
    v_mul_f32 v46, 0xbfb8aa3b, v72
    v_mul_f32 v47, 0xbfb8aa3b, v73
    v_mul_f32 v48, 0xbfb8aa3b, v74
    v_mul_f32 v49, 0xbfb8aa3b, v75
    v_exp_f32 v42, v42
    v_exp_f32 v43, v43
    v_exp_f32 v44, v44
    v_exp_f32 v45, v45
    v_exp_f32 v46, v46
    v_exp_f32 v47, v47
    v_exp_f32 v48, v48
    v_exp_f32 v49, v49
    v_mul_f32 v84, v68, v84
    v_mul_f32 v85, v69, v85
    v_mul_f32 v86, v70, v86
    v_mul_f32 v87, v71, v87
    v_mul_f32 v88, v72, v88
    v_mul_f32 v89, v73, v89
    v_mul_f32 v90, v74, v90
    v_mul_f32 v91, v75, v91
    v_add_f32 v42, 1.0, v42
    v_add_f32 v43, 1.0, v43
    v_add_f32 v44, 1.0, v44
    v_add_f32 v45, 1.0, v45
    v_add_f32 v46, 1.0, v46
    v_add_f32 v47, 1.0, v47
    v_add_f32 v48, 1.0, v48
    v_add_f32 v49, 1.0, v49
    v_rcp_f32 v42, v42
    v_rcp_f32 v43, v43
    v_rcp_f32 v44, v44
    v_rcp_f32 v45, v45
    v_rcp_f32 v46, v46
    v_rcp_f32 v47, v47
    v_rcp_f32 v48, v48
    v_rcp_f32 v49, v49
    v_mul_f32 v84, s64, v84
    v_mul_f32 v85, s64, v85
    v_mul_f32 v86, s64, v86
    v_mul_f32 v87, s64, v87
    v_mul_f32 v88, s64, v88
    v_mul_f32 v89, s64, v89
    v_mul_f32 v90, s64, v90
    v_mul_f32 v91, s64, v91
    v_mul_f32 v84, v84, v42
    v_mul_f32 v85, v85, v43
    v_mul_f32 v86, v86, v44
    v_mul_f32 v87, v87, v45
    v_mul_f32 v88, v88, v46
    v_mul_f32 v89, v89, v47
    v_mul_f32 v90, v90, v48
    v_mul_f32 v91, v91, v49
    v_cvt_pk_bf16_f32 v84, v84, v85
    v_cvt_pk_bf16_f32 v85, v86, v87
    v_cvt_pk_bf16_f32 v86, v88, v89
    v_cvt_pk_bf16_f32 v87, v90, v91
    s_add_u32 s63, s65, 1024
    buffer_store_dwordx4 v[84:87], v1, s[48:51], s63 offen sc0 sc1
    s_branch fr_pub
fr_pub:
    s_cmp_eq_u32 s97, 16
    s_cselect_b32 s60, 23, 22
    s_cmp_eq_u32 s98, 0
    s_cselect_b32 s60, s97, s60
    s_lshr_b32 s62, s2, 6
    s_cmp_eq_u32 s62, 3
    s_cselect_b32 s60, s60, s92
    s_lshl_b32 s64, s38, 5
    s_add_u32 s64, s64, s60
    s_mov_b32 s48, s36
    s_mov_b32 s49, s37
    s_mov_b32 s50, 0x1000000
    s_mov_b32 s51, 0x20000
    s_waitcnt lgkmcnt(0)
    s_add_u32 s5, s91, 1
    s_waitcnt vmcnt(0)
    s_barrier
    s_cmp_lg_u32 s3, 0
    s_cbranch_scc1 pub_9
    s_lshl_b32 s60, s64, 7
    s_add_u32 s60, s60, 0xe06000
    v_mov_b32 v8, s5
    v_mov_b32 v9, 0
    s_mov_b64 exec, 1
    buffer_store_dword v8, v9, s[48:51], s60 offen sc0 sc1
    s_mov_b64 exec, -1
pub_9:
L_f_g3:
    s_mov_b32 s4, s2
    s_and_b32 s63, s4, 7
    s_lshr_b32 s64, s4, 3
    s_lshl_b32 s38, s63, 2
    s_and_b32 s60, s64, 3
    s_add_u32 s38, s38, s60
    s_lshr_b32 s39, s64, 2
    s_and_b32 s56, s3, 1
    s_lshr_b32 s57, s3, 1
    v_lshlrev_b32 v1, 4, v0
    v_bfe_u32 v8, v0, 2, 1
    v_bfe_u32 v9, v0, 4, 1
    v_xor_b32 v8, v8, v9
    v_lshlrev_b32 v8, 6, v8
    v_and_b32 v9, 3, v0
    v_lshlrev_b32 v9, 4, v9
    v_lshrrev_b32 v10, 3, v0
    v_lshlrev_b32 v10, 10, v10
    v_add3_u32 v2, v8, v9, v10
    v_lshrrev_b32 v8, 5, v0
    v_lshlrev_b32 v8, 2, v8
    v_bfe_u32 v9, v0, 2, 2
    v_add_u32 v8, v8, v9
    v_lshlrev_b32 v8, 7, v8
    v_bfe_u32 v9, v0, 4, 1
    v_lshlrev_b32 v9, 5, v9
    v_and_b32 v10, 3, v0
    v_lshlrev_b32 v10, 3, v10
    v_add3_u32 v8, v8, v9, v10
    v_bfe_u32 v9, v0, 3, 1
    v_lshlrev_b32 v9, 6, v9
    v_add_u32 v5, v8, v9
    s_lshl_b32 s60, s57, 12
    v_add_u32 v4, s60, v5
    v_xor_b32 v6, 64, v4
    s_lshl_b32 s60, s38, 1
    s_add_u32 s60, s60, s56
    s_mul_i32 s65, s60, 89
    s_and_b32 s63, s57, 1
    s_lshl_b32 s63, s63, 1
    s_add_u32 s65, s65, s63
    s_lshl_b32 s65, s65, 10
    s_add_u32 s65, s65, 0x80e000
    s_lshr_b32 s66, s57, 1
    s_lshl_b32 s59, s3, 13
    s_lshl_b32 s60, s39, 7
    s_add_u32 s59, s59, s60
    s_lshl_b32 s61, s3, 10
    s_mov_b32 s40, s28
    s_mov_b32 s41, s29
    s_mov_b32 s42, 0x158000
    s_mov_b32 s43, 0x20000
    s_mov_b32 s44, s20
    s_mov_b32 s45, s21
    s_mov_b32 s46, 0x80000
    s_mov_b32 s47, 0x20000
    s_mov_b32 s48, s36
    s_mov_b32 s49, s37
    s_mov_b32 s50, 0x1000000
    s_mov_b32 s51, 0x20000
    s_mov_b32 s52, s32
    s_mov_b32 s53, s33
    s_mov_b32 s54, 0x200000
    s_mov_b32 s55, 0x20000
    s_add_u32 m0, s61, 0x0
    s_add_u32 s60, s59, 0x0
    buffer_load_dwordx4 v2, s[40:43], s60 offen lds
    s_add_u32 m0, s61, 0x2000
    s_add_u32 s60, s59, 0x10000
    buffer_load_dwordx4 v2, s[40:43], s60 offen lds
    s_add_u32 m0, s61, 0x4000
    s_add_u32 s60, s59, 0x20000
    buffer_load_dwordx4 v2, s[40:43], s60 offen lds
    s_add_u32 m0, s61, 0x6000
    s_add_u32 s60, s59, 0x30000
    buffer_load_dwordx4 v2, s[40:43], s60 offen lds
    s_add_u32 m0, s61, 0x8000
    s_add_u32 s60, s59, 0x40000
    buffer_load_dwordx4 v2, s[40:43], s60 offen lds
    s_add_u32 m0, s61, 0xa000
    s_add_u32 s60, s59, 0x60000
    buffer_load_dwordx4 v2, s[40:43], s60 offen lds
    s_add_u32 m0, s61, 0xc000
    s_add_u32 s60, s59, 0x70000
    buffer_load_dwordx4 v2, s[40:43], s60 offen lds
    s_add_u32 m0, s61, 0xe000
    s_add_u32 s60, s59, 0x80000
    buffer_load_dwordx4 v2, s[40:43], s60 offen lds
    s_lshl_b32 s60, s38, 16
    v_mov_b32 v125, 0
    buffer_load_dword v125, v125, s[52:55], s60 offen
    s_lshr_b32 s60, s4, 3
    s_lshl_b32 s62, s3, 5
    s_add_u32 s60, s60, s62
    s_and_b32 s62, s4, 7
    s_min_u32 s60, s60, 235
    s_cmp_ge_u32 s60, 172
    s_cselect_b32 s92, s20, s28
    s_cselect_b32 s93, s21, s29
    s_cselect_b32 s62, 172, 0
    s_mov_b32 s94, 0x158000
    s_cselect_b32 s42, 0x80000, s94
    s_mov_b32 s40, s92
    s_mov_b32 s41, s93
    s_mov_b32 s43, 0x20000
    s_sub_u32 s60, s60, s62
    s_lshl_b32 s60, s60, 13
    v_lshlrev_b32 v8, 7, v0
    buffer_load_dword v124, v8, s[40:43], s60 offen
    s_mov_b32 s40, s28
    s_mov_b32 s41, s29
    s_mov_b32 s42, 0x158000
    s_mov_b32 s43, 0x20000
    s_lshr_b32 s60, s38, 1
    s_lshl_b32 s60, s60, 12
    s_add_u32 s60, s60, 0xe06000
    v_lshlrev_b32 v10, 7, v0
    v_add_u32 v10, s60, v10
    v_mov_b32 v122, v10
    s_lshl_b32 s60, s38, 8
    s_add_u32 s60, s60, 0xe1d400
    v_lshlrev_b32 v11, 7, v0
    v_add_u32 v11, s60, v11
    v_cmp_gt_u32 vcc, 24, v0
    s_nop 1
    v_cndmask_b32 v10, v11, v10, vcc
    s_waitcnt lgkmcnt(0)
    s_add_u32 s5, s91, 1
    s_cmp_lg_u32 s3, 0
    s_cbranch_scc1 wfd_14
    s_mov_b32 s60, 0
    s_mov_b32 s62, 0x33effdf
    s_mov_b32 s63, 0x0
wf_11:
    s_mov_b64 exec, s[62:63]
    buffer_load_dword v8, v10, s[48:51], 0 offen sc0 sc1
    s_waitcnt vmcnt(0)
    v_cmp_eq_u32 vcc, s5, v8
    s_andn2_b64 s[62:63], s[62:63], vcc
    s_cbranch_scc0 wfd_14_x
    s_add_u32 s60, s60, 1
    s_cmp_lt_u32 s60, 32768
    s_cbranch_scc0 wfd_14_x
    s_sleep 4
    s_branch wf_11
wfd_14_x:
    s_mov_b64 exec, -1
wfd_14:
    s_barrier
    s_lshl_b32 s60, s38, 3
    s_lshl_b32 s64, s56, 2
    s_add_u32 s60, s60, s64
    s_lshl_b32 s60, s60, 7
    s_add_u32 s60, s60, 0x805000
    v_bfe_u32 v11, v0, 3, 2
    v_lshlrev_b32 v11, 7, v11
    v_and_b32 v10, 7, v0
    v_lshl_add_u32 v11, v10, 2, v11
    buffer_load_dword v126, v11, s[48:51], s60 offen sc1
    s_mul_i32 s62, s66, 4096
    s_add_u32 s62, s62, s65
    s_add_u32 s60, s62, 0
    buffer_load_dwordx4 v[72:75], v1, s[48:51], s60 offen sc1
    s_add_u32 s60, s62, 1024
    buffer_load_dwordx4 v[76:79], v1, s[48:51], s60 offen sc1
    s_mul_i32 s62, s66, 4096
    s_add_u32 s62, s62, s65
    s_add_u32 s60, s62, 8192
    buffer_load_dwordx4 v[80:83], v1, s[48:51], s60 offen sc1
    s_add_u32 s60, s62, 9216
    buffer_load_dwordx4 v[84:87], v1, s[48:51], s60 offen sc1
    s_mul_i32 s62, s66, 8192
    s_add_u32 s62, s62, s65
    s_add_u32 s60, s62, 16384
    buffer_load_dwordx4 v[88:91], v1, s[48:51], s60 offen sc1
    s_add_u32 s60, s62, 17408
    buffer_load_dwordx4 v[92:95], v1, s[48:51], s60 offen sc1
    s_mul_i32 s62, s66, 4096
    s_add_u32 s62, s62, s65
    s_add_u32 s60, s62, 28672
    buffer_load_dwordx4 v[96:99], v1, s[48:51], s60 offen sc1
    s_add_u32 s60, s62, 29696
    buffer_load_dwordx4 v[100:103], v1, s[48:51], s60 offen sc1
    s_setprio 0
    s_waitcnt vmcnt(6)
    s_barrier
    ds_read_b64_tr_b16 v[8:9], v4 offset:0
    ds_read_b64_tr_b16 v[10:11], v4 offset:1024
    ds_read_b64_tr_b16 v[12:13], v6 offset:0
    ds_read_b64_tr_b16 v[14:15], v6 offset:1024
    ds_read_b64_tr_b16 v[16:17], v4 offset:2048
    ds_read_b64_tr_b16 v[18:19], v4 offset:3072
    ds_read_b64_tr_b16 v[20:21], v6 offset:2048
    ds_read_b64_tr_b16 v[22:23], v6 offset:3072
    s_waitcnt lgkmcnt(0)
    s_waitcnt vmcnt(4)
    ds_read_b64_tr_b16 v[24:25], v4 offset:16384
    ds_read_b64_tr_b16 v[26:27], v4 offset:17408
    ds_read_b64_tr_b16 v[28:29], v6 offset:16384
    ds_read_b64_tr_b16 v[30:31], v6 offset:17408
    ds_read_b64_tr_b16 v[32:33], v4 offset:18432
    ds_read_b64_tr_b16 v[34:35], v4 offset:19456
    ds_read_b64_tr_b16 v[36:37], v6 offset:18432
    ds_read_b64_tr_b16 v[38:39], v6 offset:19456
    v_mfma_f32_32x32x16_bf16 v[40:55], v[8:11], v[72:75], 0
    v_mfma_f32_32x32x16_bf16 v[56:71], v[12:15], v[72:75], 0
    v_mfma_f32_32x32x16_bf16 v[40:55], v[16:19], v[76:79], v[40:55]
    v_mfma_f32_32x32x16_bf16 v[56:71], v[20:23], v[76:79], v[56:71]
    s_mul_i32 s62, s66, 4096
    s_add_u32 s62, s62, s65
    s_add_u32 s60, s62, 36864
    buffer_load_dwordx4 v[72:75], v1, s[48:51], s60 offen sc1
    s_add_u32 s60, s62, 37888
    buffer_load_dwordx4 v[76:79], v1, s[48:51], s60 offen sc1
    s_waitcnt lgkmcnt(0)
    s_waitcnt vmcnt(4)
    s_barrier
    s_add_u32 m0, s61, 0x0
    s_add_u32 s60, s59, 0x90000
    buffer_load_dwordx4 v2, s[40:43], s60 offen lds
    s_add_u32 m0, s61, 0x2000
    s_add_u32 s60, s59, 0xa0000
    buffer_load_dwordx4 v2, s[40:43], s60 offen lds
    s_add_u32 m0, s61, 0x4000
    s_add_u32 s60, s59, 0xb0000
    buffer_load_dwordx4 v2, s[40:43], s60 offen lds
    s_add_u32 m0, s61, 0x6000
    s_add_u32 s60, s59, 0xc0000
    buffer_load_dwordx4 v2, s[40:43], s60 offen lds
    ds_read_b64_tr_b16 v[8:9], v4 offset:32768
    ds_read_b64_tr_b16 v[10:11], v4 offset:33792
    ds_read_b64_tr_b16 v[12:13], v6 offset:32768
    ds_read_b64_tr_b16 v[14:15], v6 offset:33792
    ds_read_b64_tr_b16 v[16:17], v4 offset:34816
    ds_read_b64_tr_b16 v[18:19], v4 offset:35840
    ds_read_b64_tr_b16 v[20:21], v6 offset:34816
    ds_read_b64_tr_b16 v[22:23], v6 offset:35840
    v_mfma_f32_32x32x16_bf16 v[40:55], v[24:27], v[80:83], v[40:55]
    v_mfma_f32_32x32x16_bf16 v[56:71], v[28:31], v[80:83], v[56:71]
    v_mfma_f32_32x32x16_bf16 v[40:55], v[32:35], v[84:87], v[40:55]
    v_mfma_f32_32x32x16_bf16 v[56:71], v[36:39], v[84:87], v[56:71]
    s_mul_i32 s62, s66, 4096
    s_add_u32 s62, s62, s65
    s_add_u32 s60, s62, 45056
    buffer_load_dwordx4 v[80:83], v1, s[48:51], s60 offen sc1
    s_add_u32 s60, s62, 46080
    buffer_load_dwordx4 v[84:87], v1, s[48:51], s60 offen sc1
    s_waitcnt lgkmcnt(0)
    s_waitcnt vmcnt(8)
    ds_read_b64_tr_b16 v[24:25], v4 offset:49152
    ds_read_b64_tr_b16 v[26:27], v4 offset:50176
    ds_read_b64_tr_b16 v[28:29], v6 offset:49152
    ds_read_b64_tr_b16 v[30:31], v6 offset:50176
    ds_read_b64_tr_b16 v[32:33], v4 offset:51200
    ds_read_b64_tr_b16 v[34:35], v4 offset:52224
    ds_read_b64_tr_b16 v[36:37], v6 offset:51200
    ds_read_b64_tr_b16 v[38:39], v6 offset:52224
    v_mfma_f32_32x32x16_bf16 v[40:55], v[8:11], v[88:91], v[40:55]
    v_mfma_f32_32x32x16_bf16 v[56:71], v[12:15], v[88:91], v[56:71]
    v_mfma_f32_32x32x16_bf16 v[40:55], v[16:19], v[92:95], v[40:55]
    v_mfma_f32_32x32x16_bf16 v[56:71], v[20:23], v[92:95], v[56:71]
    s_mul_i32 s62, s66, 4096
    s_add_u32 s62, s62, s65
    s_add_u32 s60, s62, 53248
    buffer_load_dwordx4 v[88:91], v1, s[48:51], s60 offen sc1
    s_add_u32 s60, s62, 54272
    buffer_load_dwordx4 v[92:95], v1, s[48:51], s60 offen sc1
    s_waitcnt lgkmcnt(0)
    s_waitcnt vmcnt(4)
    s_barrier
    s_add_u32 m0, s61, 0x8000
    s_add_u32 s60, s59, 0xd0000
    buffer_load_dwordx4 v2, s[40:43], s60 offen lds
    s_add_u32 m0, s61, 0xa000
    s_add_u32 s60, s59, 0xe0000
    buffer_load_dwordx4 v2, s[40:43], s60 offen lds
    s_add_u32 m0, s61, 0xc000
    s_add_u32 s60, s59, 0xf0000
    buffer_load_dwordx4 v2, s[40:43], s60 offen lds
    s_add_u32 m0, s61, 0xe000
    s_add_u32 s60, s59, 0x110000
    buffer_load_dwordx4 v2, s[40:43], s60 offen lds
    ds_read_b64_tr_b16 v[8:9], v4 offset:0
    ds_read_b64_tr_b16 v[10:11], v4 offset:1024
    ds_read_b64_tr_b16 v[12:13], v6 offset:0
    ds_read_b64_tr_b16 v[14:15], v6 offset:1024
    ds_read_b64_tr_b16 v[16:17], v4 offset:2048
    ds_read_b64_tr_b16 v[18:19], v4 offset:3072
    ds_read_b64_tr_b16 v[20:21], v6 offset:2048
    ds_read_b64_tr_b16 v[22:23], v6 offset:3072
    v_mfma_f32_32x32x16_bf16 v[40:55], v[24:27], v[96:99], v[40:55]
    v_mfma_f32_32x32x16_bf16 v[56:71], v[28:31], v[96:99], v[56:71]
    v_mfma_f32_32x32x16_bf16 v[40:55], v[32:35], v[100:103], v[40:55]
    v_mfma_f32_32x32x16_bf16 v[56:71], v[36:39], v[100:103], v[56:71]
    s_mul_i32 s62, s66, 8192
    s_add_u32 s62, s62, s65
    s_add_u32 s60, s62, 61440
    buffer_load_dwordx4 v[96:99], v1, s[48:51], s60 offen sc1
    s_add_u32 s60, s62, 62464
    buffer_load_dwordx4 v[100:103], v1, s[48:51], s60 offen sc1
    s_waitcnt lgkmcnt(0)
    s_waitcnt vmcnt(8)
    ds_read_b64_tr_b16 v[24:25], v4 offset:16384
    ds_read_b64_tr_b16 v[26:27], v4 offset:17408
    ds_read_b64_tr_b16 v[28:29], v6 offset:16384
    ds_read_b64_tr_b16 v[30:31], v6 offset:17408
    ds_read_b64_tr_b16 v[32:33], v4 offset:18432
    ds_read_b64_tr_b16 v[34:35], v4 offset:19456
    ds_read_b64_tr_b16 v[36:37], v6 offset:18432
    ds_read_b64_tr_b16 v[38:39], v6 offset:19456
    v_mfma_f32_32x32x16_bf16 v[40:55], v[8:11], v[72:75], v[40:55]
    v_mfma_f32_32x32x16_bf16 v[56:71], v[12:15], v[72:75], v[56:71]
    v_mfma_f32_32x32x16_bf16 v[40:55], v[16:19], v[76:79], v[40:55]
    v_mfma_f32_32x32x16_bf16 v[56:71], v[20:23], v[76:79], v[56:71]
    s_mul_i32 s62, s66, 4096
    s_add_u32 s62, s62, s65
    s_add_u32 s60, s62, 73728
    buffer_load_dwordx4 v[72:75], v1, s[48:51], s60 offen sc1
    s_add_u32 s60, s62, 74752
    buffer_load_dwordx4 v[76:79], v1, s[48:51], s60 offen sc1
    s_waitcnt lgkmcnt(0)
    s_waitcnt vmcnt(4)
    s_barrier
    s_add_u32 m0, s61, 0x0
    s_add_u32 s60, s59, 0x120000
    buffer_load_dwordx4 v2, s[40:43], s60 offen lds
    s_add_u32 m0, s61, 0x2000
    s_add_u32 s60, s59, 0x130000
    buffer_load_dwordx4 v2, s[40:43], s60 offen lds
    s_add_u32 m0, s61, 0x4000
    s_add_u32 s60, s59, 0x140000
    buffer_load_dwordx4 v2, s[40:43], s60 offen lds
    s_add_u32 m0, s61, 0x6000
    s_add_u32 s60, s59, 0x150000
    buffer_load_dwordx4 v2, s[40:43], s60 offen lds
    ds_read_b64_tr_b16 v[8:9], v4 offset:32768
    ds_read_b64_tr_b16 v[10:11], v4 offset:33792
    ds_read_b64_tr_b16 v[12:13], v6 offset:32768
    ds_read_b64_tr_b16 v[14:15], v6 offset:33792
    ds_read_b64_tr_b16 v[16:17], v4 offset:34816
    ds_read_b64_tr_b16 v[18:19], v4 offset:35840
    ds_read_b64_tr_b16 v[20:21], v6 offset:34816
    ds_read_b64_tr_b16 v[22:23], v6 offset:35840
    v_mfma_f32_32x32x16_bf16 v[40:55], v[24:27], v[80:83], v[40:55]
    v_mfma_f32_32x32x16_bf16 v[56:71], v[28:31], v[80:83], v[56:71]
    v_mfma_f32_32x32x16_bf16 v[40:55], v[32:35], v[84:87], v[40:55]
    v_mfma_f32_32x32x16_bf16 v[56:71], v[36:39], v[84:87], v[56:71]
    s_mul_i32 s62, s66, 4096
    s_add_u32 s62, s62, s65
    s_add_u32 s60, s62, 81920
    buffer_load_dwordx4 v[80:83], v1, s[48:51], s60 offen sc1
    s_add_u32 s60, s62, 82944
    buffer_load_dwordx4 v[84:87], v1, s[48:51], s60 offen sc1
    s_waitcnt lgkmcnt(0)
    s_waitcnt vmcnt(8)
    ds_read_b64_tr_b16 v[24:25], v4 offset:49152
    ds_read_b64_tr_b16 v[26:27], v4 offset:50176
    ds_read_b64_tr_b16 v[28:29], v6 offset:49152
    ds_read_b64_tr_b16 v[30:31], v6 offset:50176
    ds_read_b64_tr_b16 v[32:33], v4 offset:51200
    ds_read_b64_tr_b16 v[34:35], v4 offset:52224
    ds_read_b64_tr_b16 v[36:37], v6 offset:51200
    ds_read_b64_tr_b16 v[38:39], v6 offset:52224
    v_mfma_f32_32x32x16_bf16 v[40:55], v[8:11], v[88:91], v[40:55]
    v_mfma_f32_32x32x16_bf16 v[56:71], v[12:15], v[88:91], v[56:71]
    v_mfma_f32_32x32x16_bf16 v[40:55], v[16:19], v[92:95], v[40:55]
    v_mfma_f32_32x32x16_bf16 v[56:71], v[20:23], v[92:95], v[56:71]
    s_setprio 3
    s_and_b32 s60, s38, 1
    s_mul_i32 s60, s60, 17
    v_mov_b32 v123, 5
    v_cmp_eq_u32 vcc, 1, v0
    v_mov_b32 v121, 16
    s_nop 0
    v_cndmask_b32 v123, v123, v121, vcc
    s_cmp_eq_u32 s60, 0
    s_cselect_b32 s62, 0, 17
    s_cselect_b32 s63, 0, 7
    v_mov_b32 v121, s62
    v_mov_b32 v120, s63
    v_cndmask_b32 v121, v121, v120, vcc
    v_add_u32 v123, v123, v121
    v_lshlrev_b32 v123, 7, v123
    v_readfirstlane_b32 s60, v122
    s_nop 3
    v_add_u32 v123, s60, v123
    s_waitcnt lgkmcnt(0)
    s_add_u32 s5, s91, 1
    s_cmp_lg_u32 s3, 0
    s_cbranch_scc1 wfd_18
    s_mov_b32 s60, 0
    s_mov_b32 s62, 0x3
    s_mov_b32 s63, 0x0
wf_15:
    s_mov_b64 exec, s[62:63]
    buffer_load_dword v8, v123, s[48:51], 0 offen sc0 sc1
    s_waitcnt vmcnt(0)
    v_cmp_eq_u32 vcc, s5, v8
    s_andn2_b64 s[62:63], s[62:63], vcc
    s_cbranch_scc0 wfd_18_x
    s_add_u32 s60, s60, 1
    s_cmp_lt_u32 s60, 32768
    s_cbranch_scc0 wfd_18_x
    s_sleep 2
    s_branch wf_15
wfd_18_x:
    s_mov_b64 exec, -1
wfd_18:
    s_barrier
    s_setprio 0
    s_mul_i32 s62, s66, 45056
    s_add_u32 s62, s62, s65
    s_add_u32 s60, s62, 20480
    buffer_load_dwordx4 v[88:91], v1, s[48:51], s60 offen sc1
    s_add_u32 s60, s62, 21504
    buffer_load_dwordx4 v[92:95], v1, s[48:51], s60 offen sc1
    s_waitcnt lgkmcnt(0)
    s_waitcnt vmcnt(4)
    s_barrier
    s_add_u32 m0, s61, 0x8000
    s_add_u32 s60, s59, 0x50000
    buffer_load_dwordx4 v2, s[40:43], s60 offen lds
    s_add_u32 m0, s61, 0xa000
    s_add_u32 s60, s59, 0x100000
    buffer_load_dwordx4 v2, s[40:43], s60 offen lds
    ds_read_b64_tr_b16 v[8:9], v4 offset:0
    ds_read_b64_tr_b16 v[10:11], v4 offset:1024
    ds_read_b64_tr_b16 v[12:13], v6 offset:0
    ds_read_b64_tr_b16 v[14:15], v6 offset:1024
    ds_read_b64_tr_b16 v[16:17], v4 offset:2048
    ds_read_b64_tr_b16 v[18:19], v4 offset:3072
    ds_read_b64_tr_b16 v[20:21], v6 offset:2048
    ds_read_b64_tr_b16 v[22:23], v6 offset:3072
    v_mfma_f32_32x32x16_bf16 v[40:55], v[24:27], v[96:99], v[40:55]
    v_mfma_f32_32x32x16_bf16 v[56:71], v[28:31], v[96:99], v[56:71]
    v_mfma_f32_32x32x16_bf16 v[40:55], v[32:35], v[100:103], v[40:55]
    v_mfma_f32_32x32x16_bf16 v[56:71], v[36:39], v[100:103], v[56:71]
    s_waitcnt lgkmcnt(0)
    s_waitcnt vmcnt(4)
    ds_read_b64_tr_b16 v[24:25], v4 offset:16384
    ds_read_b64_tr_b16 v[26:27], v4 offset:17408
    ds_read_b64_tr_b16 v[28:29], v6 offset:16384
    ds_read_b64_tr_b16 v[30:31], v6 offset:17408
    ds_read_b64_tr_b16 v[32:33], v4 offset:18432
    ds_read_b64_tr_b16 v[34:35], v4 offset:19456
    ds_read_b64_tr_b16 v[36:37], v6 offset:18432
    ds_read_b64_tr_b16 v[38:39], v6 offset:19456
    v_mfma_f32_32x32x16_bf16 v[40:55], v[8:11], v[72:75], v[40:55]
    v_mfma_f32_32x32x16_bf16 v[56:71], v[12:15], v[72:75], v[56:71]
    v_mfma_f32_32x32x16_bf16 v[40:55], v[16:19], v[76:79], v[40:55]
    v_mfma_f32_32x32x16_bf16 v[56:71], v[20:23], v[76:79], v[56:71]
    s_waitcnt lgkmcnt(0)
    s_waitcnt vmcnt(0)
    s_barrier
    ds_read_b64_tr_b16 v[8:9], v4 offset:32768
    ds_read_b64_tr_b16 v[10:11], v4 offset:33792
    ds_read_b64_tr_b16 v[12:13], v6 offset:32768
    ds_read_b64_tr_b16 v[14:15], v6 offset:33792
    ds_read_b64_tr_b16 v[16:17], v4 offset:34816
    ds_read_b64_tr_b16 v[18:19], v4 offset:35840
    ds_read_b64_tr_b16 v[20:21], v6 offset:34816
    ds_read_b64_tr_b16 v[22:23], v6 offset:35840
    v_mfma_f32_32x32x16_bf16 v[40:55], v[24:27], v[80:83], v[40:55]
    v_mfma_f32_32x32x16_bf16 v[56:71], v[28:31], v[80:83], v[56:71]
    v_mfma_f32_32x32x16_bf16 v[40:55], v[32:35], v[84:87], v[40:55]
    v_mfma_f32_32x32x16_bf16 v[56:71], v[36:39], v[84:87], v[56:71]
    s_waitcnt lgkmcnt(0)
    v_mfma_f32_32x32x16_bf16 v[40:55], v[8:11], v[88:91], v[40:55]
    v_mfma_f32_32x32x16_bf16 v[56:71], v[12:15], v[88:91], v[56:71]
    v_mfma_f32_32x32x16_bf16 v[40:55], v[16:19], v[92:95], v[40:55]
    v_mfma_f32_32x32x16_bf16 v[56:71], v[20:23], v[92:95], v[56:71]
    s_setprio 3
    s_barrier
    s_add_u32 m0, s61, 0x0
    s_add_u32 s60, s59, 0x0
    buffer_load_dwordx4 v2, s[44:47], s60 offen lds
    s_add_u32 m0, s61, 0x2000
    s_add_u32 s60, s59, 0x10000
    buffer_load_dwordx4 v2, s[44:47], s60 offen lds
    s_add_u32 m0, s61, 0x4000
    s_add_u32 s60, s59, 0x20000
    buffer_load_dwordx4 v2, s[44:47], s60 offen lds
    s_add_u32 m0, s61, 0x6000
    s_add_u32 s60, s59, 0x30000
    buffer_load_dwordx4 v2, s[44:47], s60 offen lds
    s_add_u32 m0, s61, 0x8000
    s_add_u32 s60, s59, 0x40000
    buffer_load_dwordx4 v2, s[44:47], s60 offen lds
    s_add_u32 m0, s61, 0xa000
    s_add_u32 s60, s59, 0x50000
    buffer_load_dwordx4 v2, s[44:47], s60 offen lds
    s_add_u32 m0, s61, 0xc000
    s_add_u32 s60, s59, 0x60000
    buffer_load_dwordx4 v2, s[44:47], s60 offen lds
    s_add_u32 m0, s61, 0xe000
    s_add_u32 s60, s59, 0x70000
    buffer_load_dwordx4 v2, s[44:47], s60 offen lds
    v_mov_b32 v7, v126
    v_sub_f32 v121, 1.0, v126
    v_mul_f32 v40, v121, v40
    v_mul_f32 v41, v121, v41
    v_mul_f32 v42, v121, v42
    v_mul_f32 v43, v121, v43
    v_mul_f32 v44, v121, v44
    v_mul_f32 v45, v121, v45
    v_mul_f32 v46, v121, v46
    v_mul_f32 v47, v121, v47
    v_mul_f32 v48, v121, v48
    v_mul_f32 v49, v121, v49
    v_mul_f32 v50, v121, v50
    v_mul_f32 v51, v121, v51
    v_mul_f32 v52, v121, v52
    v_mul_f32 v53, v121, v53
    v_mul_f32 v54, v121, v54
    v_mul_f32 v55, v121, v55
    v_mul_f32 v56, v121, v56
    v_mul_f32 v57, v121, v57
    v_mul_f32 v58, v121, v58
    v_mul_f32 v59, v121, v59
    v_mul_f32 v60, v121, v60
    v_mul_f32 v61, v121, v61
    v_mul_f32 v62, v121, v62
    v_mul_f32 v63, v121, v63
    v_mul_f32 v64, v121, v64
    v_mul_f32 v65, v121, v65
    v_mul_f32 v66, v121, v66
    v_mul_f32 v67, v121, v67
    v_mul_f32 v68, v121, v68
    v_mul_f32 v69, v121, v69
    v_mul_f32 v70, v121, v70
    v_mul_f32 v71, v121, v71
    s_lshl_b32 s64, s57, 14
    v_add_u32 v4, s64, v5
    v_xor_b32 v6, 64, v4
    v_and_b32 v8, 31, v0
    s_lshl_b32 s60, s56, 5
    v_add_u32 v8, s60, v8
    v_mul_u32_u24 v8, 272, v8
    v_lshrrev_b32 v9, 5, v0
    v_lshlrev_b32 v9, 4, v9
    s_mul_i32 s60, s57, 17408
    v_add3_u32 v2, v8, v9, s60
    s_lshl_b32 s60, s3, 3
    v_lshrrev_b32 v8, 3, v0
    v_add_u32 v8, s60, v8
    v_and_b32 v9, 7, v0
    v_mul_u32_u24 v3, 272, v8
    v_lshlrev_b32 v10, 5, v9
    v_add_u32 v3, v3, v10
    v_lshlrev_b32 v8, 10, v8
    v_lshlrev_b32 v9, 4, v9
    v_add_u32 v5, v8, v9
    s_lshl_b32 s66, s38, 16
    s_lshl_b32 s63, s39, 7
    s_add_u32 s66, s66, s63
    s_lshl_b32 s60, s38, 1
    s_add_u32 s60, s60, s56
    s_lshl_b32 s60, s60, 5
    s_lshl_b32 s64, s57, 3
    s_add_u32 s60, s60, s64
    s_lshl_b32 s60, s60, 10
    s_add_u32 s67, s60, 0x604000
    s_lshr_b32 s60, s38, 2
    s_lshl_b32 s60, s60, 12
    s_add_u32 s60, s60, 0xe16000
    v_lshlrev_b32 v10, 7, v0
    v_add_u32 v10, s60, v10
    s_waitcnt vmcnt(0)
    s_waitcnt lgkmcnt(0)
    s_add_u32 s5, s91, 1
    s_cmp_lg_u32 s3, 0
    s_cbranch_scc1 wfd_22
    s_mov_b32 s60, 0
    s_mov_b32 s62, 0xffffffff
    s_mov_b32 s63, 0x0
    s_mov_b64 exec, 1
wf1_20:
    buffer_load_dword v8, v10, s[48:51], 0 offen sc0 sc1
    s_waitcnt vmcnt(0)
    v_cmp_eq_u32 vcc, s5, v8
    s_cmp_lg_u64 vcc, 0
    s_cbranch_scc1 wf2_21
    s_add_u32 s60, s60, 1
    s_cmp_lt_u32 s60, 32768
    s_cbranch_scc0 wf2_21
    s_sleep 4
    s_branch wf1_20
wf2_21:
wf_19:
    s_mov_b64 exec, s[62:63]
    buffer_load_dword v8, v10, s[48:51], 0 offen sc0 sc1
    s_waitcnt vmcnt(0)
    v_cmp_eq_u32 vcc, s5, v8
    s_andn2_b64 s[62:63], s[62:63], vcc
    s_cbranch_scc0 wfd_22_x
    s_add_u32 s60, s60, 1
    s_cmp_lt_u32 s60, 32768
    s_cbranch_scc0 wfd_22_x
    s_branch wf_19
wfd_22_x:
    s_mov_b64 exec, -1
wfd_22:
    s_barrier
    s_add_u32 s64, s67, 0
    buffer_load_dwordx4 v[24:27], v1, s[48:51], s64 offen sc1
    s_add_u32 s64, s67, 1024
    buffer_load_dwordx4 v[28:31], v1, s[48:51], s64 offen sc1
    s_add_u32 s64, s67, 2048
    buffer_load_dwordx4 v[32:35], v1, s[48:51], s64 offen sc1
    s_add_u32 s64, s67, 3072
    buffer_load_dwordx4 v[36:39], v1, s[48:51], s64 offen sc1
    s_add_u32 s64, s67, 4096
    buffer_load_dwordx4 v[104:107], v1, s[48:51], s64 offen sc1
    s_add_u32 s64, s67, 5120
    buffer_load_dwordx4 v[108:111], v1, s[48:51], s64 offen sc1
    s_add_u32 s64, s67, 6144
    buffer_load_dwordx4 v[112:115], v1, s[48:51], s64 offen sc1
    s_add_u32 s64, s67, 7168
    buffer_load_dwordx4 v[116:119], v1, s[48:51], s64 offen sc1
    ds_read_b64_tr_b16 v[8:9], v4 offset:0
    ds_read_b64_tr_b16 v[10:11], v4 offset:1024
    ds_read_b64_tr_b16 v[12:13], v6 offset:0
    ds_read_b64_tr_b16 v[14:15], v6 offset:1024
    ds_read_b64_tr_b16 v[16:17], v4 offset:2048
    ds_read_b64_tr_b16 v[18:19], v4 offset:3072
    ds_read_b64_tr_b16 v[20:21], v6 offset:2048
    ds_read_b64_tr_b16 v[22:23], v6 offset:3072
    s_waitcnt vmcnt(7) lgkmcnt(4)
    v_mfma_f32_32x32x16_bf16 v[72:87], v[8:11], v[24:27], 0
    ds_read_b64_tr_b16 v[120:121], v4 offset:4096
    ds_read_b64_tr_b16 v[122:123], v4 offset:5120
    v_mfma_f32_32x32x16_bf16 v[88:103], v[12:15], v[24:27], 0
    ds_read_b64_tr_b16 v[124:125], v6 offset:4096
    ds_read_b64_tr_b16 v[126:127], v6 offset:5120
    s_waitcnt vmcnt(6) lgkmcnt(4)
    v_mfma_f32_32x32x16_bf16 v[72:87], v[16:19], v[28:31], v[72:87]
    ds_read_b64_tr_b16 v[8:9], v4 offset:6144
    ds_read_b64_tr_b16 v[10:11], v4 offset:7168
    v_mfma_f32_32x32x16_bf16 v[88:103], v[20:23], v[28:31], v[88:103]
    ds_read_b64_tr_b16 v[12:13], v6 offset:6144
    ds_read_b64_tr_b16 v[14:15], v6 offset:7168
    s_waitcnt vmcnt(5) lgkmcnt(4)
    v_mfma_f32_32x32x16_bf16 v[72:87], v[120:123], v[32:35], v[72:87]
    ds_read_b64_tr_b16 v[16:17], v4 offset:8192
    ds_read_b64_tr_b16 v[18:19], v4 offset:9216
    v_mfma_f32_32x32x16_bf16 v[88:103], v[124:127], v[32:35], v[88:103]
    ds_read_b64_tr_b16 v[20:21], v6 offset:8192
    ds_read_b64_tr_b16 v[22:23], v6 offset:9216
    s_waitcnt vmcnt(4) lgkmcnt(4)
    v_mfma_f32_32x32x16_bf16 v[72:87], v[8:11], v[36:39], v[72:87]
    ds_read_b64_tr_b16 v[120:121], v4 offset:10240
    ds_read_b64_tr_b16 v[122:123], v4 offset:11264
    v_mfma_f32_32x32x16_bf16 v[88:103], v[12:15], v[36:39], v[88:103]
    ds_read_b64_tr_b16 v[124:125], v6 offset:10240
    ds_read_b64_tr_b16 v[126:127], v6 offset:11264
    s_waitcnt vmcnt(3) lgkmcnt(4)
    v_mfma_f32_32x32x16_bf16 v[72:87], v[16:19], v[104:107], v[72:87]
    ds_read_b64_tr_b16 v[8:9], v4 offset:12288
    ds_read_b64_tr_b16 v[10:11], v4 offset:13312
    v_mfma_f32_32x32x16_bf16 v[88:103], v[20:23], v[104:107], v[88:103]
    ds_read_b64_tr_b16 v[12:13], v6 offset:12288
    ds_read_b64_tr_b16 v[14:15], v6 offset:13312
    s_waitcnt vmcnt(2) lgkmcnt(4)
    v_mfma_f32_32x32x16_bf16 v[72:87], v[120:123], v[108:111], v[72:87]
    ds_read_b64_tr_b16 v[16:17], v4 offset:14336
    ds_read_b64_tr_b16 v[18:19], v4 offset:15360
    v_mfma_f32_32x32x16_bf16 v[88:103], v[124:127], v[108:111], v[88:103]
    ds_read_b64_tr_b16 v[20:21], v6 offset:14336
    ds_read_b64_tr_b16 v[22:23], v6 offset:15360
    s_waitcnt vmcnt(1) lgkmcnt(4)
    v_mfma_f32_32x32x16_bf16 v[72:87], v[8:11], v[112:115], v[72:87]
    v_mfma_f32_32x32x16_bf16 v[88:103], v[12:15], v[112:115], v[88:103]
    s_waitcnt vmcnt(0) lgkmcnt(0)
    v_mfma_f32_32x32x16_bf16 v[72:87], v[16:19], v[116:119], v[72:87]
    v_mfma_f32_32x32x16_bf16 v[88:103], v[20:23], v[116:119], v[88:103]
    s_barrier
    s_nop 7
    s_nop 3
    v_fmac_f32 v40, v7, v72
    v_fmac_f32 v41, v7, v73
    v_fmac_f32 v42, v7, v74
    v_fmac_f32 v43, v7, v75
    ds_write_b128 v2, v[40:43] offset:0
    v_fmac_f32 v44, v7, v76
    v_fmac_f32 v45, v7, v77
    v_fmac_f32 v46, v7, v78
    v_fmac_f32 v47, v7, v79
    ds_write_b128 v2, v[44:47] offset:32
    v_fmac_f32 v48, v7, v80
    v_fmac_f32 v49, v7, v81
    v_fmac_f32 v50, v7, v82
    v_fmac_f32 v51, v7, v83
    ds_write_b128 v2, v[48:51] offset:64
    v_fmac_f32 v52, v7, v84
    v_fmac_f32 v53, v7, v85
    v_fmac_f32 v54, v7, v86
    v_fmac_f32 v55, v7, v87
    ds_write_b128 v2, v[52:55] offset:96
    v_fmac_f32 v56, v7, v88
    v_fmac_f32 v57, v7, v89
    v_fmac_f32 v58, v7, v90
    v_fmac_f32 v59, v7, v91
    ds_write_b128 v2, v[56:59] offset:128
    v_fmac_f32 v60, v7, v92
    v_fmac_f32 v61, v7, v93
    v_fmac_f32 v62, v7, v94
    v_fmac_f32 v63, v7, v95
    ds_write_b128 v2, v[60:63] offset:160
    v_fmac_f32 v64, v7, v96
    v_fmac_f32 v65, v7, v97
    v_fmac_f32 v66, v7, v98
    v_fmac_f32 v67, v7, v99
    ds_write_b128 v2, v[64:67] offset:192
    v_fmac_f32 v68, v7, v100
    v_fmac_f32 v69, v7, v101
    v_fmac_f32 v70, v7, v102
    v_fmac_f32 v71, v7, v103
    ds_write_b128 v2, v[68:71] offset:224
    s_waitcnt lgkmcnt(0)
    s_barrier
    ds_read_b128 v[32:35], v3 offset:0
    ds_read_b128 v[36:39], v3 offset:16
    ds_read_b128 v[40:43], v3 offset:17408
    ds_read_b128 v[44:47], v3 offset:17424
    ds_read_b128 v[48:51], v3 offset:34816
    ds_read_b128 v[52:55], v3 offset:34832
    ds_read_b128 v[56:59], v3 offset:52224
    ds_read_b128 v[60:63], v3 offset:52240
    s_waitcnt lgkmcnt(4)
    v_add_f32 v32, v32, v40
    v_add_f32 v33, v33, v41
    v_add_f32 v34, v34, v42
    v_add_f32 v35, v35, v43
    v_add_f32 v36, v36, v44
    v_add_f32 v37, v37, v45
    v_add_f32 v38, v38, v46
    v_add_f32 v39, v39, v47
    s_waitcnt lgkmcnt(2)
    v_add_f32 v32, v32, v48
    v_add_f32 v33, v33, v49
    v_add_f32 v34, v34, v50
    v_add_f32 v35, v35, v51
    v_add_f32 v36, v36, v52
    v_add_f32 v37, v37, v53
    v_add_f32 v38, v38, v54
    v_add_f32 v39, v39, v55
    s_waitcnt lgkmcnt(0)
    v_add_f32 v32, v32, v56
    v_add_f32 v33, v33, v57
    v_add_f32 v34, v34, v58
    v_add_f32 v35, v35, v59
    v_add_f32 v36, v36, v60
    v_add_f32 v37, v37, v61
    v_add_f32 v38, v38, v62
    v_add_f32 v39, v39, v63
    v_cvt_pk_bf16_f32 v12, v32, v33
    v_cvt_pk_bf16_f32 v13, v34, v35
    v_cvt_pk_bf16_f32 v14, v36, v37
    v_cvt_pk_bf16_f32 v15, v38, v39
    buffer_store_dwordx4 v[12:15], v5, s[52:55], s66 offen
    s_branch L_end
L_attn:
    s_waitcnt lgkmcnt(0)
    s_add_u32 s6, s36, 0xe2e000
    s_addc_u32 s7, s37, 0
    s_load_dword s91, s[6:7], 0
    s_sub_u32 s4, s2, 256
    s_mov_b32 s40, s16
    s_mov_b32 s41, s17
    s_mov_b32 s42, 0x200000
    s_mov_b32 s43, 0x20000
    s_mov_b32 s44, s18
    s_mov_b32 s45, s19
    s_mov_b32 s46, 0x180000
    s_mov_b32 s47, 0x20000
    s_lshr_b32 s60, s4, 3
    s_lshl_b32 s62, s3, 5
    s_add_u32 s60, s60, s62
    s_and_b32 s62, s4, 7
    s_cmp_ge_u32 s60, 48
    s_cbranch_scc1 pf_23_e
    s_cmp_ge_u32 s60, 32
    s_cbranch_scc1 pf_23_w
    s_lshr_b32 s62, s62, 2
    s_lshl_b32 s62, s62, 10
    s_and_b32 s63, s60, 15
    s_lshl_b32 s63, s63, 6
    s_add_u32 s62, s62, s63
    s_lshl_b32 s62, s62, 10
    s_lshr_b32 s60, s60, 4
    s_add_u32 s60, s60, 3
    s_lshl_b32 s60, s60, 7
    s_add_u32 s60, s60, s62
    v_lshlrev_b32 v24, 10, v0
    buffer_load_dword v120, v24, s[40:43], s60 offen
    s_branch pf_23_e
pf_23_w:
    s_sub_u32 s60, s60, 32
    s_lshl_b32 s60, s60, 3
    s_add_u32 s60, s60, 128
    s_mul_i32 s60, s60, 3072
    s_and_b32 s62, s62, 3
    s_mul_i32 s62, s62, 768
    s_add_u32 s60, s60, s62
    v_lshrrev_b32 v24, 3, v0
    v_mul_u32_u24 v24, 3072, v24
    v_and_b32 v25, 7, v0
    v_min_u32 v25, 5, v25
    v_lshlrev_b32 v25, 7, v25
    v_add_u32 v24, v24, v25
    buffer_load_dword v120, v24, s[44:47], s60 offen
pf_23_e:
    s_lshr_b32 s60, s4, 3
    s_lshl_b32 s62, s3, 5
    s_add_u32 s60, s60, s62
    s_and_b32 s62, s4, 7
    s_cmp_ge_u32 s60, 80
    s_cbranch_scc1 pf_24_e
    s_cmp_ge_u32 s60, 48
    s_cbranch_scc1 pf_24_w
    s_lshr_b32 s62, s62, 2
    s_lshl_b32 s62, s62, 10
    s_and_b32 s63, s60, 15
    s_lshl_b32 s63, s63, 6
    s_add_u32 s62, s62, s63
    s_lshl_b32 s62, s62, 10
    s_lshr_b32 s60, s60, 4
    s_add_u32 s60, s60, 5
    s_lshl_b32 s60, s60, 7
    s_add_u32 s60, s60, s62
    v_lshlrev_b32 v24, 10, v0
    buffer_load_dword v120, v24, s[40:43], s60 offen
    s_branch pf_24_e
pf_24_w:
    s_sub_u32 s60, s60, 48
    s_lshl_b32 s60, s60, 3
    s_add_u32 s60, s60, 256
    s_mul_i32 s60, s60, 3072
    s_and_b32 s62, s62, 3
    s_mul_i32 s62, s62, 768
    s_add_u32 s60, s60, s62
    v_lshrrev_b32 v24, 3, v0
    v_mul_u32_u24 v24, 3072, v24
    v_and_b32 v25, 7, v0
    v_min_u32 v25, 5, v25
    v_lshlrev_b32 v25, 7, v25
    v_add_u32 v24, v24, v25
    buffer_load_dword v120, v24, s[44:47], s60 offen
pf_24_e:
    s_waitcnt vmcnt(0)
    s_and_b32 s62, s4, 7
    s_lshr_b32 s63, s4, 3
    s_lshl_b32 s38, s62, 2
    s_lshr_b32 s60, s63, 3
    s_add_u32 s38, s38, s60
    s_and_b32 s39, s63, 7
    s_and_b32 s56, s3, 3
    s_lshr_b32 s57, s3, 2
    s_lshl_b32 s59, s38, 16
    s_lshl_b32 s60, s57, 15
    s_add_u32 s59, s59, s60
    s_lshl_b32 s60, s56, 10
    s_add_u32 s59, s59, s60
    s_lshl_b32 s61, s57, 14
    s_add_u32 s61, s61, s60
    v_lshlrev_b32 v3, 4, v0
    s_lshl_b32 s60, s57, 14
    v_add_u32 v1, s60, v3
    v_lshrrev_b32 v4, 5, v0
    v_lshlrev_b32 v4, 8, v4
    v_and_b32 v5, 15, v0
    v_lshlrev_b32 v5, 4, v5
    s_add_u32 s60, s60, 8192
    v_add3_u32 v2, v4, v5, s60
    s_mov_b32 s64, 0x0000ffff
    s_mov_b32 s65, 0x0000ffff
    s_mov_b32 s48, s36
    s_mov_b32 s49, s37
    s_mov_b32 s50, 0x1000000
    s_mov_b32 s51, 0x20000
    v_mov_b32 v48, 0
    v_mov_b32 v64, 0
    v_mov_b32 v32, 0
    v_mov_b32 v49, 0
    v_mov_b32 v65, 0
    v_mov_b32 v33, 0
    v_mov_b32 v50, 0
    v_mov_b32 v66, 0
    v_mov_b32 v34, 0
    v_mov_b32 v51, 0
    v_mov_b32 v67, 0
    v_mov_b32 v35, 0
    v_mov_b32 v52, 0
    v_mov_b32 v68, 0
    v_mov_b32 v36, 0
    v_mov_b32 v53, 0
    v_mov_b32 v69, 0
    v_mov_b32 v37, 0
    v_mov_b32 v54, 0
    v_mov_b32 v70, 0
    v_mov_b32 v38, 0
    v_mov_b32 v55, 0
    v_mov_b32 v71, 0
    v_mov_b32 v39, 0
    v_mov_b32 v56, 0
    v_mov_b32 v72, 0
    v_mov_b32 v40, 0
    v_mov_b32 v57, 0
    v_mov_b32 v73, 0
    v_mov_b32 v41, 0
    v_mov_b32 v58, 0
    v_mov_b32 v74, 0
    v_mov_b32 v42, 0
    v_mov_b32 v59, 0
    v_mov_b32 v75, 0
    v_mov_b32 v43, 0
    v_mov_b32 v60, 0
    v_mov_b32 v76, 0
    v_mov_b32 v44, 0
    v_mov_b32 v61, 0
    v_mov_b32 v77, 0
    v_mov_b32 v45, 0
    v_mov_b32 v62, 0
    v_mov_b32 v78, 0
    v_mov_b32 v46, 0
    v_mov_b32 v63, 0
    v_mov_b32 v79, 0
    v_mov_b32 v47, 0
    v_mov_b32 v112, 0xdddddddd
    v_and_b32 v4, 27, v0
    v_cmp_eq_u32 vcc, 16, v4
    v_mov_b32 v5, 0x3f803f80
    s_nop 1
    v_cndmask_b32 v96, 0, v5, vcc
    v_cndmask_b32 v97, 0, v5, vcc
    v_cndmask_b32 v98, 0, v5, vcc
    v_cndmask_b32 v99, 0, v5, vcc
    v_cndmask_b32 v100, 0, v5, vcc
    v_cndmask_b32 v101, 0, v5, vcc
    v_cndmask_b32 v102, 0, v5, vcc
    v_cndmask_b32 v103, 0, v5, vcc
    v_cndmask_b32 v104, 0, v5, vcc
    v_cndmask_b32 v105, 0, v5, vcc
    v_cndmask_b32 v106, 0, v5, vcc
    v_cndmask_b32 v107, 0, v5, vcc
    v_cndmask_b32 v108, 0, v5, vcc
    v_cndmask_b32 v109, 0, v5, vcc
    v_cndmask_b32 v110, 0, v5, vcc
    v_cndmask_b32 v111, 0, v5, vcc
    s_mov_b32 s101, 0
    v_mov_b32 v5, 0
    v_mov_b32 v6, 65536
    ds_write_b32 v6, v5
    s_lshr_b32 s60, s38, 3
    v_lshrrev_b32 v4, 4, v0
    v_lshlrev_b32 v4, 2, v4
    v_add_u32 v4, 4, v4
    v_cmp_gt_u32 vcc, 32, v0
    s_nop 1
    v_cndmask_b32 v4, 0, v4, vcc
    v_add_u32 v4, s60, v4
    v_and_b32 v5, 15, v0
    s_lshl_b32 s62, s39, 1
    v_add_u32 v6, s62, v5
    v_cndmask_b32 v5, v6, v5, vcc
    v_lshl_add_u32 v4, v4, 4, v5
    v_lshlrev_b32 v4, 7, v4
    v_add_u32 v4, 0xe00000, v4
    s_waitcnt lgkmcnt(0)
    s_add_u32 s5, s91, 1
    s_cmp_lg_u32 s3, 0
    s_cbranch_scc1 wfd_28
    s_mov_b32 s60, 0
    s_mov_b32 s62, 0xffffffff
    s_mov_b32 s63, 0x3
    s_mov_b64 exec, 1
wf1_26:
    buffer_load_dword v8, v4, s[48:51], 0 offen sc0 sc1
    s_waitcnt vmcnt(0)
    v_cmp_eq_u32 vcc, s5, v8
    s_cmp_lg_u64 vcc, 0
    s_cbranch_scc1 wf2_27
    s_add_u32 s60, s60, 1
    s_cmp_lt_u32 s60, 32768
    s_cbranch_scc0 wf2_27
    s_sleep 4
    s_branch wf1_26
wf2_27:
wf_25:
    s_mov_b64 exec, s[62:63]
    buffer_load_dword v8, v4, s[48:51], 0 offen sc0 sc1
    s_waitcnt vmcnt(0)
    v_cmp_eq_u32 vcc, s5, v8
    s_andn2_b64 s[62:63], s[62:63], vcc
    s_cbranch_scc0 wfd_28_x
    s_add_u32 s60, s60, 1
    s_cmp_lt_u32 s60, 32768
    s_cbranch_scc0 wfd_28_x
    s_branch wf_25
wfd_28_x:
    s_mov_b64 exec, -1
wfd_28:
    s_barrier
    s_setprio 1
    s_cmp_lt_u32 s3, 4
    s_cbranch_scc1 yp_29
    s_setprio 2
yp_29:
    s_lshl_b32 s60, s38, 6
    s_lshl_b32 s62, s39, 3
    s_add_u32 s60, s60, s62
    s_lshl_b32 s62, s56, 1
    s_add_u32 s60, s60, s62
    s_lshl_b32 s60, s60, 10
    s_add_u32 s60, s60, 0x1000
    s_add_u32 s62, s60, 1024
    s_mov_b32 s66, s59
    s_mov_b32 s67, s61
    s_mov_b32 s92, s60
    s_add_u32 m0, s67, 0
    s_add_u32 s63, s66, 0x202000
    buffer_load_dwordx4 v3, s[48:51], s63 offen sc1 lds
    s_add_u32 m0, s67, 8192
    s_add_u32 s63, s66, 0x403000
    buffer_load_dwordx4 v3, s[48:51], s63 offen sc1 lds
    buffer_load_dwordx4 v[80:83], v3, s[48:51], s92 offen sc1
    buffer_load_dwordx4 v[84:87], v3, s[48:51], s62 offen sc1
    s_mov_b32 s58, 0
    s_add_u32 m0, s67, 4096
    s_add_u32 s63, s66, 0x203000
    buffer_load_dwordx4 v3, s[48:51], s63 offen sc1 lds
    s_add_u32 m0, s67, 12288
    s_add_u32 s63, s66, 0x404000
    buffer_load_dwordx4 v3, s[48:51], s63 offen sc1 lds
    s_add_u32 s66, s66, 8192
    s_xor_b32 s67, s67, 32768
    s_add_u32 m0, s67, 0
    s_add_u32 s60, s66, 0x202000
    buffer_load_dwordx4 v3, s[48:51], s60 offen sc1 lds
    s_add_u32 m0, s67, 4096
    s_add_u32 s60, s66, 0x203000
    buffer_load_dwordx4 v3, s[48:51], s60 offen sc1 lds
    s_add_u32 m0, s67, 8192
    s_add_u32 s60, s66, 0x403000
    buffer_load_dwordx4 v3, s[48:51], s60 offen sc1 lds
    s_add_u32 m0, s67, 12288
    s_add_u32 s60, s66, 0x404000
    buffer_load_dwordx4 v3, s[48:51], s60 offen sc1 lds
    s_add_u32 s66, s66, 8192
    s_xor_b32 s67, s67, 32768
    s_waitcnt vmcnt(4)
    s_barrier
    s_cmp_lg_u32 s3, 0
    s_cbranch_scc1 fs_30
    s_waitcnt lgkmcnt(0)
    s_add_u32 s5, s91, 1
    s_lshl_b32 s60, s4, 7
    s_add_u32 s60, s60, 0xe26000
    v_mov_b32 v8, s5
    v_mov_b32 v9, 0
    s_mov_b64 exec, 1
    buffer_store_dword v8, v9, s[48:51], s60 offen sc0 sc1
    s_mov_b64 exec, -1
fs_30:
    ds_read_b128 v[88:91], v1 offset:0
    s_mov_b64 exec, s[64:65]
    ds_read_b128 v[96:99], v2 offset:0
    ds_read_b128 v[100:103], v2 offset:512
    s_mov_b64 exec, -1
    s_waitcnt lgkmcnt(0)
    v_mfma_f32_32x32x16_bf16 v[16:31], v[88:91], v[80:83], 0
    s_nop 7
    s_nop 7
    .p2align 6
at_loop:
    v_exp_f32 v16, v16
    ds_read_b128 v[92:95], v1 offset:1024
    v_exp_f32 v17, v17
    v_smfmac_f32_32x32x32_bf16 v[64:79], v[104:107], v[32:39], v112
    v_exp_f32 v18, v18
    v_exp_f32 v19, v19
    v_exp_f32 v20, v20
    v_smfmac_f32_32x32x32_bf16 v[64:79], v[108:111], v[40:47], v112
    v_exp_f32 v21, v21
    v_exp_f32 v22, v22
    v_exp_f32 v23, v23
    v_mfma_f32_32x32x16_bf16 v[32:47], v[88:91], v[84:87], 0
    s_mov_b64 exec, s[64:65]
    ds_read_b128 v[104:107], v2 offset:1024
    ds_read_b128 v[108:111], v2 offset:1536
    s_mov_b64 exec, -1
    v_exp_f32 v24, v24
    v_exp_f32 v25, v25
    v_exp_f32 v26, v26
    v_exp_f32 v27, v27
    v_exp_f32 v28, v28
    v_exp_f32 v29, v29
    v_exp_f32 v30, v30
    v_exp_f32 v31, v31
    s_waitcnt lgkmcnt(2)
    v_exp_f32 v32, v32
    v_exp_f32 v33, v33
    v_smfmac_f32_32x32x32_bf16 v[48:63], v[96:99], v[16:23], v112
    v_exp_f32 v34, v34
    v_exp_f32 v35, v35
    v_exp_f32 v36, v36
    v_smfmac_f32_32x32x32_bf16 v[48:63], v[100:103], v[24:31], v112
    v_exp_f32 v37, v37
    v_exp_f32 v38, v38
    v_exp_f32 v39, v39
    v_mfma_f32_32x32x16_bf16 v[16:31], v[92:95], v[80:83], 0
    v_exp_f32 v40, v40
    v_exp_f32 v41, v41
    v_exp_f32 v42, v42
    v_exp_f32 v43, v43
    v_exp_f32 v44, v44
    v_exp_f32 v45, v45
    v_exp_f32 v46, v46
    v_exp_f32 v47, v47
    v_exp_f32 v16, v16
    ds_read_b128 v[88:91], v1 offset:2048
    v_exp_f32 v17, v17
    v_smfmac_f32_32x32x32_bf16 v[64:79], v[96:99], v[32:39], v112
    v_exp_f32 v18, v18
    v_exp_f32 v19, v19
    v_exp_f32 v20, v20
    v_smfmac_f32_32x32x32_bf16 v[64:79], v[100:103], v[40:47], v112
    v_exp_f32 v21, v21
    v_exp_f32 v22, v22
    v_exp_f32 v23, v23
    v_mfma_f32_32x32x16_bf16 v[32:47], v[92:95], v[84:87], 0
    s_mov_b64 exec, s[64:65]
    ds_read_b128 v[96:99], v2 offset:2048
    ds_read_b128 v[100:103], v2 offset:2560
    s_mov_b64 exec, -1
    v_exp_f32 v24, v24
    v_exp_f32 v25, v25
    v_exp_f32 v26, v26
    v_exp_f32 v27, v27
    v_exp_f32 v28, v28
    v_exp_f32 v29, v29
    v_exp_f32 v30, v30
    v_exp_f32 v31, v31
    s_waitcnt lgkmcnt(2)
    v_exp_f32 v32, v32
    v_exp_f32 v33, v33
    v_smfmac_f32_32x32x32_bf16 v[48:63], v[104:107], v[16:23], v112
    v_exp_f32 v34, v34
    v_exp_f32 v35, v35
    v_exp_f32 v36, v36
    v_smfmac_f32_32x32x32_bf16 v[48:63], v[108:111], v[24:31], v112
    v_exp_f32 v37, v37
    v_exp_f32 v38, v38
    v_exp_f32 v39, v39
    v_mfma_f32_32x32x16_bf16 v[16:31], v[88:91], v[80:83], 0
    v_exp_f32 v40, v40
    v_exp_f32 v41, v41
    v_exp_f32 v42, v42
    v_exp_f32 v43, v43
    v_exp_f32 v44, v44
    v_exp_f32 v45, v45
    v_exp_f32 v46, v46
    v_exp_f32 v47, v47
    v_exp_f32 v16, v16
    ds_read_b128 v[92:95], v1 offset:3072
    v_exp_f32 v17, v17
    v_smfmac_f32_32x32x32_bf16 v[64:79], v[104:107], v[32:39], v112
    v_exp_f32 v18, v18
    v_exp_f32 v19, v19
    v_exp_f32 v20, v20
    v_smfmac_f32_32x32x32_bf16 v[64:79], v[108:111], v[40:47], v112
    v_exp_f32 v21, v21
    v_exp_f32 v22, v22
    v_exp_f32 v23, v23
    v_mfma_f32_32x32x16_bf16 v[32:47], v[88:91], v[84:87], 0
    s_mov_b64 exec, s[64:65]
    ds_read_b128 v[104:107], v2 offset:3072
    ds_read_b128 v[108:111], v2 offset:3584
    s_mov_b64 exec, -1
    v_exp_f32 v24, v24
    v_exp_f32 v25, v25
    v_exp_f32 v26, v26
    v_exp_f32 v27, v27
    v_exp_f32 v28, v28
    v_exp_f32 v29, v29
    v_exp_f32 v30, v30
    v_exp_f32 v31, v31
    s_waitcnt lgkmcnt(2)
    v_exp_f32 v32, v32
    v_exp_f32 v33, v33
    v_smfmac_f32_32x32x32_bf16 v[48:63], v[96:99], v[16:23], v112
    v_exp_f32 v34, v34
    v_exp_f32 v35, v35
    v_exp_f32 v36, v36
    v_smfmac_f32_32x32x32_bf16 v[48:63], v[100:103], v[24:31], v112
    v_exp_f32 v37, v37
    v_exp_f32 v38, v38
    v_exp_f32 v39, v39
    v_mfma_f32_32x32x16_bf16 v[16:31], v[92:95], v[80:83], 0
    v_exp_f32 v40, v40
    v_exp_f32 v41, v41
    v_exp_f32 v42, v42
    v_exp_f32 v43, v43
    v_exp_f32 v44, v44
    v_exp_f32 v45, v45
    v_exp_f32 v46, v46
    v_exp_f32 v47, v47
    v_exp_f32 v16, v16
    ds_read_b128 v[88:91], v1 offset:4096
    v_exp_f32 v17, v17
    v_smfmac_f32_32x32x32_bf16 v[64:79], v[96:99], v[32:39], v112
    v_exp_f32 v18, v18
    v_exp_f32 v19, v19
    v_exp_f32 v20, v20
    v_smfmac_f32_32x32x32_bf16 v[64:79], v[100:103], v[40:47], v112
    v_exp_f32 v21, v21
    v_exp_f32 v22, v22
    v_exp_f32 v23, v23
    v_mfma_f32_32x32x16_bf16 v[32:47], v[92:95], v[84:87], 0
    s_mov_b64 exec, s[64:65]
    ds_read_b128 v[96:99], v2 offset:4096
    ds_read_b128 v[100:103], v2 offset:4608
    s_mov_b64 exec, -1
    v_exp_f32 v24, v24
    v_exp_f32 v25, v25
    v_exp_f32 v26, v26
    v_exp_f32 v27, v27
    v_exp_f32 v28, v28
    v_exp_f32 v29, v29
    v_exp_f32 v30, v30
    v_exp_f32 v31, v31
    s_waitcnt lgkmcnt(2)
    v_exp_f32 v32, v32
    v_exp_f32 v33, v33
    v_smfmac_f32_32x32x32_bf16 v[48:63], v[104:107], v[16:23], v112
    v_exp_f32 v34, v34
    v_exp_f32 v35, v35
    v_exp_f32 v36, v36
    v_smfmac_f32_32x32x32_bf16 v[48:63], v[108:111], v[24:31], v112
    v_exp_f32 v37, v37
    v_exp_f32 v38, v38
    v_exp_f32 v39, v39
    v_mfma_f32_32x32x16_bf16 v[16:31], v[88:91], v[80:83], 0
    v_exp_f32 v40, v40
    v_exp_f32 v41, v41
    v_exp_f32 v42, v42
    v_exp_f32 v43, v43
    v_exp_f32 v44, v44
    v_exp_f32 v45, v45
    v_exp_f32 v46, v46
    v_exp_f32 v47, v47
    v_exp_f32 v16, v16
    ds_read_b128 v[92:95], v1 offset:5120
    v_exp_f32 v17, v17
    v_smfmac_f32_32x32x32_bf16 v[64:79], v[104:107], v[32:39], v112
    v_exp_f32 v18, v18
    v_exp_f32 v19, v19
    v_exp_f32 v20, v20
    v_smfmac_f32_32x32x32_bf16 v[64:79], v[108:111], v[40:47], v112
    v_exp_f32 v21, v21
    v_exp_f32 v22, v22
    v_exp_f32 v23, v23
    v_mfma_f32_32x32x16_bf16 v[32:47], v[88:91], v[84:87], 0
    s_mov_b64 exec, s[64:65]
    ds_read_b128 v[104:107], v2 offset:5120
    ds_read_b128 v[108:111], v2 offset:5632
    s_mov_b64 exec, -1
    v_exp_f32 v24, v24
    v_exp_f32 v25, v25
    v_exp_f32 v26, v26
    v_exp_f32 v27, v27
    v_exp_f32 v28, v28
    v_exp_f32 v29, v29
    v_exp_f32 v30, v30
    v_exp_f32 v31, v31
    s_waitcnt lgkmcnt(2)
    v_exp_f32 v32, v32
    v_exp_f32 v33, v33
    v_smfmac_f32_32x32x32_bf16 v[48:63], v[96:99], v[16:23], v112
    v_exp_f32 v34, v34
    v_exp_f32 v35, v35
    v_exp_f32 v36, v36
    v_smfmac_f32_32x32x32_bf16 v[48:63], v[100:103], v[24:31], v112
    v_exp_f32 v37, v37
    v_exp_f32 v38, v38
    v_exp_f32 v39, v39
    v_mfma_f32_32x32x16_bf16 v[16:31], v[92:95], v[80:83], 0
    v_exp_f32 v40, v40
    v_exp_f32 v41, v41
    v_exp_f32 v42, v42
    v_exp_f32 v43, v43
    v_exp_f32 v44, v44
    v_exp_f32 v45, v45
    v_exp_f32 v46, v46
    v_exp_f32 v47, v47
    v_exp_f32 v16, v16
    ds_read_b128 v[88:91], v1 offset:6144
    v_exp_f32 v17, v17
    v_smfmac_f32_32x32x32_bf16 v[64:79], v[96:99], v[32:39], v112
    v_exp_f32 v18, v18
    v_exp_f32 v19, v19
    v_exp_f32 v20, v20
    v_smfmac_f32_32x32x32_bf16 v[64:79], v[100:103], v[40:47], v112
    v_exp_f32 v21, v21
    v_exp_f32 v22, v22
    v_exp_f32 v23, v23
    v_mfma_f32_32x32x16_bf16 v[32:47], v[92:95], v[84:87], 0
    s_mov_b64 exec, s[64:65]
    ds_read_b128 v[96:99], v2 offset:6144
    ds_read_b128 v[100:103], v2 offset:6656
    s_mov_b64 exec, -1
    v_exp_f32 v24, v24
    v_exp_f32 v25, v25
    v_exp_f32 v26, v26
    v_exp_f32 v27, v27
    v_exp_f32 v28, v28
    v_exp_f32 v29, v29
    v_exp_f32 v30, v30
    v_exp_f32 v31, v31
    s_waitcnt lgkmcnt(2)
    v_exp_f32 v32, v32
    v_exp_f32 v33, v33
    v_smfmac_f32_32x32x32_bf16 v[48:63], v[104:107], v[16:23], v112
    v_exp_f32 v34, v34
    v_exp_f32 v35, v35
    v_exp_f32 v36, v36
    v_smfmac_f32_32x32x32_bf16 v[48:63], v[108:111], v[24:31], v112
    v_exp_f32 v37, v37
    v_exp_f32 v38, v38
    v_exp_f32 v39, v39
    v_mfma_f32_32x32x16_bf16 v[16:31], v[88:91], v[80:83], 0
    v_exp_f32 v40, v40
    v_exp_f32 v41, v41
    v_exp_f32 v42, v42
    v_exp_f32 v43, v43
    v_exp_f32 v44, v44
    v_exp_f32 v45, v45
    v_exp_f32 v46, v46
    v_exp_f32 v47, v47
    v_exp_f32 v16, v16
    ds_read_b128 v[92:95], v1 offset:7168
    v_exp_f32 v17, v17
    v_smfmac_f32_32x32x32_bf16 v[64:79], v[104:107], v[32:39], v112
    v_exp_f32 v18, v18
    v_exp_f32 v19, v19
    v_exp_f32 v20, v20
    v_smfmac_f32_32x32x32_bf16 v[64:79], v[108:111], v[40:47], v112
    v_exp_f32 v21, v21
    v_exp_f32 v22, v22
    v_exp_f32 v23, v23
    v_mfma_f32_32x32x16_bf16 v[32:47], v[88:91], v[84:87], 0
    s_mov_b64 exec, s[64:65]
    ds_read_b128 v[104:107], v2 offset:7168
    ds_read_b128 v[108:111], v2 offset:7680
    s_mov_b64 exec, -1
    v_exp_f32 v24, v24
    v_exp_f32 v25, v25
    v_exp_f32 v26, v26
    v_exp_f32 v27, v27
    v_exp_f32 v28, v28
    v_exp_f32 v29, v29
    v_exp_f32 v30, v30
    v_exp_f32 v31, v31
    s_waitcnt lgkmcnt(2)
    v_exp_f32 v32, v32
    v_exp_f32 v33, v33
    v_smfmac_f32_32x32x32_bf16 v[48:63], v[96:99], v[16:23], v112
    v_exp_f32 v34, v34
    v_exp_f32 v35, v35
    v_exp_f32 v36, v36
    v_smfmac_f32_32x32x32_bf16 v[48:63], v[100:103], v[24:31], v112
    v_exp_f32 v37, v37
    v_exp_f32 v38, v38
    v_exp_f32 v39, v39
    v_mfma_f32_32x32x16_bf16 v[16:31], v[92:95], v[80:83], 0
    v_exp_f32 v40, v40
    v_exp_f32 v41, v41
    v_exp_f32 v42, v42
    v_exp_f32 v43, v43
    v_exp_f32 v44, v44
    v_exp_f32 v45, v45
    v_exp_f32 v46, v46
    v_exp_f32 v47, v47
    s_cmp_eq_u32 s58, 3
    s_cbranch_scc1 at_nob
    s_waitcnt vmcnt(0) lgkmcnt(0)
    s_barrier
    v_xor_b32 v1, 0x8000, v1
    v_xor_b32 v2, 0x8000, v2
    s_cmp_ge_u32 s58, 2
    s_cbranch_scc1 at_nod
    v_exp_f32 v16, v16
    ds_read_b128 v[88:91], v1 offset:0
    v_exp_f32 v17, v17
    v_smfmac_f32_32x32x32_bf16 v[64:79], v[96:99], v[32:39], v112
    v_exp_f32 v18, v18
    v_exp_f32 v19, v19
    v_exp_f32 v20, v20
    v_smfmac_f32_32x32x32_bf16 v[64:79], v[100:103], v[40:47], v112
    v_exp_f32 v21, v21
    v_exp_f32 v22, v22
    v_exp_f32 v23, v23
    v_mfma_f32_32x32x16_bf16 v[32:47], v[92:95], v[84:87], 0
    s_mov_b64 exec, s[64:65]
    ds_read_b128 v[96:99], v2 offset:0
    ds_read_b128 v[100:103], v2 offset:512
    s_mov_b64 exec, -1
    v_exp_f32 v24, v24
    s_add_u32 m0, s67, 0
    v_exp_f32 v25, v25
    s_add_u32 s60, s66, 0x202000
    v_exp_f32 v26, v26
    buffer_load_dwordx4 v3, s[48:51], s60 offen sc1 lds
    v_exp_f32 v27, v27
    s_add_u32 m0, s67, 4096
    v_exp_f32 v28, v28
    s_add_u32 s60, s66, 0x203000
    v_exp_f32 v29, v29
    buffer_load_dwordx4 v3, s[48:51], s60 offen sc1 lds
    v_exp_f32 v30, v30
    s_add_u32 m0, s67, 8192
    v_exp_f32 v31, v31
    s_add_u32 s60, s66, 0x403000
    s_waitcnt lgkmcnt(2)
    v_exp_f32 v32, v32
    v_exp_f32 v33, v33
    v_smfmac_f32_32x32x32_bf16 v[48:63], v[104:107], v[16:23], v112
    v_exp_f32 v34, v34
    v_exp_f32 v35, v35
    v_exp_f32 v36, v36
    v_smfmac_f32_32x32x32_bf16 v[48:63], v[108:111], v[24:31], v112
    v_exp_f32 v37, v37
    v_exp_f32 v38, v38
    v_exp_f32 v39, v39
    v_mfma_f32_32x32x16_bf16 v[16:31], v[88:91], v[80:83], 0
    v_exp_f32 v40, v40
    buffer_load_dwordx4 v3, s[48:51], s60 offen sc1 lds
    v_exp_f32 v41, v41
    s_add_u32 m0, s67, 12288
    v_exp_f32 v42, v42
    s_add_u32 s60, s66, 0x404000
    v_exp_f32 v43, v43
    buffer_load_dwordx4 v3, s[48:51], s60 offen sc1 lds
    v_exp_f32 v44, v44
    s_add_u32 s66, s66, 8192
    v_exp_f32 v45, v45
    s_xor_b32 s67, s67, 32768
    v_exp_f32 v46, v46
    v_exp_f32 v47, v47
    s_add_u32 s58, s58, 1
    s_branch at_loop
at_nod:
    v_exp_f32 v16, v16
    ds_read_b128 v[88:91], v1 offset:0
    v_exp_f32 v17, v17
    v_smfmac_f32_32x32x32_bf16 v[64:79], v[96:99], v[32:39], v112
    v_exp_f32 v18, v18
    v_exp_f32 v19, v19
    v_exp_f32 v20, v20
    v_smfmac_f32_32x32x32_bf16 v[64:79], v[100:103], v[40:47], v112
    v_exp_f32 v21, v21
    v_exp_f32 v22, v22
    v_exp_f32 v23, v23
    v_mfma_f32_32x32x16_bf16 v[32:47], v[92:95], v[84:87], 0
    s_mov_b64 exec, s[64:65]
    ds_read_b128 v[96:99], v2 offset:0
    ds_read_b128 v[100:103], v2 offset:512
    s_mov_b64 exec, -1
    v_exp_f32 v24, v24
    v_exp_f32 v25, v25
    v_exp_f32 v26, v26
    v_exp_f32 v27, v27
    v_exp_f32 v28, v28
    v_exp_f32 v29, v29
    v_exp_f32 v30, v30
    v_exp_f32 v31, v31
    s_waitcnt lgkmcnt(2)
    v_exp_f32 v32, v32
    v_exp_f32 v33, v33
    v_smfmac_f32_32x32x32_bf16 v[48:63], v[104:107], v[16:23], v112
    v_exp_f32 v34, v34
    v_exp_f32 v35, v35
    v_exp_f32 v36, v36
    v_smfmac_f32_32x32x32_bf16 v[48:63], v[108:111], v[24:31], v112
    v_exp_f32 v37, v37
    v_exp_f32 v38, v38
    v_exp_f32 v39, v39
    v_mfma_f32_32x32x16_bf16 v[16:31], v[88:91], v[80:83], 0
    v_exp_f32 v40, v40
    v_exp_f32 v41, v41
    v_exp_f32 v42, v42
    v_exp_f32 v43, v43
    v_exp_f32 v44, v44
    v_exp_f32 v45, v45
    v_exp_f32 v46, v46
    v_exp_f32 v47, v47
    s_add_u32 s58, s58, 1
    s_branch at_loop
at_nob:
    v_exp_f32 v16, v16
    ds_read_b128 v[88:91], v1 offset:0
    v_exp_f32 v17, v17
    v_smfmac_f32_32x32x32_bf16 v[64:79], v[96:99], v[32:39], v112
    v_exp_f32 v18, v18
    v_exp_f32 v19, v19
    v_exp_f32 v20, v20
    v_smfmac_f32_32x32x32_bf16 v[64:79], v[100:103], v[40:47], v112
    v_exp_f32 v21, v21
    v_exp_f32 v22, v22
    v_exp_f32 v23, v23
    v_mfma_f32_32x32x16_bf16 v[32:47], v[92:95], v[84:87], 0
    s_mov_b64 exec, s[64:65]
    ds_read_b128 v[96:99], v2 offset:0
    ds_read_b128 v[100:103], v2 offset:512
    s_mov_b64 exec, -1
    v_exp_f32 v24, v24
    v_exp_f32 v25, v25
    v_exp_f32 v26, v26
    v_exp_f32 v27, v27
    v_exp_f32 v28, v28
    v_exp_f32 v29, v29
    v_exp_f32 v30, v30
    v_exp_f32 v31, v31
    s_waitcnt lgkmcnt(2)
    v_exp_f32 v32, v32
    v_exp_f32 v33, v33
    v_smfmac_f32_32x32x32_bf16 v[48:63], v[104:107], v[16:23], v112
    v_exp_f32 v34, v34
    v_exp_f32 v35, v35
    v_exp_f32 v36, v36
    v_smfmac_f32_32x32x32_bf16 v[48:63], v[108:111], v[24:31], v112
    v_exp_f32 v37, v37
    v_exp_f32 v38, v38
    v_exp_f32 v39, v39
    v_mfma_f32_32x32x16_bf16 v[16:31], v[88:91], v[80:83], 0
    v_exp_f32 v40, v40
    v_exp_f32 v41, v41
    v_exp_f32 v42, v42
    v_exp_f32 v43, v43
    v_exp_f32 v44, v44
    v_exp_f32 v45, v45
    v_exp_f32 v46, v46
    v_exp_f32 v47, v47
    v_smfmac_f32_32x32x32_bf16 v[64:79], v[104:107], v[32:39], v112
    v_smfmac_f32_32x32x32_bf16 v[64:79], v[108:111], v[40:47], v112
at_red:
    s_waitcnt lgkmcnt(0)
    s_mul_i32 s60, s56, 6144
    v_mul_u32_u24 v4, 48, v0
    v_add_u32 v4, s60, v4
    s_lshl_b32 s60, s39, 3
    s_lshl_b32 s62, s56, 1
    s_add_u32 s60, s60, s62
    s_add_u32 s60, s60, s57
    s_lshl_b32 s60, s60, 5
    s_add_u32 s60, s60, s38
    s_lshl_b32 s60, s60, 10
    s_add_u32 s66, s60, 0x604000
    s_barrier
    s_nop 4
    s_cmp_eq_u32 s57, 0
    s_cbranch_scc0 at_k1
    ds_write_b128 v4, v[64:67] offset:3072
    ds_write_b128 v4, v[68:71] offset:3088
    ds_write_b128 v4, v[72:75] offset:3104
    s_waitcnt lgkmcnt(0)
    s_barrier
    ds_read_b128 v[80:83], v4 offset:0
    ds_read_b128 v[84:87], v4 offset:16
    ds_read_b128 v[88:91], v4 offset:32
    s_waitcnt lgkmcnt(0)
    v_add_f32 v48, v48, v80
    v_add_f32 v49, v49, v81
    v_add_f32 v50, v50, v82
    v_add_f32 v51, v51, v83
    v_add_f32 v52, v52, v84
    v_add_f32 v53, v53, v85
    v_add_f32 v54, v54, v86
    v_add_f32 v55, v55, v87
    v_add_f32 v56, v56, v88
    s_branch at_fin
at_k1:
    ds_write_b128 v4, v[48:51] offset:0
    ds_write_b128 v4, v[52:55] offset:16
    ds_write_b128 v4, v[56:59] offset:32
    s_waitcnt lgkmcnt(0)
    s_barrier
    ds_read_b128 v[80:83], v4 offset:3072
    ds_read_b128 v[84:87], v4 offset:3088
    ds_read_b128 v[88:91], v4 offset:3104
    s_waitcnt lgkmcnt(0)
    v_add_f32 v48, v64, v80
    v_add_f32 v49, v65, v81
    v_add_f32 v50, v66, v82
    v_add_f32 v51, v67, v83
    v_add_f32 v52, v68, v84
    v_add_f32 v53, v69, v85
    v_add_f32 v54, v70, v86
    v_add_f32 v55, v71, v87
    v_add_f32 v56, v72, v88
at_fin:
    v_max3_f32 v92, abs(v48), abs(v49), abs(v50)
    v_max3_f32 v93, abs(v51), abs(v52), abs(v53)
    v_rcp_f32 v94, v56
    v_max3_f32 v92, abs(v54), abs(v55), v92
    s_mov_b32 s60, 0x1f800000
    s_mov_b32 s62, 0x5f800000
    s_mov_b32 s63, 0x7e800000
    v_max_f32 v92, v92, v93
    v_cmp_nle_f32 vcc, s60, v56
    v_cmp_nge_f32 s[64:65], s62, v56
    s_or_b64 vcc, vcc, s[64:65]
    v_cmp_nge_f32 s[64:65], s63, v92
    s_or_b64 vcc, vcc, s[64:65]
    v_mul_f32 v48, v48, v94
    v_mul_f32 v49, v49, v94
    v_mul_f32 v50, v50, v94
    v_mul_f32 v51, v51, v94
    v_mul_f32 v52, v52, v94
    v_mul_f32 v53, v53, v94
    v_mul_f32 v54, v54, v94
    v_mul_f32 v55, v55, v94
    v_cvt_pk_bf16_f32 v84, v48, v49
    v_cvt_pk_bf16_f32 v85, v50, v51
    v_cvt_pk_bf16_f32 v86, v52, v53
    v_cvt_pk_bf16_f32 v87, v54, v55
    buffer_store_dwordx4 v[84:87], v3, s[48:51], s66 offen sc0 sc1
    s_cmp_eq_u64 vcc, 0
    s_cbranch_scc1 at_pub
    v_mov_b32 v5, 1
    v_mov_b32 v6, 65536
    ds_write_b32 v6, v5
at_pub:
    s_waitcnt lgkmcnt(0)
    s_add_u32 s5, s91, 1
    s_waitcnt vmcnt(0)
    s_barrier
    v_mov_b32 v6, 65536
    ds_read_b32 v5, v6
    s_waitcnt lgkmcnt(0)
    v_readfirstlane_b32 s60, v5
    s_andn2_b32 s60, s60, s101
    s_cmp_lg_u32 s60, 0
    s_cbranch_scc1 at_slow
    s_lshl_b32 s64, s39, 5
    s_add_u32 s64, s64, s38
    s_cmp_lg_u32 s3, 0
    s_cbranch_scc1 fs_31
    s_waitcnt lgkmcnt(0)
    s_add_u32 s5, s91, 1
    s_lshl_b32 s60, s64, 7
    s_add_u32 s60, s60, 0xe16000
    v_mov_b32 v8, s5
    v_mov_b32 v9, 0
    s_mov_b64 exec, 1
    buffer_store_dword v8, v9, s[48:51], s60 offen sc0 sc1
    s_mov_b64 exec, -1
fs_31:
    s_or_b32 s60, s4, s3
    s_cmp_lg_u32 s60, 0
    s_cbranch_scc1 L_end
    v_lshlrev_b32 v4, 7, v0
    s_mov_b32 s66, 0
at_ep:
    s_mov_b32 s60, 0xe16000
    buffer_load_dword v8, v4, s[48:51], s60 offen sc0 sc1
    s_mov_b32 s60, 0xe18000
    buffer_load_dword v9, v4, s[48:51], s60 offen sc0 sc1
    s_mov_b32 s60, 0xe1a000
    buffer_load_dword v10, v4, s[48:51], s60 offen sc0 sc1
    s_mov_b32 s60, 0xe1c000
    buffer_load_dword v11, v4, s[48:51], s60 offen sc0 sc1
    s_mov_b32 s60, 0xe00000
    buffer_load_dword v12, v4, s[48:51], s60 offen sc0 sc1
    s_mov_b32 s60, 0xe02000
    buffer_load_dword v13, v4, s[48:51], s60 offen sc0 sc1
    s_mov_b32 s60, 0xe04000
    buffer_load_dword v14, v4, s[48:51], s60 offen sc0 sc1
    s_mov_b32 s60, 0xe06000
    buffer_load_dword v16, v4, s[48:51], s60 offen sc0 sc1
    s_mov_b32 s60, 0xe08000
    buffer_load_dword v17, v4, s[48:51], s60 offen sc0 sc1
    s_mov_b32 s60, 0xe0a000
    buffer_load_dword v18, v4, s[48:51], s60 offen sc0 sc1
    s_mov_b32 s60, 0xe0c000
    buffer_load_dword v19, v4, s[48:51], s60 offen sc0 sc1
    s_mov_b32 s60, 0xe0e000
    buffer_load_dword v20, v4, s[48:51], s60 offen sc0 sc1
    s_mov_b32 s60, 0xe10000
    buffer_load_dword v21, v4, s[48:51], s60 offen sc0 sc1
    s_mov_b32 s60, 0xe12000
    buffer_load_dword v22, v4, s[48:51], s60 offen sc0 sc1
    s_mov_b32 s60, 0xe14000
    buffer_load_dword v23, v4, s[48:51], s60 offen sc0 sc1
    s_waitcnt vmcnt(0)
    s_mov_b64 s[62:63], -1
    v_cmp_eq_u32 vcc, s5, v8
    s_and_b64 s[62:63], s[62:63], vcc
    v_cmp_eq_u32 vcc, s5, v9
    s_and_b64 s[62:63], s[62:63], vcc
    v_cmp_eq_u32 vcc, s5, v10
    s_and_b64 s[62:63], s[62:63], vcc
    v_cmp_eq_u32 vcc, s5, v11
    s_and_b64 s[62:63], s[62:63], vcc
    v_cmp_eq_u32 vcc, s5, v12
    s_and_b64 s[62:63], s[62:63], vcc
    v_cmp_eq_u32 vcc, s5, v13
    s_and_b64 s[62:63], s[62:63], vcc
    v_cmp_eq_u32 vcc, s5, v14
    s_and_b64 s[62:63], s[62:63], vcc
    s_mov_b32 s64, 0xff000000
    s_mov_b32 s65, 0xff000000
    v_cmp_eq_u32 vcc, s5, v16
    s_or_b64 vcc, vcc, s[64:65]
    s_and_b64 s[62:63], s[62:63], vcc
    v_cmp_eq_u32 vcc, s5, v17
    s_or_b64 vcc, vcc, s[64:65]
    s_and_b64 s[62:63], s[62:63], vcc
    v_cmp_eq_u32 vcc, s5, v18
    s_or_b64 vcc, vcc, s[64:65]
    s_and_b64 s[62:63], s[62:63], vcc
    v_cmp_eq_u32 vcc, s5, v19
    s_or_b64 vcc, vcc, s[64:65]
    s_and_b64 s[62:63], s[62:63], vcc
    v_cmp_eq_u32 vcc, s5, v20
    s_or_b64 vcc, vcc, s[64:65]
    s_and_b64 s[62:63], s[62:63], vcc
    v_cmp_eq_u32 vcc, s5, v21
    s_or_b64 vcc, vcc, s[64:65]
    s_and_b64 s[62:63], s[62:63], vcc
    v_cmp_eq_u32 vcc, s5, v22
    s_or_b64 vcc, vcc, s[64:65]
    s_and_b64 s[62:63], s[62:63], vcc
    v_cmp_eq_u32 vcc, s5, v23
    s_or_b64 vcc, vcc, s[64:65]
    s_and_b64 s[62:63], s[62:63], vcc
    s_cmp_eq_u64 s[62:63], -1
    s_cbranch_scc1 at_ep_ok
    s_add_u32 s66, s66, 1
    s_cmp_lt_u32 s66, 32768
    s_cbranch_scc0 at_ep_ok
    s_sleep 4
    s_branch at_ep
at_ep_ok:
    v_mov_b32 v8, s5
    v_mov_b32 v9, 0
    s_mov_b32 s60, 0xe2e000
    s_mov_b64 exec, 1
    buffer_store_dword v8, v9, s[48:51], s60 offen sc0 sc1
    s_branch L_end
at_slow:
    s_mov_b32 s101, 1
    s_lshl_b32 s60, s38, 6
    s_lshl_b32 s62, s39, 3
    s_add_u32 s60, s60, s62
    s_lshl_b32 s62, s56, 1
    s_add_u32 s60, s60, s62
    s_lshl_b32 s60, s60, 10
    s_add_u32 s60, s60, 0x1000
    s_add_u32 s62, s60, 1024
    buffer_load_dwordx4 v[80:83], v3, s[48:51], s60 offen sc1
    buffer_load_dwordx4 v[84:87], v3, s[48:51], s62 offen sc1
    s_lshl_b32 s66, s38, 16
    s_lshl_b32 s60, s57, 15
    s_add_u32 s66, s66, s60
    v_mov_b32 v113, 0xff800000
    v_mov_b32 v114, 0xff800000
    s_mov_b32 s67, 0
at_s1:
    s_add_u32 s60, s66, 0x202000
    buffer_load_dwordx4 v[88:91], v3, s[48:51], s60 offen sc1
    s_waitcnt vmcnt(0)
    v_mfma_f32_32x32x16_bf16 v[16:31], v[88:91], v[80:83], 0
    v_mfma_f32_32x32x16_bf16 v[32:47], v[88:91], v[84:87], 0
    s_nop 15
    s_nop 7
    v_max3_f32 v113, v16, v17, v113
    v_max3_f32 v113, v18, v19, v113
    v_max3_f32 v113, v20, v21, v113
    v_max3_f32 v113, v22, v23, v113
    v_max3_f32 v113, v24, v25, v113
    v_max3_f32 v113, v26, v27, v113
    v_max3_f32 v113, v28, v29, v113
    v_max3_f32 v113, v30, v31, v113
    v_max3_f32 v114, v32, v33, v114
    v_max3_f32 v114, v34, v35, v114
    v_max3_f32 v114, v36, v37, v114
    v_max3_f32 v114, v38, v39, v114
    v_max3_f32 v114, v40, v41, v114
    v_max3_f32 v114, v42, v43, v114
    v_max3_f32 v114, v44, v45, v114
    v_max3_f32 v114, v46, v47, v114
    s_add_u32 s66, s66, 1024
    s_add_u32 s67, s67, 1
    s_cmp_lt_u32 s67, 32
    s_cbranch_scc1 at_s1
    s_sub_u32 s66, s66, 32768
    v_mov_b32 v5, v113
    s_nop 1
    v_permlane32_swap_b32 v113, v5
    s_nop 1
    v_max_f32 v113, v113, v5
    v_mov_b32 v5, v114
    s_nop 1
    v_permlane32_swap_b32 v114, v5
    s_nop 1
    v_max_f32 v114, v114, v5
    s_lshl_b32 s60, s3, 9
    v_lshlrev_b32 v5, 2, v0
    v_add_u32 v6, s60, v5
    ds_write_b32 v6, v113
    ds_write_b32 v6, v114 offset:256
    s_waitcnt lgkmcnt(0)
    s_barrier
    s_xor_b32 s60, s3, 4
    s_lshl_b32 s60, s60, 9
    v_add_u32 v6, s60, v5
    ds_read_b32 v7, v6
    ds_read_b32 v8, v6 offset:256
    s_waitcnt lgkmcnt(0)
    v_max_f32 v113, v113, v7
    v_max_f32 v114, v114, v8
    v_mov_b32 v48, 0
    v_mov_b32 v64, 0
    v_mov_b32 v49, 0
    v_mov_b32 v65, 0
    v_mov_b32 v50, 0
    v_mov_b32 v66, 0
    v_mov_b32 v51, 0
    v_mov_b32 v67, 0
    v_mov_b32 v52, 0
    v_mov_b32 v68, 0
    v_mov_b32 v53, 0
    v_mov_b32 v69, 0
    v_mov_b32 v54, 0
    v_mov_b32 v70, 0
    v_mov_b32 v55, 0
    v_mov_b32 v71, 0
    v_mov_b32 v56, 0
    v_mov_b32 v72, 0
    v_mov_b32 v57, 0
    v_mov_b32 v73, 0
    v_mov_b32 v58, 0
    v_mov_b32 v74, 0
    v_mov_b32 v59, 0
    v_mov_b32 v75, 0
    v_mov_b32 v60, 0
    v_mov_b32 v76, 0
    v_mov_b32 v61, 0
    v_mov_b32 v77, 0
    v_mov_b32 v62, 0
    v_mov_b32 v78, 0
    v_mov_b32 v63, 0
    v_mov_b32 v79, 0
    v_and_b32 v4, 27, v0
    v_cmp_eq_u32 vcc, 16, v4
    v_mov_b32 v5, 0x3f803f80
    s_nop 1
    v_cndmask_b32 v96, 0, v5, vcc
    v_cndmask_b32 v97, 0, v5, vcc
    v_cndmask_b32 v98, 0, v5, vcc
    v_cndmask_b32 v99, 0, v5, vcc
    v_cndmask_b32 v100, 0, v5, vcc
    v_cndmask_b32 v101, 0, v5, vcc
    v_cndmask_b32 v102, 0, v5, vcc
    v_cndmask_b32 v103, 0, v5, vcc
    v_lshrrev_b32 v4, 5, v0
    v_lshlrev_b32 v4, 8, v4
    v_and_b32 v5, 15, v0
    v_lshlrev_b32 v5, 4, v5
    v_add_u32 v7, v4, v5
    s_mov_b32 s64, 0x0000ffff
    s_mov_b32 s65, 0x0000ffff
    s_mov_b32 s67, 0
at_s2:
    s_add_u32 s60, s66, 0x202000
    buffer_load_dwordx4 v[88:91], v3, s[48:51], s60 offen sc1
    s_add_u32 s60, s66, 0x403000
    s_mov_b64 exec, s[64:65]
    buffer_load_dwordx4 v[96:99], v7, s[48:51], s60 offen sc1
    buffer_load_dwordx4 v[100:103], v7, s[48:51], s60 offen offset:512 sc1
    s_mov_b64 exec, -1
    s_waitcnt vmcnt(0)
    v_mfma_f32_32x32x16_bf16 v[16:31], v[88:91], v[80:83], 0
    v_mfma_f32_32x32x16_bf16 v[32:47], v[88:91], v[84:87], 0
    s_nop 15
    s_nop 7
    v_sub_f32 v16, v16, v113
    v_sub_f32 v17, v17, v113
    v_sub_f32 v18, v18, v113
    v_sub_f32 v19, v19, v113
    v_sub_f32 v20, v20, v113
    v_sub_f32 v21, v21, v113
    v_sub_f32 v22, v22, v113
    v_sub_f32 v23, v23, v113
    v_sub_f32 v24, v24, v113
    v_sub_f32 v25, v25, v113
    v_sub_f32 v26, v26, v113
    v_sub_f32 v27, v27, v113
    v_sub_f32 v28, v28, v113
    v_sub_f32 v29, v29, v113
    v_sub_f32 v30, v30, v113
    v_sub_f32 v31, v31, v113
    v_exp_f32 v16, v16
    v_exp_f32 v17, v17
    v_exp_f32 v18, v18
    v_exp_f32 v19, v19
    v_exp_f32 v20, v20
    v_exp_f32 v21, v21
    v_exp_f32 v22, v22
    v_exp_f32 v23, v23
    v_exp_f32 v24, v24
    v_exp_f32 v25, v25
    v_exp_f32 v26, v26
    v_exp_f32 v27, v27
    v_exp_f32 v28, v28
    v_exp_f32 v29, v29
    v_exp_f32 v30, v30
    v_exp_f32 v31, v31
    v_sub_f32 v32, v32, v114
    v_sub_f32 v33, v33, v114
    v_sub_f32 v34, v34, v114
    v_sub_f32 v35, v35, v114
    v_sub_f32 v36, v36, v114
    v_sub_f32 v37, v37, v114
    v_sub_f32 v38, v38, v114
    v_sub_f32 v39, v39, v114
    v_sub_f32 v40, v40, v114
    v_sub_f32 v41, v41, v114
    v_sub_f32 v42, v42, v114
    v_sub_f32 v43, v43, v114
    v_sub_f32 v44, v44, v114
    v_sub_f32 v45, v45, v114
    v_sub_f32 v46, v46, v114
    v_sub_f32 v47, v47, v114
    v_exp_f32 v32, v32
    v_exp_f32 v33, v33
    v_exp_f32 v34, v34
    v_exp_f32 v35, v35
    v_exp_f32 v36, v36
    v_exp_f32 v37, v37
    v_exp_f32 v38, v38
    v_exp_f32 v39, v39
    v_exp_f32 v40, v40
    v_exp_f32 v41, v41
    v_exp_f32 v42, v42
    v_exp_f32 v43, v43
    v_exp_f32 v44, v44
    v_exp_f32 v45, v45
    v_exp_f32 v46, v46
    v_exp_f32 v47, v47
    s_nop 3
    v_smfmac_f32_32x32x32_bf16 v[48:63], v[96:99], v[16:23], v112
    v_smfmac_f32_32x32x32_bf16 v[48:63], v[100:103], v[24:31], v112
    v_smfmac_f32_32x32x32_bf16 v[64:79], v[96:99], v[32:39], v112
    v_smfmac_f32_32x32x32_bf16 v[64:79], v[100:103], v[40:47], v112
    s_add_u32 s66, s66, 1024
    s_add_u32 s67, s67, 1
    s_cmp_lt_u32 s67, 32
    s_cbranch_scc1 at_s2
    s_nop 15
    s_nop 7
    s_branch at_red
L_end:
L_exit:
    s_endpgm

.section .rodata,"a"
.p2align 6
.amdhsa_kernel gated_mix__mha_block__swiglu_ffn__prompt_kernel
  .amdhsa_next_free_vgpr 128
  .amdhsa_next_free_sgpr 102
  .amdhsa_accum_offset 128
  .amdhsa_group_segment_fixed_size 0
  .amdhsa_kernarg_size 88
  .amdhsa_user_sgpr_count 2
  .amdhsa_user_sgpr_kernarg_segment_ptr 1
  .amdhsa_system_sgpr_workgroup_id_x 1
  .amdhsa_float_denorm_mode_32 0
  .amdhsa_ieee_mode 0
  .amdhsa_dx10_clamp 1
.end_amdhsa_kernel
```
